```python
import torch

def _softmax(x, axis=-1):
    return torch.softmax(x, dim=axis)

def _gelu(x):
    return torch.nn.functional.gelu(x, approximate='tanh')

def _silu(x):
    return torch.nn.functional.silu(x)

def _sigmoid(x):
    return torch.sigmoid(x)

def _layernorm(x, axis=-1, eps=1e-05):
    m = x.mean(dim=axis, keepdim=True)
    v = x.var(dim=axis, keepdim=True, unbiased=False)
    return (x - m) / torch.sqrt(v + eps)

def _scatter_add(tgt, idx, src, axis=0):
    return tgt.clone().index_add_(axis, idx, src)

def _segment_sum(src, seg, n):
    out = torch.zeros((n,) + src.shape[1:], dtype=src.dtype)
    return out.index_add_(0, seg, src)

def _pad(x, pw):
    flat = tuple((v for pair in reversed(pw) for v in pair))
    return torch.nn.functional.pad(x, flat)
kernel_name = 'standalone__memory_aug_recurrent_mem_tr__prompt'

def setup_inputs():

    _w = lambda a: (lambda t: t.to(torch.bfloat16) if t.is_floating_point() else t)(torch.as_tensor(a))
    B, S, Dm = (1, 2048, 448)
    H, Dh = (16, 256)
    M, seg = (8, 32)
    seg = min(seg, S)
    S = S // seg * seg
    return {'x': _w((lambda *s: torch.randn(*s, dtype=torch.bfloat16) * 0.05)(B, S, Dm)), 'mem0': _w((lambda *s: torch.randn(*s, dtype=torch.bfloat16) * 0.4)(B, M, Dm)), 'Wq': _w((lambda *s: torch.randn(*s, dtype=torch.bfloat16) * 6.4)(Dm, H, Dh) * Dm ** (-0.5)), 'Wk': _w((lambda *s: torch.randn(*s, dtype=torch.bfloat16) * 6.4)(Dm, H, Dh) * Dm ** (-0.5)), 'Wv': _w((lambda *s: torch.randn(*s, dtype=torch.bfloat16) * 0.4)(Dm, H, Dh) * Dm ** (-0.5)), 'Wo': _w((lambda *s: torch.randn(*s, dtype=torch.bfloat16) * 0.4)(H, Dh, Dm) * (H * Dh) ** (-0.5)), 'seg_len': seg}

def reference(x, mem0, Wq, Wk, Wv, Wo, seg_len):
    B, S, Dm = x.shape
    H, Dh = (Wq.shape[1], Wq.shape[2])
    M = mem0.shape[1]
    scale = Dh ** (-0.5)
    n_seg = S // seg_len
    L = M + seg_len
    idx = torch.arange(L)
    mask = (idx[:, None] < M) | (idx[:, None] >= idx[None, :])
    mem = mem0
    outs = []
    for s in range(n_seg):
        xs = x[:, s * seg_len:(s + 1) * seg_len, :].clone()
        h = torch.concatenate([mem, xs], axis=1)
        q = torch.einsum('btd,dhe->bhte', h, Wq)
        k = torch.einsum('btd,dhe->bhte', h, Wk)
        v = torch.einsum('btd,dhe->bhte', h, Wv)
        scores = torch.einsum('bhqe,bhke->bhqk', q, k) * scale
        scores = torch.where(mask[None, None], scores, -1000000000.0)
        p = _softmax(scores, axis=-1)
        o = torch.einsum('bhqk,bhke->bhqe', p, v)
        o = torch.einsum('bhte,hed->btd', o, Wo)
        mem = o[:, :M, :].clone()
        outs.append(o[:, M:, :])
    return torch.concatenate(outs, axis=1)
```

```asm
; @launch grid=(256,1,1) block=(256,1,1) lds=163840
.amdgcn_target "amdgcn-amd-amdhsa--gfx950"
.text
.globl standalone__memory_aug_recurrent_mem_tr__prompt_kernel
.p2align 8
.type standalone__memory_aug_recurrent_mem_tr__prompt_kernel,@function

standalone__memory_aug_recurrent_mem_tr__prompt_kernel:
    s_cmp_ge_u32 s2, 256
    s_cbranch_scc1 standalone__memory_aug_recurrent_mem_tr__prompt_kernel_end
    s_load_dwordx4 s[28:31], s[0:1], 0
    s_load_dwordx4 s[32:35], s[0:1], 16
    s_load_dwordx4 s[36:39], s[0:1], 32
    s_load_dwordx2 s[40:41], s[0:1], 56
    s_load_dwordx4 s[44:47], s[0:1], 64
    s_getreg_b32 s3, hwreg(HW_REG_XCC_ID)
    s_and_b32 s3, s3, 7
    v_lshrrev_b32 v1, 6, v0
    v_mov_b32 v6, v0
    v_and_b32 v0, 63, v0
    v_readfirstlane_b32 s9, v1
    s_waitcnt lgkmcnt(0)
    s_mov_b32 s4, s46
    s_mov_b32 s5, s47
    s_mov_b32 s6, 0x10000000
    s_mov_b32 s7, 0x00020000
    s_mov_b32 s12, s44
    s_mov_b32 s13, s45
    s_mov_b32 s14, 256
    s_mov_b32 s15, 0x00020000
    s_mov_b32 s20, s40
    s_mov_b32 s21, s41
    s_mov_b32 s22, 1835008
    s_mov_b32 s23, 0x00020000
    s_mov_b32 s17, 262144

    s_and_b32 s24, s2, 7
    s_lshr_b32 s25, s2, 3
    v_lshrrev_b32 v3, 4, v0
    v_and_b32 v4, 15, v0
    s_cmp_eq_u32 s24, 0
    s_cbranch_scc1 standalone__memory_aug_recurrent_mem_tr__prompt_kernel_misc
    s_sub_u32 s24, s24, 1
    s_lshl_b32 s24, s24, 5
    s_add_u32 s24, s24, s25
    s_mul_i32 s26, s24, 9363
    s_lshr_b32 s26, s26, 16
    s_mul_i32 s27, s26, 7
    s_sub_u32 s48, s24, s27
    s_lshr_b32 s43, s26, 1
    s_and_b32 s25, s26, 1
    s_mul_i32 s25, s25, 14

    v_lshrrev_b32 v5, 3, v0
    v_and_b32 v7, 7, v0
    v_xor_b32 v7, v7, v5
    v_xor_b32 v7, s9, v7
    v_lshlrev_b32 v7, 4, v7
    v_lshl_add_u32 v8, v5, 13, v7
    v_xor_b32 v9, 64, v8
    s_lshl_b32 s50, s9, 10
    s_lshl_b32 s51, s48, 19
    s_lshl_b32 s52, s9, 16
    s_add_u32 s51, s51, s52
    s_lshl_b32 s53, s43, 9
    s_add_u32 s51, s51, s53
    s_add_u32 s52, s52, s53
    v_lshrrev_b32 v5, 2, v4
    v_and_b32 v7, 3, v4
    v_xor_b32 v10, v5, v7
    v_xor_b32 v10, v10, v3
    v_lshlrev_b32 v10, 4, v10
    v_lshl_add_u32 v10, v7, 7, v10
    v_lshl_add_u32 v10, v5, 10, v10
    s_cmp_ge_u32 s25, 14
    s_cbranch_scc1 standalone__memory_aug_recurrent_mem_tr__prompt_kernel_cjob

    s_mov_b32 s64, s32
    s_mov_b32 s65, s33
    s_mov_b32 s66, 3670016
    s_mov_b32 s67, 0x00020000
    s_mov_b32 s68, s34
    s_mov_b32 s69, s35
    s_mov_b32 s70, 3670016
    s_mov_b32 s71, 0x00020000
    v_lshrrev_b32 v5, 2, v4
    v_bfe_u32 v6, v4, 1, 1
    v_and_b32 v7, 1, v4
    v_lshl_add_u32 v6, v6, 2, v7
    s_mul_i32 s26, s9, 112
    v_lshlrev_b32 v7, 4, v5
    v_add3_u32 v11, v7, v6, s26
    v_lshlrev_b32 v7, 3, v5
    v_add3_u32 v12, v7, v6, s26
    v_add_u32 v13, s26, v4
    v_add_u32 v5, 0, v11
    v_lshrrev_b32 v6, 3, v5
    v_xor_b32 v7, v5, v6
    v_and_b32 v7, 7, v7
    v_xor_b32 v7, v7, v3
    v_lshlrev_b32 v7, 4, v7
    v_and_b32 v5, 7, v5
    v_lshl_add_u32 v7, v5, 7, v7
    v_lshl_add_u32 v7, v6, 10, v7
    v_add_u32 v16, 8192, v7
    v_xor_b32 v24, 64, v16
    v_add_u32 v5, 2, v11
    v_lshrrev_b32 v6, 3, v5
    v_xor_b32 v7, v5, v6
    v_and_b32 v7, 7, v7
    v_xor_b32 v7, v7, v3
    v_lshlrev_b32 v7, 4, v7
    v_and_b32 v5, 7, v5
    v_lshl_add_u32 v7, v5, 7, v7
    v_lshl_add_u32 v7, v6, 10, v7
    v_add_u32 v17, 8192, v7
    v_xor_b32 v25, 64, v17
    v_add_u32 v5, 8, v11
    v_lshrrev_b32 v6, 3, v5
    v_xor_b32 v7, v5, v6
    v_and_b32 v7, 7, v7
    v_xor_b32 v7, v7, v3
    v_lshlrev_b32 v7, 4, v7
    v_and_b32 v5, 7, v5
    v_lshl_add_u32 v7, v5, 7, v7
    v_lshl_add_u32 v7, v6, 10, v7
    v_add_u32 v18, 8192, v7
    v_xor_b32 v26, 64, v18
    v_add_u32 v5, 10, v11
    v_lshrrev_b32 v6, 3, v5
    v_xor_b32 v7, v5, v6
    v_and_b32 v7, 7, v7
    v_xor_b32 v7, v7, v3
    v_lshlrev_b32 v7, 4, v7
    v_and_b32 v5, 7, v5
    v_lshl_add_u32 v7, v5, 7, v7
    v_lshl_add_u32 v7, v6, 10, v7
    v_add_u32 v19, 8192, v7
    v_xor_b32 v27, 64, v19
    v_add_u32 v5, 64, v12
    v_lshrrev_b32 v6, 3, v5
    v_xor_b32 v7, v5, v6
    v_and_b32 v7, 7, v7
    v_xor_b32 v7, v7, v3
    v_lshlrev_b32 v7, 4, v7
    v_and_b32 v5, 7, v5
    v_lshl_add_u32 v7, v5, 7, v7
    v_lshl_add_u32 v7, v6, 10, v7
    v_add_u32 v20, 8192, v7
    v_xor_b32 v28, 64, v20
    v_add_u32 v5, 66, v12
    v_lshrrev_b32 v6, 3, v5
    v_xor_b32 v7, v5, v6
    v_and_b32 v7, 7, v7
    v_xor_b32 v7, v7, v3
    v_lshlrev_b32 v7, 4, v7
    v_and_b32 v5, 7, v5
    v_lshl_add_u32 v7, v5, 7, v7
    v_lshl_add_u32 v7, v6, 10, v7
    v_add_u32 v21, 8192, v7
    v_xor_b32 v29, 64, v21
    v_add_u32 v5, 96, v13
    v_lshrrev_b32 v6, 3, v5
    v_xor_b32 v7, v5, v6
    v_and_b32 v7, 7, v7
    v_xor_b32 v7, v7, v3
    v_lshlrev_b32 v7, 4, v7
    v_and_b32 v5, 7, v5
    v_lshl_add_u32 v7, v5, 7, v7
    v_lshl_add_u32 v7, v6, 10, v7
    v_add_u32 v22, 8192, v7
    v_xor_b32 v30, 64, v22
    v_lshlrev_b32 v2, 13, v0
    s_lshl_b32 s26, s48, 19
    s_add_u32 s26, s26, s53
    s_add_u32 s26, s26, 256
    s_cmp_eq_u32 s9, 0
    s_cbranch_scc0 standalone__memory_aug_recurrent_mem_tr__prompt_kernel_ta1
    buffer_load_dword v1, v2, s[64:67], s26 offen nt
    buffer_load_dword v1, v2, s[64:67], s26 offen offset:128 nt
standalone__memory_aug_recurrent_mem_tr__prompt_kernel_ta1:
    s_cmp_eq_u32 s9, 1
    s_cbranch_scc0 standalone__memory_aug_recurrent_mem_tr__prompt_kernel_ta2
    buffer_load_dword v1, v2, s[68:71], s26 offen nt
    buffer_load_dword v1, v2, s[68:71], s26 offen offset:128 nt
standalone__memory_aug_recurrent_mem_tr__prompt_kernel_ta2:
    s_add_u32 s26, s50, 0
    s_mov_b32 m0, s26
    s_add_u32 s27, s51, 0
    buffer_load_dwordx4 v8, s[64:67], s27 offen nt lds
    s_add_u32 s26, s50, 4096
    s_mov_b32 m0, s26
    s_add_u32 s27, s51, 262144
    buffer_load_dwordx4 v9, s[64:67], s27 offen nt lds
    s_add_u32 s26, s50, 8192
    s_mov_b32 m0, s26
    s_add_u32 s27, s52, 0
    buffer_load_dwordx4 v8, s[68:71], s27 offen nt lds
    s_add_u32 s26, s50, 12288
    s_mov_b32 m0, s26
    s_add_u32 s27, s52, 262144
    buffer_load_dwordx4 v9, s[68:71], s27 offen nt lds
    s_add_u32 s26, s50, 16384
    s_mov_b32 m0, s26
    s_add_u32 s27, s52, 524288
    buffer_load_dwordx4 v8, s[68:71], s27 offen nt lds
    s_add_u32 s26, s50, 20480
    s_mov_b32 m0, s26
    s_add_u32 s27, s52, 786432
    buffer_load_dwordx4 v9, s[68:71], s27 offen nt lds
    s_add_u32 s26, s50, 24576
    s_mov_b32 m0, s26
    s_add_u32 s27, s52, 1048576
    buffer_load_dwordx4 v8, s[68:71], s27 offen nt lds
    s_add_u32 s26, s50, 28672
    s_mov_b32 m0, s26
    s_add_u32 s27, s52, 1310720
    buffer_load_dwordx4 v9, s[68:71], s27 offen nt lds
    s_add_u32 s26, s50, 32768
    s_mov_b32 m0, s26
    s_add_u32 s27, s52, 1572864
    buffer_load_dwordx4 v8, s[68:71], s27 offen nt lds
    s_add_u32 s26, s50, 36864
    s_mov_b32 m0, s26
    s_add_u32 s27, s52, 1835008
    buffer_load_dwordx4 v9, s[68:71], s27 offen nt lds
    s_add_u32 s26, s50, 40960
    s_mov_b32 m0, s26
    s_add_u32 s27, s52, 2097152
    buffer_load_dwordx4 v8, s[68:71], s27 offen nt lds
    s_add_u32 s26, s50, 45056
    s_mov_b32 m0, s26
    s_add_u32 s27, s52, 2359296
    buffer_load_dwordx4 v9, s[68:71], s27 offen nt lds
    s_add_u32 s26, s50, 49152
    s_mov_b32 m0, s26
    s_add_u32 s27, s52, 2621440
    buffer_load_dwordx4 v8, s[68:71], s27 offen nt lds
    s_add_u32 s26, s50, 53248
    s_mov_b32 m0, s26
    s_add_u32 s27, s52, 2883584
    buffer_load_dwordx4 v9, s[68:71], s27 offen nt lds
    s_add_u32 s26, s50, 57344
    s_mov_b32 m0, s26
    s_add_u32 s27, s52, 3145728
    buffer_load_dwordx4 v8, s[68:71], s27 offen nt lds
    s_add_u32 s26, s50, 61440
    s_mov_b32 m0, s26
    s_add_u32 s27, s52, 3407872
    buffer_load_dwordx4 v9, s[68:71], s27 offen nt lds
    s_add_u32 s26, s50, 69632
    s_mov_b32 m0, s26
    s_add_u32 s27, s51, 128
    buffer_load_dwordx4 v8, s[64:67], s27 offen nt lds
    s_add_u32 s26, s50, 73728
    s_mov_b32 m0, s26
    s_add_u32 s27, s51, 262272
    buffer_load_dwordx4 v9, s[64:67], s27 offen nt lds
    s_add_u32 s26, s50, 77824
    s_mov_b32 m0, s26
    s_add_u32 s27, s52, 128
    buffer_load_dwordx4 v8, s[68:71], s27 offen nt lds
    s_add_u32 s26, s50, 81920
    s_mov_b32 m0, s26
    s_add_u32 s27, s52, 262272
    buffer_load_dwordx4 v9, s[68:71], s27 offen nt lds
    s_add_u32 s26, s50, 86016
    s_mov_b32 m0, s26
    s_add_u32 s27, s52, 524416
    buffer_load_dwordx4 v8, s[68:71], s27 offen nt lds
    s_add_u32 s26, s50, 90112
    s_mov_b32 m0, s26
    s_add_u32 s27, s52, 786560
    buffer_load_dwordx4 v9, s[68:71], s27 offen nt lds
    s_add_u32 s26, s50, 94208
    s_mov_b32 m0, s26
    s_add_u32 s27, s52, 1048704
    buffer_load_dwordx4 v8, s[68:71], s27 offen nt lds
    s_add_u32 s26, s50, 98304
    s_mov_b32 m0, s26
    s_add_u32 s27, s52, 1310848
    buffer_load_dwordx4 v9, s[68:71], s27 offen nt lds
    s_add_u32 s26, s50, 102400
    s_mov_b32 m0, s26
    s_add_u32 s27, s52, 1572992
    buffer_load_dwordx4 v8, s[68:71], s27 offen nt lds
    s_add_u32 s26, s50, 106496
    s_mov_b32 m0, s26
    s_add_u32 s27, s52, 1835136
    buffer_load_dwordx4 v9, s[68:71], s27 offen nt lds
    s_add_u32 s26, s50, 110592
    s_mov_b32 m0, s26
    s_add_u32 s27, s52, 2097280
    buffer_load_dwordx4 v8, s[68:71], s27 offen nt lds
    s_add_u32 s26, s50, 114688
    s_mov_b32 m0, s26
    s_add_u32 s27, s52, 2359424
    buffer_load_dwordx4 v9, s[68:71], s27 offen nt lds
    s_add_u32 s26, s50, 118784
    s_mov_b32 m0, s26
    s_add_u32 s27, s52, 2621568
    buffer_load_dwordx4 v8, s[68:71], s27 offen nt lds
    s_add_u32 s26, s50, 122880
    s_mov_b32 m0, s26
    s_add_u32 s27, s52, 2883712
    buffer_load_dwordx4 v9, s[68:71], s27 offen nt lds
    s_add_u32 s26, s50, 126976
    s_mov_b32 m0, s26
    s_add_u32 s27, s52, 3145856
    buffer_load_dwordx4 v8, s[68:71], s27 offen nt lds
    s_add_u32 s26, s50, 131072
    s_mov_b32 m0, s26
    s_add_u32 s27, s52, 3408000
    buffer_load_dwordx4 v9, s[68:71], s27 offen nt lds
    s_cmp_lg_u32 s9, 0
    s_cbranch_scc1 standalone__memory_aug_recurrent_mem_tr__prompt_kernel_registered1
    s_mov_b64 exec, 1
    s_cmp_lg_u32 s2, 0
    s_cbranch_scc1 standalone__memory_aug_recurrent_mem_tr__prompt_kernel_notag1
    s_memrealtime s[26:27]
    s_waitcnt lgkmcnt(0)
    s_andn2_b32 s26, s26, 15
    s_or_b32 s26, s26, 8
    s_or_b32 s26, s26, s3
    v_mov_b32 v250, s26
    v_mov_b32 v251, 32
    buffer_store_dword v250, v251, s[12:15], 0 offen sc1
    s_nop 1
standalone__memory_aug_recurrent_mem_tr__prompt_kernel_notag1:
    s_lshl_b32 s26, s3, 2
    v_mov_b32 v250, 1
    v_mov_b32 v251, s26
    buffer_atomic_add v250, v251, s[12:15], 0 offen sc0
    s_mov_b64 exec, -1
standalone__memory_aug_recurrent_mem_tr__prompt_kernel_registered1:
    s_waitcnt vmcnt(16)
    s_barrier
    ds_read_b128 v[144:147], v10 offset:0
    ds_read_b128 v[148:151], v10 offset:576
    ds_read_b128 v[152:155], v10 offset:4160
    ds_read_b128 v[156:159], v10 offset:4608
    ds_read_b128 v[176:179], v16
    ds_read_b128 v[180:183], v17
    ds_read_b128 v[184:187], v18
    ds_read_b128 v[188:191], v19
    ds_read_b128 v[192:195], v20
    ds_read_b128 v[196:199], v21
    ds_read_b128 v[200:203], v22
    ds_read_b128 v[160:163], v10 offset:64
    ds_read_b128 v[164:167], v10 offset:512
    ds_read_b128 v[168:171], v10 offset:4096
    ds_read_b128 v[172:175], v10 offset:4672
    ds_read_b128 v[204:207], v24
    ds_read_b128 v[208:211], v25
    ds_read_b128 v[212:215], v26
    ds_read_b128 v[216:219], v27
    ds_read_b128 v[220:223], v28
    ds_read_b128 v[224:227], v29
    ds_read_b128 v[228:231], v30
    s_waitcnt lgkmcnt(11)
    v_mfma_f32_16x16x32_bf16 v[32:35], v[144:147], v[176:179], 0
    v_mfma_f32_16x16x32_bf16 v[60:63], v[148:151], v[176:179], 0
    v_mfma_f32_16x16x32_bf16 v[88:91], v[152:155], v[176:179], 0
    v_mfma_f32_16x16x32_bf16 v[116:119], v[156:159], v[176:179], 0
    v_mfma_f32_16x16x32_bf16 v[36:39], v[144:147], v[180:183], 0
    v_mfma_f32_16x16x32_bf16 v[64:67], v[148:151], v[180:183], 0
    v_mfma_f32_16x16x32_bf16 v[92:95], v[152:155], v[180:183], 0
    v_mfma_f32_16x16x32_bf16 v[120:123], v[156:159], v[180:183], 0
    v_mfma_f32_16x16x32_bf16 v[40:43], v[144:147], v[184:187], 0
    v_mfma_f32_16x16x32_bf16 v[68:71], v[148:151], v[184:187], 0
    v_mfma_f32_16x16x32_bf16 v[96:99], v[152:155], v[184:187], 0
    v_mfma_f32_16x16x32_bf16 v[124:127], v[156:159], v[184:187], 0
    v_mfma_f32_16x16x32_bf16 v[44:47], v[144:147], v[188:191], 0
    v_mfma_f32_16x16x32_bf16 v[72:75], v[148:151], v[188:191], 0
    v_mfma_f32_16x16x32_bf16 v[100:103], v[152:155], v[188:191], 0
    v_mfma_f32_16x16x32_bf16 v[128:131], v[156:159], v[188:191], 0
    v_mfma_f32_16x16x32_bf16 v[48:51], v[144:147], v[192:195], 0
    v_mfma_f32_16x16x32_bf16 v[76:79], v[148:151], v[192:195], 0
    v_mfma_f32_16x16x32_bf16 v[104:107], v[152:155], v[192:195], 0
    v_mfma_f32_16x16x32_bf16 v[132:135], v[156:159], v[192:195], 0
    v_mfma_f32_16x16x32_bf16 v[52:55], v[144:147], v[196:199], 0
    v_mfma_f32_16x16x32_bf16 v[80:83], v[148:151], v[196:199], 0
    v_mfma_f32_16x16x32_bf16 v[108:111], v[152:155], v[196:199], 0
    v_mfma_f32_16x16x32_bf16 v[136:139], v[156:159], v[196:199], 0
    v_mfma_f32_16x16x32_bf16 v[56:59], v[144:147], v[200:203], 0
    v_mfma_f32_16x16x32_bf16 v[84:87], v[148:151], v[200:203], 0
    v_mfma_f32_16x16x32_bf16 v[112:115], v[152:155], v[200:203], 0
    v_mfma_f32_16x16x32_bf16 v[140:143], v[156:159], v[200:203], 0
    s_waitcnt lgkmcnt(0)
    v_mfma_f32_16x16x32_bf16 v[32:35], v[160:163], v[204:207], v[32:35]
    v_mfma_f32_16x16x32_bf16 v[60:63], v[164:167], v[204:207], v[60:63]
    v_mfma_f32_16x16x32_bf16 v[88:91], v[168:171], v[204:207], v[88:91]
    v_mfma_f32_16x16x32_bf16 v[116:119], v[172:175], v[204:207], v[116:119]
    v_mfma_f32_16x16x32_bf16 v[36:39], v[160:163], v[208:211], v[36:39]
    v_mfma_f32_16x16x32_bf16 v[64:67], v[164:167], v[208:211], v[64:67]
    v_mfma_f32_16x16x32_bf16 v[92:95], v[168:171], v[208:211], v[92:95]
    v_mfma_f32_16x16x32_bf16 v[120:123], v[172:175], v[208:211], v[120:123]
    v_mfma_f32_16x16x32_bf16 v[40:43], v[160:163], v[212:215], v[40:43]
    v_mfma_f32_16x16x32_bf16 v[68:71], v[164:167], v[212:215], v[68:71]
    v_mfma_f32_16x16x32_bf16 v[96:99], v[168:171], v[212:215], v[96:99]
    v_mfma_f32_16x16x32_bf16 v[124:127], v[172:175], v[212:215], v[124:127]
    v_mfma_f32_16x16x32_bf16 v[44:47], v[160:163], v[216:219], v[44:47]
    v_mfma_f32_16x16x32_bf16 v[72:75], v[164:167], v[216:219], v[72:75]
    v_mfma_f32_16x16x32_bf16 v[100:103], v[168:171], v[216:219], v[100:103]
    v_mfma_f32_16x16x32_bf16 v[128:131], v[172:175], v[216:219], v[128:131]
    v_mfma_f32_16x16x32_bf16 v[48:51], v[160:163], v[220:223], v[48:51]
    v_mfma_f32_16x16x32_bf16 v[76:79], v[164:167], v[220:223], v[76:79]
    v_mfma_f32_16x16x32_bf16 v[104:107], v[168:171], v[220:223], v[104:107]
    v_mfma_f32_16x16x32_bf16 v[132:135], v[172:175], v[220:223], v[132:135]
    v_mfma_f32_16x16x32_bf16 v[52:55], v[160:163], v[224:227], v[52:55]
    v_mfma_f32_16x16x32_bf16 v[80:83], v[164:167], v[224:227], v[80:83]
    v_mfma_f32_16x16x32_bf16 v[108:111], v[168:171], v[224:227], v[108:111]
    v_mfma_f32_16x16x32_bf16 v[136:139], v[172:175], v[224:227], v[136:139]
    v_mfma_f32_16x16x32_bf16 v[56:59], v[160:163], v[228:231], v[56:59]
    v_mfma_f32_16x16x32_bf16 v[84:87], v[164:167], v[228:231], v[84:87]
    v_mfma_f32_16x16x32_bf16 v[112:115], v[168:171], v[228:231], v[112:115]
    v_mfma_f32_16x16x32_bf16 v[140:143], v[172:175], v[228:231], v[140:143]
    v_add_u32 v10, 69632, v10
    v_add_u32 v16, 69632, v16
    v_add_u32 v17, 69632, v17
    v_add_u32 v18, 69632, v18
    v_add_u32 v19, 69632, v19
    v_add_u32 v20, 69632, v20
    v_add_u32 v21, 69632, v21
    v_add_u32 v22, 69632, v22
    v_add_u32 v24, 69632, v24
    v_add_u32 v25, 69632, v25
    v_add_u32 v26, 69632, v26
    v_add_u32 v27, 69632, v27
    v_add_u32 v28, 69632, v28
    v_add_u32 v29, 69632, v29
    v_add_u32 v30, 69632, v30
    s_barrier
    s_add_u32 s26, s50, 0
    s_mov_b32 m0, s26
    s_add_u32 s27, s51, 256
    buffer_load_dwordx4 v8, s[64:67], s27 offen nt lds
    s_add_u32 s26, s50, 4096
    s_mov_b32 m0, s26
    s_add_u32 s27, s51, 262400
    buffer_load_dwordx4 v9, s[64:67], s27 offen nt lds
    s_add_u32 s26, s50, 8192
    s_mov_b32 m0, s26
    s_add_u32 s27, s52, 256
    buffer_load_dwordx4 v8, s[68:71], s27 offen nt lds
    s_add_u32 s26, s50, 12288
    s_mov_b32 m0, s26
    s_add_u32 s27, s52, 262400
    buffer_load_dwordx4 v9, s[68:71], s27 offen nt lds
    s_add_u32 s26, s50, 16384
    s_mov_b32 m0, s26
    s_add_u32 s27, s52, 524544
    buffer_load_dwordx4 v8, s[68:71], s27 offen nt lds
    s_add_u32 s26, s50, 20480
    s_mov_b32 m0, s26
    s_add_u32 s27, s52, 786688
    buffer_load_dwordx4 v9, s[68:71], s27 offen nt lds
    s_add_u32 s26, s50, 24576
    s_mov_b32 m0, s26
    s_add_u32 s27, s52, 1048832
    buffer_load_dwordx4 v8, s[68:71], s27 offen nt lds
    s_add_u32 s26, s50, 28672
    s_mov_b32 m0, s26
    s_add_u32 s27, s52, 1310976
    buffer_load_dwordx4 v9, s[68:71], s27 offen nt lds
    s_add_u32 s26, s50, 32768
    s_mov_b32 m0, s26
    s_add_u32 s27, s52, 1573120
    buffer_load_dwordx4 v8, s[68:71], s27 offen nt lds
    s_add_u32 s26, s50, 36864
    s_mov_b32 m0, s26
    s_add_u32 s27, s52, 1835264
    buffer_load_dwordx4 v9, s[68:71], s27 offen nt lds
    s_add_u32 s26, s50, 40960
    s_mov_b32 m0, s26
    s_add_u32 s27, s52, 2097408
    buffer_load_dwordx4 v8, s[68:71], s27 offen nt lds
    s_add_u32 s26, s50, 45056
    s_mov_b32 m0, s26
    s_add_u32 s27, s52, 2359552
    buffer_load_dwordx4 v9, s[68:71], s27 offen nt lds
    s_add_u32 s26, s50, 49152
    s_mov_b32 m0, s26
    s_add_u32 s27, s52, 2621696
    buffer_load_dwordx4 v8, s[68:71], s27 offen nt lds
    s_add_u32 s26, s50, 53248
    s_mov_b32 m0, s26
    s_add_u32 s27, s52, 2883840
    buffer_load_dwordx4 v9, s[68:71], s27 offen nt lds
    s_add_u32 s26, s50, 57344
    s_mov_b32 m0, s26
    s_add_u32 s27, s52, 3145984
    buffer_load_dwordx4 v8, s[68:71], s27 offen nt lds
    s_add_u32 s26, s50, 61440
    s_mov_b32 m0, s26
    s_add_u32 s27, s52, 3408128
    buffer_load_dwordx4 v9, s[68:71], s27 offen nt lds
    s_waitcnt vmcnt(16)
    s_barrier
    ds_read_b128 v[144:147], v10 offset:0
    ds_read_b128 v[148:151], v10 offset:576
    ds_read_b128 v[152:155], v10 offset:4160
    ds_read_b128 v[156:159], v10 offset:4608
    ds_read_b128 v[176:179], v16
    ds_read_b128 v[180:183], v17
    ds_read_b128 v[184:187], v18
    ds_read_b128 v[188:191], v19
    ds_read_b128 v[192:195], v20
    ds_read_b128 v[196:199], v21
    ds_read_b128 v[200:203], v22
    ds_read_b128 v[160:163], v10 offset:64
    ds_read_b128 v[164:167], v10 offset:512
    ds_read_b128 v[168:171], v10 offset:4096
    ds_read_b128 v[172:175], v10 offset:4672
    ds_read_b128 v[204:207], v24
    ds_read_b128 v[208:211], v25
    ds_read_b128 v[212:215], v26
    ds_read_b128 v[216:219], v27
    ds_read_b128 v[220:223], v28
    ds_read_b128 v[224:227], v29
    ds_read_b128 v[228:231], v30
    s_waitcnt lgkmcnt(11)
    v_mfma_f32_16x16x32_bf16 v[32:35], v[144:147], v[176:179], v[32:35]
    v_mfma_f32_16x16x32_bf16 v[60:63], v[148:151], v[176:179], v[60:63]
    v_mfma_f32_16x16x32_bf16 v[88:91], v[152:155], v[176:179], v[88:91]
    v_mfma_f32_16x16x32_bf16 v[116:119], v[156:159], v[176:179], v[116:119]
    v_mfma_f32_16x16x32_bf16 v[36:39], v[144:147], v[180:183], v[36:39]
    v_mfma_f32_16x16x32_bf16 v[64:67], v[148:151], v[180:183], v[64:67]
    v_mfma_f32_16x16x32_bf16 v[92:95], v[152:155], v[180:183], v[92:95]
    v_mfma_f32_16x16x32_bf16 v[120:123], v[156:159], v[180:183], v[120:123]
    v_mfma_f32_16x16x32_bf16 v[40:43], v[144:147], v[184:187], v[40:43]
    v_mfma_f32_16x16x32_bf16 v[68:71], v[148:151], v[184:187], v[68:71]
    v_mfma_f32_16x16x32_bf16 v[96:99], v[152:155], v[184:187], v[96:99]
    v_mfma_f32_16x16x32_bf16 v[124:127], v[156:159], v[184:187], v[124:127]
    v_mfma_f32_16x16x32_bf16 v[44:47], v[144:147], v[188:191], v[44:47]
    v_mfma_f32_16x16x32_bf16 v[72:75], v[148:151], v[188:191], v[72:75]
    v_mfma_f32_16x16x32_bf16 v[100:103], v[152:155], v[188:191], v[100:103]
    v_mfma_f32_16x16x32_bf16 v[128:131], v[156:159], v[188:191], v[128:131]
    v_mfma_f32_16x16x32_bf16 v[48:51], v[144:147], v[192:195], v[48:51]
    v_mfma_f32_16x16x32_bf16 v[76:79], v[148:151], v[192:195], v[76:79]
    v_mfma_f32_16x16x32_bf16 v[104:107], v[152:155], v[192:195], v[104:107]
    v_mfma_f32_16x16x32_bf16 v[132:135], v[156:159], v[192:195], v[132:135]
    v_mfma_f32_16x16x32_bf16 v[52:55], v[144:147], v[196:199], v[52:55]
    v_mfma_f32_16x16x32_bf16 v[80:83], v[148:151], v[196:199], v[80:83]
    v_mfma_f32_16x16x32_bf16 v[108:111], v[152:155], v[196:199], v[108:111]
    v_mfma_f32_16x16x32_bf16 v[136:139], v[156:159], v[196:199], v[136:139]
    v_mfma_f32_16x16x32_bf16 v[56:59], v[144:147], v[200:203], v[56:59]
    v_mfma_f32_16x16x32_bf16 v[84:87], v[148:151], v[200:203], v[84:87]
    v_mfma_f32_16x16x32_bf16 v[112:115], v[152:155], v[200:203], v[112:115]
    v_mfma_f32_16x16x32_bf16 v[140:143], v[156:159], v[200:203], v[140:143]
    s_waitcnt lgkmcnt(0)
    v_mfma_f32_16x16x32_bf16 v[32:35], v[160:163], v[204:207], v[32:35]
    v_mfma_f32_16x16x32_bf16 v[60:63], v[164:167], v[204:207], v[60:63]
    v_mfma_f32_16x16x32_bf16 v[88:91], v[168:171], v[204:207], v[88:91]
    v_mfma_f32_16x16x32_bf16 v[116:119], v[172:175], v[204:207], v[116:119]
    v_mfma_f32_16x16x32_bf16 v[36:39], v[160:163], v[208:211], v[36:39]
    v_mfma_f32_16x16x32_bf16 v[64:67], v[164:167], v[208:211], v[64:67]
    v_mfma_f32_16x16x32_bf16 v[92:95], v[168:171], v[208:211], v[92:95]
    v_mfma_f32_16x16x32_bf16 v[120:123], v[172:175], v[208:211], v[120:123]
    v_mfma_f32_16x16x32_bf16 v[40:43], v[160:163], v[212:215], v[40:43]
    v_mfma_f32_16x16x32_bf16 v[68:71], v[164:167], v[212:215], v[68:71]
    v_mfma_f32_16x16x32_bf16 v[96:99], v[168:171], v[212:215], v[96:99]
    v_mfma_f32_16x16x32_bf16 v[124:127], v[172:175], v[212:215], v[124:127]
    v_mfma_f32_16x16x32_bf16 v[44:47], v[160:163], v[216:219], v[44:47]
    v_mfma_f32_16x16x32_bf16 v[72:75], v[164:167], v[216:219], v[72:75]
    v_mfma_f32_16x16x32_bf16 v[100:103], v[168:171], v[216:219], v[100:103]
    v_mfma_f32_16x16x32_bf16 v[128:131], v[172:175], v[216:219], v[128:131]
    v_mfma_f32_16x16x32_bf16 v[48:51], v[160:163], v[220:223], v[48:51]
    v_mfma_f32_16x16x32_bf16 v[76:79], v[164:167], v[220:223], v[76:79]
    v_mfma_f32_16x16x32_bf16 v[104:107], v[168:171], v[220:223], v[104:107]
    v_mfma_f32_16x16x32_bf16 v[132:135], v[172:175], v[220:223], v[132:135]
    v_mfma_f32_16x16x32_bf16 v[52:55], v[160:163], v[224:227], v[52:55]
    v_mfma_f32_16x16x32_bf16 v[80:83], v[164:167], v[224:227], v[80:83]
    v_mfma_f32_16x16x32_bf16 v[108:111], v[168:171], v[224:227], v[108:111]
    v_mfma_f32_16x16x32_bf16 v[136:139], v[172:175], v[224:227], v[136:139]
    v_mfma_f32_16x16x32_bf16 v[56:59], v[160:163], v[228:231], v[56:59]
    v_mfma_f32_16x16x32_bf16 v[84:87], v[164:167], v[228:231], v[84:87]
    v_mfma_f32_16x16x32_bf16 v[112:115], v[168:171], v[228:231], v[112:115]
    v_mfma_f32_16x16x32_bf16 v[140:143], v[172:175], v[228:231], v[140:143]
    v_add_u32 v10, 4294897664, v10
    v_add_u32 v16, 4294897664, v16
    v_add_u32 v17, 4294897664, v17
    v_add_u32 v18, 4294897664, v18
    v_add_u32 v19, 4294897664, v19
    v_add_u32 v20, 4294897664, v20
    v_add_u32 v21, 4294897664, v21
    v_add_u32 v22, 4294897664, v22
    v_add_u32 v24, 4294897664, v24
    v_add_u32 v25, 4294897664, v25
    v_add_u32 v26, 4294897664, v26
    v_add_u32 v27, 4294897664, v27
    v_add_u32 v28, 4294897664, v28
    v_add_u32 v29, 4294897664, v29
    v_add_u32 v30, 4294897664, v30
    s_barrier
    s_add_u32 s26, s50, 69632
    s_mov_b32 m0, s26
    s_add_u32 s27, s51, 384
    buffer_load_dwordx4 v8, s[64:67], s27 offen nt lds
    s_add_u32 s26, s50, 73728
    s_mov_b32 m0, s26
    s_add_u32 s27, s51, 262528
    buffer_load_dwordx4 v9, s[64:67], s27 offen nt lds
    s_add_u32 s26, s50, 77824
    s_mov_b32 m0, s26
    s_add_u32 s27, s52, 384
    buffer_load_dwordx4 v8, s[68:71], s27 offen nt lds
    s_add_u32 s26, s50, 81920
    s_mov_b32 m0, s26
    s_add_u32 s27, s52, 262528
    buffer_load_dwordx4 v9, s[68:71], s27 offen nt lds
    s_add_u32 s26, s50, 86016
    s_mov_b32 m0, s26
    s_add_u32 s27, s52, 524672
    buffer_load_dwordx4 v8, s[68:71], s27 offen nt lds
    s_add_u32 s26, s50, 90112
    s_mov_b32 m0, s26
    s_add_u32 s27, s52, 786816
    buffer_load_dwordx4 v9, s[68:71], s27 offen nt lds
    s_add_u32 s26, s50, 94208
    s_mov_b32 m0, s26
    s_add_u32 s27, s52, 1048960
    buffer_load_dwordx4 v8, s[68:71], s27 offen nt lds
    s_add_u32 s26, s50, 98304
    s_mov_b32 m0, s26
    s_add_u32 s27, s52, 1311104
    buffer_load_dwordx4 v9, s[68:71], s27 offen nt lds
    s_add_u32 s26, s50, 102400
    s_mov_b32 m0, s26
    s_add_u32 s27, s52, 1573248
    buffer_load_dwordx4 v8, s[68:71], s27 offen nt lds
    s_add_u32 s26, s50, 106496
    s_mov_b32 m0, s26
    s_add_u32 s27, s52, 1835392
    buffer_load_dwordx4 v9, s[68:71], s27 offen nt lds
    s_add_u32 s26, s50, 110592
    s_mov_b32 m0, s26
    s_add_u32 s27, s52, 2097536
    buffer_load_dwordx4 v8, s[68:71], s27 offen nt lds
    s_add_u32 s26, s50, 114688
    s_mov_b32 m0, s26
    s_add_u32 s27, s52, 2359680
    buffer_load_dwordx4 v9, s[68:71], s27 offen nt lds
    s_add_u32 s26, s50, 118784
    s_mov_b32 m0, s26
    s_add_u32 s27, s52, 2621824
    buffer_load_dwordx4 v8, s[68:71], s27 offen nt lds
    s_add_u32 s26, s50, 122880
    s_mov_b32 m0, s26
    s_add_u32 s27, s52, 2883968
    buffer_load_dwordx4 v9, s[68:71], s27 offen nt lds
    s_add_u32 s26, s50, 126976
    s_mov_b32 m0, s26
    s_add_u32 s27, s52, 3146112
    buffer_load_dwordx4 v8, s[68:71], s27 offen nt lds
    s_add_u32 s26, s50, 131072
    s_mov_b32 m0, s26
    s_add_u32 s27, s52, 3408256
    buffer_load_dwordx4 v9, s[68:71], s27 offen nt lds
    v_lshlrev_b32 v253, 2, v0
    buffer_load_dword v252, v253, s[12:15], 0 offen sc1
    s_waitcnt vmcnt(16)
    s_barrier
    ds_read_b128 v[144:147], v10 offset:0
    ds_read_b128 v[148:151], v10 offset:576
    ds_read_b128 v[152:155], v10 offset:4160
    ds_read_b128 v[156:159], v10 offset:4608
    ds_read_b128 v[176:179], v16
    ds_read_b128 v[180:183], v17
    ds_read_b128 v[184:187], v18
    ds_read_b128 v[188:191], v19
    ds_read_b128 v[192:195], v20
    ds_read_b128 v[196:199], v21
    ds_read_b128 v[200:203], v22
    ds_read_b128 v[160:163], v10 offset:64
    ds_read_b128 v[164:167], v10 offset:512
    ds_read_b128 v[168:171], v10 offset:4096
    ds_read_b128 v[172:175], v10 offset:4672
    ds_read_b128 v[204:207], v24
    ds_read_b128 v[208:211], v25
    ds_read_b128 v[212:215], v26
    ds_read_b128 v[216:219], v27
    ds_read_b128 v[220:223], v28
    ds_read_b128 v[224:227], v29
    ds_read_b128 v[228:231], v30
    s_waitcnt lgkmcnt(11)
    v_mfma_f32_16x16x32_bf16 v[32:35], v[144:147], v[176:179], v[32:35]
    v_mfma_f32_16x16x32_bf16 v[60:63], v[148:151], v[176:179], v[60:63]
    v_mfma_f32_16x16x32_bf16 v[88:91], v[152:155], v[176:179], v[88:91]
    v_mfma_f32_16x16x32_bf16 v[116:119], v[156:159], v[176:179], v[116:119]
    v_mfma_f32_16x16x32_bf16 v[36:39], v[144:147], v[180:183], v[36:39]
    v_mfma_f32_16x16x32_bf16 v[64:67], v[148:151], v[180:183], v[64:67]
    v_mfma_f32_16x16x32_bf16 v[92:95], v[152:155], v[180:183], v[92:95]
    v_mfma_f32_16x16x32_bf16 v[120:123], v[156:159], v[180:183], v[120:123]
    v_mfma_f32_16x16x32_bf16 v[40:43], v[144:147], v[184:187], v[40:43]
    v_mfma_f32_16x16x32_bf16 v[68:71], v[148:151], v[184:187], v[68:71]
    v_mfma_f32_16x16x32_bf16 v[96:99], v[152:155], v[184:187], v[96:99]
    v_mfma_f32_16x16x32_bf16 v[124:127], v[156:159], v[184:187], v[124:127]
    v_mfma_f32_16x16x32_bf16 v[44:47], v[144:147], v[188:191], v[44:47]
    v_mfma_f32_16x16x32_bf16 v[72:75], v[148:151], v[188:191], v[72:75]
    v_mfma_f32_16x16x32_bf16 v[100:103], v[152:155], v[188:191], v[100:103]
    v_mfma_f32_16x16x32_bf16 v[128:131], v[156:159], v[188:191], v[128:131]
    v_mfma_f32_16x16x32_bf16 v[48:51], v[144:147], v[192:195], v[48:51]
    v_mfma_f32_16x16x32_bf16 v[76:79], v[148:151], v[192:195], v[76:79]
    v_mfma_f32_16x16x32_bf16 v[104:107], v[152:155], v[192:195], v[104:107]
    v_mfma_f32_16x16x32_bf16 v[132:135], v[156:159], v[192:195], v[132:135]
    v_mfma_f32_16x16x32_bf16 v[52:55], v[144:147], v[196:199], v[52:55]
    v_mfma_f32_16x16x32_bf16 v[80:83], v[148:151], v[196:199], v[80:83]
    v_mfma_f32_16x16x32_bf16 v[108:111], v[152:155], v[196:199], v[108:111]
    v_mfma_f32_16x16x32_bf16 v[136:139], v[156:159], v[196:199], v[136:139]
    v_mfma_f32_16x16x32_bf16 v[56:59], v[144:147], v[200:203], v[56:59]
    v_mfma_f32_16x16x32_bf16 v[84:87], v[148:151], v[200:203], v[84:87]
    v_mfma_f32_16x16x32_bf16 v[112:115], v[152:155], v[200:203], v[112:115]
    v_mfma_f32_16x16x32_bf16 v[140:143], v[156:159], v[200:203], v[140:143]
    s_waitcnt lgkmcnt(0)
    v_mfma_f32_16x16x32_bf16 v[32:35], v[160:163], v[204:207], v[32:35]
    v_mfma_f32_16x16x32_bf16 v[60:63], v[164:167], v[204:207], v[60:63]
    v_mfma_f32_16x16x32_bf16 v[88:91], v[168:171], v[204:207], v[88:91]
    v_mfma_f32_16x16x32_bf16 v[116:119], v[172:175], v[204:207], v[116:119]
    v_mfma_f32_16x16x32_bf16 v[36:39], v[160:163], v[208:211], v[36:39]
    v_mfma_f32_16x16x32_bf16 v[64:67], v[164:167], v[208:211], v[64:67]
    v_mfma_f32_16x16x32_bf16 v[92:95], v[168:171], v[208:211], v[92:95]
    v_mfma_f32_16x16x32_bf16 v[120:123], v[172:175], v[208:211], v[120:123]
    v_mfma_f32_16x16x32_bf16 v[40:43], v[160:163], v[212:215], v[40:43]
    v_mfma_f32_16x16x32_bf16 v[68:71], v[164:167], v[212:215], v[68:71]
    v_mfma_f32_16x16x32_bf16 v[96:99], v[168:171], v[212:215], v[96:99]
    v_mfma_f32_16x16x32_bf16 v[124:127], v[172:175], v[212:215], v[124:127]
    v_mfma_f32_16x16x32_bf16 v[44:47], v[160:163], v[216:219], v[44:47]
    v_mfma_f32_16x16x32_bf16 v[72:75], v[164:167], v[216:219], v[72:75]
    v_mfma_f32_16x16x32_bf16 v[100:103], v[168:171], v[216:219], v[100:103]
    v_mfma_f32_16x16x32_bf16 v[128:131], v[172:175], v[216:219], v[128:131]
    v_mfma_f32_16x16x32_bf16 v[48:51], v[160:163], v[220:223], v[48:51]
    v_mfma_f32_16x16x32_bf16 v[76:79], v[164:167], v[220:223], v[76:79]
    v_mfma_f32_16x16x32_bf16 v[104:107], v[168:171], v[220:223], v[104:107]
    v_mfma_f32_16x16x32_bf16 v[132:135], v[172:175], v[220:223], v[132:135]
    v_mfma_f32_16x16x32_bf16 v[52:55], v[160:163], v[224:227], v[52:55]
    v_mfma_f32_16x16x32_bf16 v[80:83], v[164:167], v[224:227], v[80:83]
    v_mfma_f32_16x16x32_bf16 v[108:111], v[168:171], v[224:227], v[108:111]
    v_mfma_f32_16x16x32_bf16 v[136:139], v[172:175], v[224:227], v[136:139]
    v_mfma_f32_16x16x32_bf16 v[56:59], v[160:163], v[228:231], v[56:59]
    v_mfma_f32_16x16x32_bf16 v[84:87], v[164:167], v[228:231], v[84:87]
    v_mfma_f32_16x16x32_bf16 v[112:115], v[168:171], v[228:231], v[112:115]
    v_mfma_f32_16x16x32_bf16 v[140:143], v[172:175], v[228:231], v[140:143]
    v_add_u32 v10, 69632, v10
    v_add_u32 v16, 69632, v16
    v_add_u32 v17, 69632, v17
    v_add_u32 v18, 69632, v18
    v_add_u32 v19, 69632, v19
    v_add_u32 v20, 69632, v20
    v_add_u32 v21, 69632, v21
    v_add_u32 v22, 69632, v22
    v_add_u32 v24, 69632, v24
    v_add_u32 v25, 69632, v25
    v_add_u32 v26, 69632, v26
    v_add_u32 v27, 69632, v27
    v_add_u32 v28, 69632, v28
    v_add_u32 v29, 69632, v29
    v_add_u32 v30, 69632, v30
    s_waitcnt vmcnt(0)
    s_barrier
    ds_read_b128 v[144:147], v10 offset:0
    ds_read_b128 v[148:151], v10 offset:576
    ds_read_b128 v[152:155], v10 offset:4160
    ds_read_b128 v[156:159], v10 offset:4608
    ds_read_b128 v[176:179], v16
    ds_read_b128 v[180:183], v17
    ds_read_b128 v[184:187], v18
    ds_read_b128 v[188:191], v19
    ds_read_b128 v[192:195], v20
    ds_read_b128 v[196:199], v21
    ds_read_b128 v[200:203], v22
    ds_read_b128 v[160:163], v10 offset:64
    ds_read_b128 v[164:167], v10 offset:512
    ds_read_b128 v[168:171], v10 offset:4096
    ds_read_b128 v[172:175], v10 offset:4672
    ds_read_b128 v[204:207], v24
    ds_read_b128 v[208:211], v25
    ds_read_b128 v[212:215], v26
    ds_read_b128 v[216:219], v27
    ds_read_b128 v[220:223], v28
    ds_read_b128 v[224:227], v29
    ds_read_b128 v[228:231], v30
    s_waitcnt lgkmcnt(11)
    v_mfma_f32_16x16x32_bf16 v[32:35], v[144:147], v[176:179], v[32:35]
    v_mfma_f32_16x16x32_bf16 v[60:63], v[148:151], v[176:179], v[60:63]
    v_mfma_f32_16x16x32_bf16 v[88:91], v[152:155], v[176:179], v[88:91]
    v_mfma_f32_16x16x32_bf16 v[116:119], v[156:159], v[176:179], v[116:119]
    v_mfma_f32_16x16x32_bf16 v[36:39], v[144:147], v[180:183], v[36:39]
    v_mfma_f32_16x16x32_bf16 v[64:67], v[148:151], v[180:183], v[64:67]
    v_mfma_f32_16x16x32_bf16 v[92:95], v[152:155], v[180:183], v[92:95]
    v_mfma_f32_16x16x32_bf16 v[120:123], v[156:159], v[180:183], v[120:123]
    v_mfma_f32_16x16x32_bf16 v[40:43], v[144:147], v[184:187], v[40:43]
    v_mfma_f32_16x16x32_bf16 v[68:71], v[148:151], v[184:187], v[68:71]
    v_mfma_f32_16x16x32_bf16 v[96:99], v[152:155], v[184:187], v[96:99]
    v_mfma_f32_16x16x32_bf16 v[124:127], v[156:159], v[184:187], v[124:127]
    v_mfma_f32_16x16x32_bf16 v[44:47], v[144:147], v[188:191], v[44:47]
    v_mfma_f32_16x16x32_bf16 v[72:75], v[148:151], v[188:191], v[72:75]
    v_mfma_f32_16x16x32_bf16 v[100:103], v[152:155], v[188:191], v[100:103]
    v_mfma_f32_16x16x32_bf16 v[128:131], v[156:159], v[188:191], v[128:131]
    v_mfma_f32_16x16x32_bf16 v[48:51], v[144:147], v[192:195], v[48:51]
    v_mfma_f32_16x16x32_bf16 v[76:79], v[148:151], v[192:195], v[76:79]
    v_mfma_f32_16x16x32_bf16 v[104:107], v[152:155], v[192:195], v[104:107]
    v_mfma_f32_16x16x32_bf16 v[132:135], v[156:159], v[192:195], v[132:135]
    v_mfma_f32_16x16x32_bf16 v[52:55], v[144:147], v[196:199], v[52:55]
    v_mfma_f32_16x16x32_bf16 v[80:83], v[148:151], v[196:199], v[80:83]
    v_mfma_f32_16x16x32_bf16 v[108:111], v[152:155], v[196:199], v[108:111]
    v_mfma_f32_16x16x32_bf16 v[136:139], v[156:159], v[196:199], v[136:139]
    v_mfma_f32_16x16x32_bf16 v[56:59], v[144:147], v[200:203], v[56:59]
    v_mfma_f32_16x16x32_bf16 v[84:87], v[148:151], v[200:203], v[84:87]
    v_mfma_f32_16x16x32_bf16 v[112:115], v[152:155], v[200:203], v[112:115]
    v_mfma_f32_16x16x32_bf16 v[140:143], v[156:159], v[200:203], v[140:143]
    s_waitcnt lgkmcnt(0)
    v_mfma_f32_16x16x32_bf16 v[32:35], v[160:163], v[204:207], v[32:35]
    v_mfma_f32_16x16x32_bf16 v[60:63], v[164:167], v[204:207], v[60:63]
    v_mfma_f32_16x16x32_bf16 v[88:91], v[168:171], v[204:207], v[88:91]
    v_mfma_f32_16x16x32_bf16 v[116:119], v[172:175], v[204:207], v[116:119]
    v_mfma_f32_16x16x32_bf16 v[36:39], v[160:163], v[208:211], v[36:39]
    v_mfma_f32_16x16x32_bf16 v[64:67], v[164:167], v[208:211], v[64:67]
    v_mfma_f32_16x16x32_bf16 v[92:95], v[168:171], v[208:211], v[92:95]
    v_mfma_f32_16x16x32_bf16 v[120:123], v[172:175], v[208:211], v[120:123]
    v_mfma_f32_16x16x32_bf16 v[40:43], v[160:163], v[212:215], v[40:43]
    v_mfma_f32_16x16x32_bf16 v[68:71], v[164:167], v[212:215], v[68:71]
    v_mfma_f32_16x16x32_bf16 v[96:99], v[168:171], v[212:215], v[96:99]
    v_mfma_f32_16x16x32_bf16 v[124:127], v[172:175], v[212:215], v[124:127]
    v_mfma_f32_16x16x32_bf16 v[44:47], v[160:163], v[216:219], v[44:47]
    v_mfma_f32_16x16x32_bf16 v[72:75], v[164:167], v[216:219], v[72:75]
    v_mfma_f32_16x16x32_bf16 v[100:103], v[168:171], v[216:219], v[100:103]
    v_mfma_f32_16x16x32_bf16 v[128:131], v[172:175], v[216:219], v[128:131]
    v_mfma_f32_16x16x32_bf16 v[48:51], v[160:163], v[220:223], v[48:51]
    v_mfma_f32_16x16x32_bf16 v[76:79], v[164:167], v[220:223], v[76:79]
    v_mfma_f32_16x16x32_bf16 v[104:107], v[168:171], v[220:223], v[104:107]
    v_mfma_f32_16x16x32_bf16 v[132:135], v[172:175], v[220:223], v[132:135]
    v_mfma_f32_16x16x32_bf16 v[52:55], v[160:163], v[224:227], v[52:55]
    v_mfma_f32_16x16x32_bf16 v[80:83], v[164:167], v[224:227], v[80:83]
    v_mfma_f32_16x16x32_bf16 v[108:111], v[168:171], v[224:227], v[108:111]
    v_mfma_f32_16x16x32_bf16 v[136:139], v[172:175], v[224:227], v[136:139]
    v_mfma_f32_16x16x32_bf16 v[56:59], v[160:163], v[228:231], v[56:59]
    v_mfma_f32_16x16x32_bf16 v[84:87], v[164:167], v[228:231], v[84:87]
    v_mfma_f32_16x16x32_bf16 v[112:115], v[168:171], v[228:231], v[112:115]
    v_mfma_f32_16x16x32_bf16 v[140:143], v[172:175], v[228:231], v[140:143]
    s_lshl_b32 s26, s43, 2
    s_add_u32 s26, s26, s9
    s_mul_i32 s26, s26, 49
    s_add_u32 s26, s26, s48
    s_lshl_b32 s26, s26, 11
    s_add_u32 s26, s26, 3932160
    v_lshlrev_b32 v5, 4, v0
    v_cvt_pk_bf16_f32 v144, v32, v33
    v_cvt_pk_bf16_f32 v145, v34, v35
    v_cvt_pk_bf16_f32 v146, v60, v61
    v_cvt_pk_bf16_f32 v147, v62, v63
    s_add_u32 s27, s26, 0
    buffer_store_dwordx4 v[144:147], v5, s[4:7], s27 offen offset:0 sc1
    v_cvt_pk_bf16_f32 v148, v88, v89
    v_cvt_pk_bf16_f32 v149, v90, v91
    v_cvt_pk_bf16_f32 v150, v116, v117
    v_cvt_pk_bf16_f32 v151, v118, v119
    s_add_u32 s27, s26, 0
    buffer_store_dwordx4 v[148:151], v5, s[4:7], s27 offen offset:1024 sc1
    v_cvt_pk_bf16_f32 v152, v36, v37
    v_cvt_pk_bf16_f32 v153, v38, v39
    v_cvt_pk_bf16_f32 v154, v64, v65
    v_cvt_pk_bf16_f32 v155, v66, v67
    s_add_u32 s27, s26, 14336
    buffer_store_dwordx4 v[152:155], v5, s[4:7], s27 offen offset:0 sc1
    v_cvt_pk_bf16_f32 v156, v92, v93
    v_cvt_pk_bf16_f32 v157, v94, v95
    v_cvt_pk_bf16_f32 v158, v120, v121
    v_cvt_pk_bf16_f32 v159, v122, v123
    s_add_u32 s27, s26, 14336
    buffer_store_dwordx4 v[156:159], v5, s[4:7], s27 offen offset:1024 sc1
    v_cvt_pk_bf16_f32 v160, v40, v41
    v_cvt_pk_bf16_f32 v161, v42, v43
    v_cvt_pk_bf16_f32 v162, v68, v69
    v_cvt_pk_bf16_f32 v163, v70, v71
    s_add_u32 s27, s26, 28672
    buffer_store_dwordx4 v[160:163], v5, s[4:7], s27 offen offset:0 sc1
    v_cvt_pk_bf16_f32 v164, v96, v97
    v_cvt_pk_bf16_f32 v165, v98, v99
    v_cvt_pk_bf16_f32 v166, v124, v125
    v_cvt_pk_bf16_f32 v167, v126, v127
    s_add_u32 s27, s26, 28672
    buffer_store_dwordx4 v[164:167], v5, s[4:7], s27 offen offset:1024 sc1
    v_cvt_pk_bf16_f32 v168, v44, v45
    v_cvt_pk_bf16_f32 v169, v46, v47
    v_cvt_pk_bf16_f32 v170, v72, v73
    v_cvt_pk_bf16_f32 v171, v74, v75
    s_add_u32 s27, s26, 43008
    buffer_store_dwordx4 v[168:171], v5, s[4:7], s27 offen offset:0 sc1
    v_cvt_pk_bf16_f32 v172, v100, v101
    v_cvt_pk_bf16_f32 v173, v102, v103
    v_cvt_pk_bf16_f32 v174, v128, v129
    v_cvt_pk_bf16_f32 v175, v130, v131
    s_add_u32 s27, s26, 43008
    buffer_store_dwordx4 v[172:175], v5, s[4:7], s27 offen offset:1024 sc1
    v_cvt_pk_bf16_f32 v144, v48, v49
    v_cvt_pk_bf16_f32 v145, v50, v51
    v_cvt_pk_bf16_f32 v146, v76, v77
    v_cvt_pk_bf16_f32 v147, v78, v79
    s_add_u32 s27, s26, 57344
    buffer_store_dwordx4 v[144:147], v5, s[4:7], s27 offen offset:0 sc1
    v_cvt_pk_bf16_f32 v148, v104, v105
    v_cvt_pk_bf16_f32 v149, v106, v107
    v_cvt_pk_bf16_f32 v150, v132, v133
    v_cvt_pk_bf16_f32 v151, v134, v135
    s_add_u32 s27, s26, 57344
    buffer_store_dwordx4 v[148:151], v5, s[4:7], s27 offen offset:1024 sc1
    v_cvt_pk_bf16_f32 v152, v52, v53
    v_cvt_pk_bf16_f32 v153, v54, v55
    v_cvt_pk_bf16_f32 v154, v80, v81
    v_cvt_pk_bf16_f32 v155, v82, v83
    s_add_u32 s27, s26, 71680
    buffer_store_dwordx4 v[152:155], v5, s[4:7], s27 offen offset:0 sc1
    v_cvt_pk_bf16_f32 v156, v108, v109
    v_cvt_pk_bf16_f32 v157, v110, v111
    v_cvt_pk_bf16_f32 v158, v136, v137
    v_cvt_pk_bf16_f32 v159, v138, v139
    s_add_u32 s27, s26, 71680
    buffer_store_dwordx4 v[156:159], v5, s[4:7], s27 offen offset:1024 sc1
    v_cvt_pk_bf16_f32 v160, v56, v57
    v_cvt_pk_bf16_f32 v161, v58, v59
    v_cvt_pk_bf16_f32 v162, v84, v85
    v_cvt_pk_bf16_f32 v163, v86, v87
    s_add_u32 s27, s26, 86016
    buffer_store_dwordx4 v[160:163], v5, s[4:7], s27 offen offset:0 sc1
    v_cvt_pk_bf16_f32 v164, v112, v113
    v_cvt_pk_bf16_f32 v165, v114, v115
    v_cvt_pk_bf16_f32 v166, v140, v141
    v_cvt_pk_bf16_f32 v167, v142, v143
    s_add_u32 s27, s26, 86016
    buffer_store_dwordx4 v[164:167], v5, s[4:7], s27 offen offset:1024 sc1
    s_branch standalone__memory_aug_recurrent_mem_tr__prompt_kernel_prep_done
standalone__memory_aug_recurrent_mem_tr__prompt_kernel_cjob:
    s_mov_b32 s64, s36
    s_mov_b32 s65, s37
    s_mov_b32 s66, 3670016
    s_mov_b32 s67, 0x00020000
    s_mov_b32 s68, s38
    s_mov_b32 s69, s39
    s_mov_b32 s70, 3670016
    s_mov_b32 s71, 0x00020000
    v_lshlrev_b32 v6, 4, v0
    s_mul_i32 s52, s43, 229376
    s_mul_i32 s26, s9, 14336
    s_add_u32 s52, s52, s26
    s_mul_i32 s53, s9, 14592
    v_lshrrev_b32 v7, 2, v4
    v_lshl_add_u32 v7, v3, 3, v7
    v_mul_u32_u24 v7, 912, v7
    v_and_b32 v5, 3, v4
    v_lshl_add_u32 v7, v5, 3, v7
    s_mul_i32 s26, s9, 224
    s_add_u32 s26, s26, 8192
    v_add_u32 v11, s26, v7
    v_lshlrev_b32 v2, 13, v0
    s_lshl_b32 s26, s48, 19
    s_lshl_b32 s27, s43, 9
    s_add_u32 s26, s26, s27
    s_add_u32 s26, s26, 256
    s_cmp_eq_u32 s9, 0
    s_cbranch_scc0 standalone__memory_aug_recurrent_mem_tr__prompt_kernel_tc1
    buffer_load_dword v1, v2, s[64:67], s26 offen nt
    buffer_load_dword v1, v2, s[64:67], s26 offen offset:128 nt
standalone__memory_aug_recurrent_mem_tr__prompt_kernel_tc1:
    v_lshlrev_b32 v2, 7, v0
    s_mul_i32 s26, s43, 229376
    s_mul_i32 s27, s48, 16384
    s_add_u32 s26, s26, s27
    s_add_u32 s26, s26, 106496
    s_lshl_b32 s27, s9, 13
    s_add_u32 s26, s26, s27
    s_sub_u32 s27, s9, 1
    s_cmp_lt_u32 s27, 2
    s_cbranch_scc0 standalone__memory_aug_recurrent_mem_tr__prompt_kernel_tc2
    buffer_load_dword v1, v2, s[68:71], s26 offen nt
standalone__memory_aug_recurrent_mem_tr__prompt_kernel_tc2:
    s_add_u32 s26, s50, 0
    s_mov_b32 m0, s26
    s_add_u32 s27, s51, 0
    buffer_load_dwordx4 v8, s[64:67], s27 offen nt lds
    s_add_u32 s26, s50, 4096
    s_mov_b32 m0, s26
    s_add_u32 s27, s51, 262144
    buffer_load_dwordx4 v9, s[64:67], s27 offen nt lds
    s_mov_b32 s56, -1
    s_mov_b32 s57, 0x00ffffff
    s_mov_b64 exec, s[56:57]
    s_add_u32 s26, s53, 8192
    s_mov_b32 m0, s26
    s_add_u32 s27, s52, 0
    buffer_load_dwordx4 v6, s[68:71], s27 offen nt lds
    s_add_u32 s26, s53, 9104
    s_mov_b32 m0, s26
    s_add_u32 s27, s52, 896
    buffer_load_dwordx4 v6, s[68:71], s27 offen nt lds
    s_add_u32 s26, s53, 10016
    s_mov_b32 m0, s26
    s_add_u32 s27, s52, 1792
    buffer_load_dwordx4 v6, s[68:71], s27 offen nt lds
    s_add_u32 s26, s53, 10928
    s_mov_b32 m0, s26
    s_add_u32 s27, s52, 2688
    buffer_load_dwordx4 v6, s[68:71], s27 offen nt lds
    s_add_u32 s26, s53, 11840
    s_mov_b32 m0, s26
    s_add_u32 s27, s52, 3584
    buffer_load_dwordx4 v6, s[68:71], s27 offen nt lds
    s_add_u32 s26, s53, 12752
    s_mov_b32 m0, s26
    s_add_u32 s27, s52, 4480
    buffer_load_dwordx4 v6, s[68:71], s27 offen nt lds
    s_add_u32 s26, s53, 13664
    s_mov_b32 m0, s26
    s_add_u32 s27, s52, 5376
    buffer_load_dwordx4 v6, s[68:71], s27 offen nt lds
    s_add_u32 s26, s53, 14576
    s_mov_b32 m0, s26
    s_add_u32 s27, s52, 6272
    buffer_load_dwordx4 v6, s[68:71], s27 offen nt lds
    s_add_u32 s26, s53, 15488
    s_mov_b32 m0, s26
    s_add_u32 s27, s52, 7168
    buffer_load_dwordx4 v6, s[68:71], s27 offen nt lds
    s_add_u32 s26, s53, 16400
    s_mov_b32 m0, s26
    s_add_u32 s27, s52, 8064
    buffer_load_dwordx4 v6, s[68:71], s27 offen nt lds
    s_add_u32 s26, s53, 17312
    s_mov_b32 m0, s26
    s_add_u32 s27, s52, 8960
    buffer_load_dwordx4 v6, s[68:71], s27 offen nt lds
    s_add_u32 s26, s53, 18224
    s_mov_b32 m0, s26
    s_add_u32 s27, s52, 9856
    buffer_load_dwordx4 v6, s[68:71], s27 offen nt lds
    s_add_u32 s26, s53, 19136
    s_mov_b32 m0, s26
    s_add_u32 s27, s52, 10752
    buffer_load_dwordx4 v6, s[68:71], s27 offen nt lds
    s_add_u32 s26, s53, 20048
    s_mov_b32 m0, s26
    s_add_u32 s27, s52, 11648
    buffer_load_dwordx4 v6, s[68:71], s27 offen nt lds
    s_add_u32 s26, s53, 20960
    s_mov_b32 m0, s26
    s_add_u32 s27, s52, 12544
    buffer_load_dwordx4 v6, s[68:71], s27 offen nt lds
    s_add_u32 s26, s53, 21872
    s_mov_b32 m0, s26
    s_add_u32 s27, s52, 13440
    buffer_load_dwordx4 v6, s[68:71], s27 offen nt lds
    s_mov_b64 exec, -1
    s_add_u32 s26, s50, 69632
    s_mov_b32 m0, s26
    s_add_u32 s27, s51, 128
    buffer_load_dwordx4 v8, s[64:67], s27 offen nt lds
    s_add_u32 s26, s50, 73728
    s_mov_b32 m0, s26
    s_add_u32 s27, s51, 262272
    buffer_load_dwordx4 v9, s[64:67], s27 offen nt lds
    s_mov_b32 s56, -1
    s_mov_b32 s57, 0x00ffffff
    s_mov_b64 exec, s[56:57]
    s_add_u32 s26, s53, 77824
    s_mov_b32 m0, s26
    s_add_u32 s27, s52, 57344
    buffer_load_dwordx4 v6, s[68:71], s27 offen nt lds
    s_add_u32 s26, s53, 78736
    s_mov_b32 m0, s26
    s_add_u32 s27, s52, 58240
    buffer_load_dwordx4 v6, s[68:71], s27 offen nt lds
    s_add_u32 s26, s53, 79648
    s_mov_b32 m0, s26
    s_add_u32 s27, s52, 59136
    buffer_load_dwordx4 v6, s[68:71], s27 offen nt lds
    s_add_u32 s26, s53, 80560
    s_mov_b32 m0, s26
    s_add_u32 s27, s52, 60032
    buffer_load_dwordx4 v6, s[68:71], s27 offen nt lds
    s_add_u32 s26, s53, 81472
    s_mov_b32 m0, s26
    s_add_u32 s27, s52, 60928
    buffer_load_dwordx4 v6, s[68:71], s27 offen nt lds
    s_add_u32 s26, s53, 82384
    s_mov_b32 m0, s26
    s_add_u32 s27, s52, 61824
    buffer_load_dwordx4 v6, s[68:71], s27 offen nt lds
    s_add_u32 s26, s53, 83296
    s_mov_b32 m0, s26
    s_add_u32 s27, s52, 62720
    buffer_load_dwordx4 v6, s[68:71], s27 offen nt lds
    s_add_u32 s26, s53, 84208
    s_mov_b32 m0, s26
    s_add_u32 s27, s52, 63616
    buffer_load_dwordx4 v6, s[68:71], s27 offen nt lds
    s_add_u32 s26, s53, 85120
    s_mov_b32 m0, s26
    s_add_u32 s27, s52, 64512
    buffer_load_dwordx4 v6, s[68:71], s27 offen nt lds
    s_add_u32 s26, s53, 86032
    s_mov_b32 m0, s26
    s_add_u32 s27, s52, 65408
    buffer_load_dwordx4 v6, s[68:71], s27 offen nt lds
    s_add_u32 s26, s53, 86944
    s_mov_b32 m0, s26
    s_add_u32 s27, s52, 66304
    buffer_load_dwordx4 v6, s[68:71], s27 offen nt lds
    s_add_u32 s26, s53, 87856
    s_mov_b32 m0, s26
    s_add_u32 s27, s52, 67200
    buffer_load_dwordx4 v6, s[68:71], s27 offen nt lds
    s_add_u32 s26, s53, 88768
    s_mov_b32 m0, s26
    s_add_u32 s27, s52, 68096
    buffer_load_dwordx4 v6, s[68:71], s27 offen nt lds
    s_add_u32 s26, s53, 89680
    s_mov_b32 m0, s26
    s_add_u32 s27, s52, 68992
    buffer_load_dwordx4 v6, s[68:71], s27 offen nt lds
    s_add_u32 s26, s53, 90592
    s_mov_b32 m0, s26
    s_add_u32 s27, s52, 69888
    buffer_load_dwordx4 v6, s[68:71], s27 offen nt lds
    s_add_u32 s26, s53, 91504
    s_mov_b32 m0, s26
    s_add_u32 s27, s52, 70784
    buffer_load_dwordx4 v6, s[68:71], s27 offen nt lds
    s_mov_b64 exec, -1
    s_cmp_lg_u32 s9, 0
    s_cbranch_scc1 standalone__memory_aug_recurrent_mem_tr__prompt_kernel_registered2
    s_mov_b64 exec, 1
    s_cmp_lg_u32 s2, 0
    s_cbranch_scc1 standalone__memory_aug_recurrent_mem_tr__prompt_kernel_notag2
    s_memrealtime s[26:27]
    s_waitcnt lgkmcnt(0)
    s_andn2_b32 s26, s26, 15
    s_or_b32 s26, s26, 8
    s_or_b32 s26, s26, s3
    v_mov_b32 v250, s26
    v_mov_b32 v251, 32
    buffer_store_dword v250, v251, s[12:15], 0 offen sc1
    s_nop 1
standalone__memory_aug_recurrent_mem_tr__prompt_kernel_notag2:
    s_lshl_b32 s26, s3, 2
    v_mov_b32 v250, 1
    v_mov_b32 v251, s26
    buffer_atomic_add v250, v251, s[12:15], 0 offen sc0
    s_mov_b64 exec, -1
standalone__memory_aug_recurrent_mem_tr__prompt_kernel_registered2:
    s_waitcnt vmcnt(18)
    s_barrier
    ds_read_b128 v[144:147], v10 offset:0
    ds_read_b128 v[148:151], v10 offset:576
    ds_read_b128 v[152:155], v10 offset:4160
    ds_read_b128 v[156:159], v10 offset:4608
    ds_read_b64_tr_b16 v[176:177], v11 offset:0
    ds_read_b64_tr_b16 v[178:179], v11 offset:3648
    ds_read_b64_tr_b16 v[180:181], v11 offset:32
    ds_read_b64_tr_b16 v[182:183], v11 offset:3680
    ds_read_b64_tr_b16 v[184:185], v11 offset:64
    ds_read_b64_tr_b16 v[186:187], v11 offset:3712
    ds_read_b64_tr_b16 v[188:189], v11 offset:96
    ds_read_b64_tr_b16 v[190:191], v11 offset:3744
    ds_read_b64_tr_b16 v[192:193], v11 offset:128
    ds_read_b64_tr_b16 v[194:195], v11 offset:3776
    ds_read_b64_tr_b16 v[196:197], v11 offset:160
    ds_read_b64_tr_b16 v[198:199], v11 offset:3808
    ds_read_b64_tr_b16 v[200:201], v11 offset:192
    ds_read_b64_tr_b16 v[202:203], v11 offset:3840
    ds_read_b128 v[160:163], v10 offset:64
    ds_read_b128 v[164:167], v10 offset:512
    ds_read_b128 v[168:171], v10 offset:4096
    ds_read_b128 v[172:175], v10 offset:4672
    ds_read_b64_tr_b16 v[204:205], v11 offset:29184
    ds_read_b64_tr_b16 v[206:207], v11 offset:32832
    ds_read_b64_tr_b16 v[208:209], v11 offset:29216
    ds_read_b64_tr_b16 v[210:211], v11 offset:32864
    ds_read_b64_tr_b16 v[212:213], v11 offset:29248
    ds_read_b64_tr_b16 v[214:215], v11 offset:32896
    ds_read_b64_tr_b16 v[216:217], v11 offset:29280
    ds_read_b64_tr_b16 v[218:219], v11 offset:32928
    ds_read_b64_tr_b16 v[220:221], v11 offset:29312
    ds_read_b64_tr_b16 v[222:223], v11 offset:32960
    ds_read_b64_tr_b16 v[224:225], v11 offset:29344
    ds_read_b64_tr_b16 v[226:227], v11 offset:32992
    ds_read_b64_tr_b16 v[228:229], v11 offset:29376
    ds_read_b64_tr_b16 v[230:231], v11 offset:33024
    s_waitcnt lgkmcnt(15)
    v_mfma_f32_16x16x32_bf16 v[32:35], v[144:147], v[176:179], 0
    v_mfma_f32_16x16x32_bf16 v[60:63], v[148:151], v[176:179], 0
    v_mfma_f32_16x16x32_bf16 v[88:91], v[152:155], v[176:179], 0
    v_mfma_f32_16x16x32_bf16 v[116:119], v[156:159], v[176:179], 0
    v_mfma_f32_16x16x32_bf16 v[36:39], v[144:147], v[180:183], 0
    v_mfma_f32_16x16x32_bf16 v[64:67], v[148:151], v[180:183], 0
    v_mfma_f32_16x16x32_bf16 v[92:95], v[152:155], v[180:183], 0
    v_mfma_f32_16x16x32_bf16 v[120:123], v[156:159], v[180:183], 0
    v_mfma_f32_16x16x32_bf16 v[40:43], v[144:147], v[184:187], 0
    v_mfma_f32_16x16x32_bf16 v[68:71], v[148:151], v[184:187], 0
    v_mfma_f32_16x16x32_bf16 v[96:99], v[152:155], v[184:187], 0
    v_mfma_f32_16x16x32_bf16 v[124:127], v[156:159], v[184:187], 0
    v_mfma_f32_16x16x32_bf16 v[44:47], v[144:147], v[188:191], 0
    v_mfma_f32_16x16x32_bf16 v[72:75], v[148:151], v[188:191], 0
    v_mfma_f32_16x16x32_bf16 v[100:103], v[152:155], v[188:191], 0
    v_mfma_f32_16x16x32_bf16 v[128:131], v[156:159], v[188:191], 0
    v_mfma_f32_16x16x32_bf16 v[48:51], v[144:147], v[192:195], 0
    v_mfma_f32_16x16x32_bf16 v[76:79], v[148:151], v[192:195], 0
    v_mfma_f32_16x16x32_bf16 v[104:107], v[152:155], v[192:195], 0
    v_mfma_f32_16x16x32_bf16 v[132:135], v[156:159], v[192:195], 0
    v_mfma_f32_16x16x32_bf16 v[52:55], v[144:147], v[196:199], 0
    v_mfma_f32_16x16x32_bf16 v[80:83], v[148:151], v[196:199], 0
    v_mfma_f32_16x16x32_bf16 v[108:111], v[152:155], v[196:199], 0
    v_mfma_f32_16x16x32_bf16 v[136:139], v[156:159], v[196:199], 0
    v_mfma_f32_16x16x32_bf16 v[56:59], v[144:147], v[200:203], 0
    v_mfma_f32_16x16x32_bf16 v[84:87], v[148:151], v[200:203], 0
    v_mfma_f32_16x16x32_bf16 v[112:115], v[152:155], v[200:203], 0
    v_mfma_f32_16x16x32_bf16 v[140:143], v[156:159], v[200:203], 0
    s_waitcnt lgkmcnt(0)
    v_mfma_f32_16x16x32_bf16 v[32:35], v[160:163], v[204:207], v[32:35]
    v_mfma_f32_16x16x32_bf16 v[60:63], v[164:167], v[204:207], v[60:63]
    v_mfma_f32_16x16x32_bf16 v[88:91], v[168:171], v[204:207], v[88:91]
    v_mfma_f32_16x16x32_bf16 v[116:119], v[172:175], v[204:207], v[116:119]
    v_mfma_f32_16x16x32_bf16 v[36:39], v[160:163], v[208:211], v[36:39]
    v_mfma_f32_16x16x32_bf16 v[64:67], v[164:167], v[208:211], v[64:67]
    v_mfma_f32_16x16x32_bf16 v[92:95], v[168:171], v[208:211], v[92:95]
    v_mfma_f32_16x16x32_bf16 v[120:123], v[172:175], v[208:211], v[120:123]
    v_mfma_f32_16x16x32_bf16 v[40:43], v[160:163], v[212:215], v[40:43]
    v_mfma_f32_16x16x32_bf16 v[68:71], v[164:167], v[212:215], v[68:71]
    v_mfma_f32_16x16x32_bf16 v[96:99], v[168:171], v[212:215], v[96:99]
    v_mfma_f32_16x16x32_bf16 v[124:127], v[172:175], v[212:215], v[124:127]
    v_mfma_f32_16x16x32_bf16 v[44:47], v[160:163], v[216:219], v[44:47]
    v_mfma_f32_16x16x32_bf16 v[72:75], v[164:167], v[216:219], v[72:75]
    v_mfma_f32_16x16x32_bf16 v[100:103], v[168:171], v[216:219], v[100:103]
    v_mfma_f32_16x16x32_bf16 v[128:131], v[172:175], v[216:219], v[128:131]
    v_mfma_f32_16x16x32_bf16 v[48:51], v[160:163], v[220:223], v[48:51]
    v_mfma_f32_16x16x32_bf16 v[76:79], v[164:167], v[220:223], v[76:79]
    v_mfma_f32_16x16x32_bf16 v[104:107], v[168:171], v[220:223], v[104:107]
    v_mfma_f32_16x16x32_bf16 v[132:135], v[172:175], v[220:223], v[132:135]
    v_mfma_f32_16x16x32_bf16 v[52:55], v[160:163], v[224:227], v[52:55]
    v_mfma_f32_16x16x32_bf16 v[80:83], v[164:167], v[224:227], v[80:83]
    v_mfma_f32_16x16x32_bf16 v[108:111], v[168:171], v[224:227], v[108:111]
    v_mfma_f32_16x16x32_bf16 v[136:139], v[172:175], v[224:227], v[136:139]
    v_mfma_f32_16x16x32_bf16 v[56:59], v[160:163], v[228:231], v[56:59]
    v_mfma_f32_16x16x32_bf16 v[84:87], v[164:167], v[228:231], v[84:87]
    v_mfma_f32_16x16x32_bf16 v[112:115], v[168:171], v[228:231], v[112:115]
    v_mfma_f32_16x16x32_bf16 v[140:143], v[172:175], v[228:231], v[140:143]
    v_add_u32 v10, 69632, v10
    v_add_u32 v11, 69632, v11
    s_barrier
    s_add_u32 s26, s50, 0
    s_mov_b32 m0, s26
    s_add_u32 s27, s51, 256
    buffer_load_dwordx4 v8, s[64:67], s27 offen nt lds
    s_add_u32 s26, s50, 4096
    s_mov_b32 m0, s26
    s_add_u32 s27, s51, 262400
    buffer_load_dwordx4 v9, s[64:67], s27 offen nt lds
    s_mov_b32 s56, -1
    s_mov_b32 s57, 0x00ffffff
    s_mov_b64 exec, s[56:57]
    s_add_u32 s26, s53, 8192
    s_mov_b32 m0, s26
    s_add_u32 s27, s52, 114688
    buffer_load_dwordx4 v6, s[68:71], s27 offen nt lds
    s_add_u32 s26, s53, 9104
    s_mov_b32 m0, s26
    s_add_u32 s27, s52, 115584
    buffer_load_dwordx4 v6, s[68:71], s27 offen nt lds
    s_add_u32 s26, s53, 10016
    s_mov_b32 m0, s26
    s_add_u32 s27, s52, 116480
    buffer_load_dwordx4 v6, s[68:71], s27 offen nt lds
    s_add_u32 s26, s53, 10928
    s_mov_b32 m0, s26
    s_add_u32 s27, s52, 117376
    buffer_load_dwordx4 v6, s[68:71], s27 offen nt lds
    s_add_u32 s26, s53, 11840
    s_mov_b32 m0, s26
    s_add_u32 s27, s52, 118272
    buffer_load_dwordx4 v6, s[68:71], s27 offen nt lds
    s_add_u32 s26, s53, 12752
    s_mov_b32 m0, s26
    s_add_u32 s27, s52, 119168
    buffer_load_dwordx4 v6, s[68:71], s27 offen nt lds
    s_add_u32 s26, s53, 13664
    s_mov_b32 m0, s26
    s_add_u32 s27, s52, 120064
    buffer_load_dwordx4 v6, s[68:71], s27 offen nt lds
    s_add_u32 s26, s53, 14576
    s_mov_b32 m0, s26
    s_add_u32 s27, s52, 120960
    buffer_load_dwordx4 v6, s[68:71], s27 offen nt lds
    s_add_u32 s26, s53, 15488
    s_mov_b32 m0, s26
    s_add_u32 s27, s52, 121856
    buffer_load_dwordx4 v6, s[68:71], s27 offen nt lds
    s_add_u32 s26, s53, 16400
    s_mov_b32 m0, s26
    s_add_u32 s27, s52, 122752
    buffer_load_dwordx4 v6, s[68:71], s27 offen nt lds
    s_add_u32 s26, s53, 17312
    s_mov_b32 m0, s26
    s_add_u32 s27, s52, 123648
    buffer_load_dwordx4 v6, s[68:71], s27 offen nt lds
    s_add_u32 s26, s53, 18224
    s_mov_b32 m0, s26
    s_add_u32 s27, s52, 124544
    buffer_load_dwordx4 v6, s[68:71], s27 offen nt lds
    s_add_u32 s26, s53, 19136
    s_mov_b32 m0, s26
    s_add_u32 s27, s52, 125440
    buffer_load_dwordx4 v6, s[68:71], s27 offen nt lds
    s_add_u32 s26, s53, 20048
    s_mov_b32 m0, s26
    s_add_u32 s27, s52, 126336
    buffer_load_dwordx4 v6, s[68:71], s27 offen nt lds
    s_add_u32 s26, s53, 20960
    s_mov_b32 m0, s26
    s_add_u32 s27, s52, 127232
    buffer_load_dwordx4 v6, s[68:71], s27 offen nt lds
    s_add_u32 s26, s53, 21872
    s_mov_b32 m0, s26
    s_add_u32 s27, s52, 128128
    buffer_load_dwordx4 v6, s[68:71], s27 offen nt lds
    s_mov_b64 exec, -1
    s_waitcnt vmcnt(18)
    s_barrier
    ds_read_b128 v[144:147], v10 offset:0
    ds_read_b128 v[148:151], v10 offset:576
    ds_read_b128 v[152:155], v10 offset:4160
    ds_read_b128 v[156:159], v10 offset:4608
    ds_read_b64_tr_b16 v[176:177], v11 offset:0
    ds_read_b64_tr_b16 v[178:179], v11 offset:3648
    ds_read_b64_tr_b16 v[180:181], v11 offset:32
    ds_read_b64_tr_b16 v[182:183], v11 offset:3680
    ds_read_b64_tr_b16 v[184:185], v11 offset:64
    ds_read_b64_tr_b16 v[186:187], v11 offset:3712
    ds_read_b64_tr_b16 v[188:189], v11 offset:96
    ds_read_b64_tr_b16 v[190:191], v11 offset:3744
    ds_read_b64_tr_b16 v[192:193], v11 offset:128
    ds_read_b64_tr_b16 v[194:195], v11 offset:3776
    ds_read_b64_tr_b16 v[196:197], v11 offset:160
    ds_read_b64_tr_b16 v[198:199], v11 offset:3808
    ds_read_b64_tr_b16 v[200:201], v11 offset:192
    ds_read_b64_tr_b16 v[202:203], v11 offset:3840
    ds_read_b128 v[160:163], v10 offset:64
    ds_read_b128 v[164:167], v10 offset:512
    ds_read_b128 v[168:171], v10 offset:4096
    ds_read_b128 v[172:175], v10 offset:4672
    ds_read_b64_tr_b16 v[204:205], v11 offset:29184
    ds_read_b64_tr_b16 v[206:207], v11 offset:32832
    ds_read_b64_tr_b16 v[208:209], v11 offset:29216
    ds_read_b64_tr_b16 v[210:211], v11 offset:32864
    ds_read_b64_tr_b16 v[212:213], v11 offset:29248
    ds_read_b64_tr_b16 v[214:215], v11 offset:32896
    ds_read_b64_tr_b16 v[216:217], v11 offset:29280
    ds_read_b64_tr_b16 v[218:219], v11 offset:32928
    ds_read_b64_tr_b16 v[220:221], v11 offset:29312
    ds_read_b64_tr_b16 v[222:223], v11 offset:32960
    ds_read_b64_tr_b16 v[224:225], v11 offset:29344
    ds_read_b64_tr_b16 v[226:227], v11 offset:32992
    ds_read_b64_tr_b16 v[228:229], v11 offset:29376
    ds_read_b64_tr_b16 v[230:231], v11 offset:33024
    s_waitcnt lgkmcnt(15)
    v_mfma_f32_16x16x32_bf16 v[32:35], v[144:147], v[176:179], v[32:35]
    v_mfma_f32_16x16x32_bf16 v[60:63], v[148:151], v[176:179], v[60:63]
    v_mfma_f32_16x16x32_bf16 v[88:91], v[152:155], v[176:179], v[88:91]
    v_mfma_f32_16x16x32_bf16 v[116:119], v[156:159], v[176:179], v[116:119]
    v_mfma_f32_16x16x32_bf16 v[36:39], v[144:147], v[180:183], v[36:39]
    v_mfma_f32_16x16x32_bf16 v[64:67], v[148:151], v[180:183], v[64:67]
    v_mfma_f32_16x16x32_bf16 v[92:95], v[152:155], v[180:183], v[92:95]
    v_mfma_f32_16x16x32_bf16 v[120:123], v[156:159], v[180:183], v[120:123]
    v_mfma_f32_16x16x32_bf16 v[40:43], v[144:147], v[184:187], v[40:43]
    v_mfma_f32_16x16x32_bf16 v[68:71], v[148:151], v[184:187], v[68:71]
    v_mfma_f32_16x16x32_bf16 v[96:99], v[152:155], v[184:187], v[96:99]
    v_mfma_f32_16x16x32_bf16 v[124:127], v[156:159], v[184:187], v[124:127]
    v_mfma_f32_16x16x32_bf16 v[44:47], v[144:147], v[188:191], v[44:47]
    v_mfma_f32_16x16x32_bf16 v[72:75], v[148:151], v[188:191], v[72:75]
    v_mfma_f32_16x16x32_bf16 v[100:103], v[152:155], v[188:191], v[100:103]
    v_mfma_f32_16x16x32_bf16 v[128:131], v[156:159], v[188:191], v[128:131]
    v_mfma_f32_16x16x32_bf16 v[48:51], v[144:147], v[192:195], v[48:51]
    v_mfma_f32_16x16x32_bf16 v[76:79], v[148:151], v[192:195], v[76:79]
    v_mfma_f32_16x16x32_bf16 v[104:107], v[152:155], v[192:195], v[104:107]
    v_mfma_f32_16x16x32_bf16 v[132:135], v[156:159], v[192:195], v[132:135]
    v_mfma_f32_16x16x32_bf16 v[52:55], v[144:147], v[196:199], v[52:55]
    v_mfma_f32_16x16x32_bf16 v[80:83], v[148:151], v[196:199], v[80:83]
    v_mfma_f32_16x16x32_bf16 v[108:111], v[152:155], v[196:199], v[108:111]
    v_mfma_f32_16x16x32_bf16 v[136:139], v[156:159], v[196:199], v[136:139]
    v_mfma_f32_16x16x32_bf16 v[56:59], v[144:147], v[200:203], v[56:59]
    v_mfma_f32_16x16x32_bf16 v[84:87], v[148:151], v[200:203], v[84:87]
    v_mfma_f32_16x16x32_bf16 v[112:115], v[152:155], v[200:203], v[112:115]
    v_mfma_f32_16x16x32_bf16 v[140:143], v[156:159], v[200:203], v[140:143]
    s_waitcnt lgkmcnt(0)
    v_mfma_f32_16x16x32_bf16 v[32:35], v[160:163], v[204:207], v[32:35]
    v_mfma_f32_16x16x32_bf16 v[60:63], v[164:167], v[204:207], v[60:63]
    v_mfma_f32_16x16x32_bf16 v[88:91], v[168:171], v[204:207], v[88:91]
    v_mfma_f32_16x16x32_bf16 v[116:119], v[172:175], v[204:207], v[116:119]
    v_mfma_f32_16x16x32_bf16 v[36:39], v[160:163], v[208:211], v[36:39]
    v_mfma_f32_16x16x32_bf16 v[64:67], v[164:167], v[208:211], v[64:67]
    v_mfma_f32_16x16x32_bf16 v[92:95], v[168:171], v[208:211], v[92:95]
    v_mfma_f32_16x16x32_bf16 v[120:123], v[172:175], v[208:211], v[120:123]
    v_mfma_f32_16x16x32_bf16 v[40:43], v[160:163], v[212:215], v[40:43]
    v_mfma_f32_16x16x32_bf16 v[68:71], v[164:167], v[212:215], v[68:71]
    v_mfma_f32_16x16x32_bf16 v[96:99], v[168:171], v[212:215], v[96:99]
    v_mfma_f32_16x16x32_bf16 v[124:127], v[172:175], v[212:215], v[124:127]
    v_mfma_f32_16x16x32_bf16 v[44:47], v[160:163], v[216:219], v[44:47]
    v_mfma_f32_16x16x32_bf16 v[72:75], v[164:167], v[216:219], v[72:75]
    v_mfma_f32_16x16x32_bf16 v[100:103], v[168:171], v[216:219], v[100:103]
    v_mfma_f32_16x16x32_bf16 v[128:131], v[172:175], v[216:219], v[128:131]
    v_mfma_f32_16x16x32_bf16 v[48:51], v[160:163], v[220:223], v[48:51]
    v_mfma_f32_16x16x32_bf16 v[76:79], v[164:167], v[220:223], v[76:79]
    v_mfma_f32_16x16x32_bf16 v[104:107], v[168:171], v[220:223], v[104:107]
    v_mfma_f32_16x16x32_bf16 v[132:135], v[172:175], v[220:223], v[132:135]
    v_mfma_f32_16x16x32_bf16 v[52:55], v[160:163], v[224:227], v[52:55]
    v_mfma_f32_16x16x32_bf16 v[80:83], v[164:167], v[224:227], v[80:83]
    v_mfma_f32_16x16x32_bf16 v[108:111], v[168:171], v[224:227], v[108:111]
    v_mfma_f32_16x16x32_bf16 v[136:139], v[172:175], v[224:227], v[136:139]
    v_mfma_f32_16x16x32_bf16 v[56:59], v[160:163], v[228:231], v[56:59]
    v_mfma_f32_16x16x32_bf16 v[84:87], v[164:167], v[228:231], v[84:87]
    v_mfma_f32_16x16x32_bf16 v[112:115], v[168:171], v[228:231], v[112:115]
    v_mfma_f32_16x16x32_bf16 v[140:143], v[172:175], v[228:231], v[140:143]
    v_add_u32 v10, 4294897664, v10
    v_add_u32 v11, 4294897664, v11
    s_barrier
    s_add_u32 s26, s50, 69632
    s_mov_b32 m0, s26
    s_add_u32 s27, s51, 384
    buffer_load_dwordx4 v8, s[64:67], s27 offen nt lds
    s_add_u32 s26, s50, 73728
    s_mov_b32 m0, s26
    s_add_u32 s27, s51, 262528
    buffer_load_dwordx4 v9, s[64:67], s27 offen nt lds
    s_mov_b32 s56, -1
    s_mov_b32 s57, 0x00ffffff
    s_mov_b64 exec, s[56:57]
    s_add_u32 s26, s53, 77824
    s_mov_b32 m0, s26
    s_add_u32 s27, s52, 172032
    buffer_load_dwordx4 v6, s[68:71], s27 offen nt lds
    s_add_u32 s26, s53, 78736
    s_mov_b32 m0, s26
    s_add_u32 s27, s52, 172928
    buffer_load_dwordx4 v6, s[68:71], s27 offen nt lds
    s_add_u32 s26, s53, 79648
    s_mov_b32 m0, s26
    s_add_u32 s27, s52, 173824
    buffer_load_dwordx4 v6, s[68:71], s27 offen nt lds
    s_add_u32 s26, s53, 80560
    s_mov_b32 m0, s26
    s_add_u32 s27, s52, 174720
    buffer_load_dwordx4 v6, s[68:71], s27 offen nt lds
    s_add_u32 s26, s53, 81472
    s_mov_b32 m0, s26
    s_add_u32 s27, s52, 175616
    buffer_load_dwordx4 v6, s[68:71], s27 offen nt lds
    s_add_u32 s26, s53, 82384
    s_mov_b32 m0, s26
    s_add_u32 s27, s52, 176512
    buffer_load_dwordx4 v6, s[68:71], s27 offen nt lds
    s_add_u32 s26, s53, 83296
    s_mov_b32 m0, s26
    s_add_u32 s27, s52, 177408
    buffer_load_dwordx4 v6, s[68:71], s27 offen nt lds
    s_add_u32 s26, s53, 84208
    s_mov_b32 m0, s26
    s_add_u32 s27, s52, 178304
    buffer_load_dwordx4 v6, s[68:71], s27 offen nt lds
    s_add_u32 s26, s53, 85120
    s_mov_b32 m0, s26
    s_add_u32 s27, s52, 179200
    buffer_load_dwordx4 v6, s[68:71], s27 offen nt lds
    s_add_u32 s26, s53, 86032
    s_mov_b32 m0, s26
    s_add_u32 s27, s52, 180096
    buffer_load_dwordx4 v6, s[68:71], s27 offen nt lds
    s_add_u32 s26, s53, 86944
    s_mov_b32 m0, s26
    s_add_u32 s27, s52, 180992
    buffer_load_dwordx4 v6, s[68:71], s27 offen nt lds
    s_add_u32 s26, s53, 87856
    s_mov_b32 m0, s26
    s_add_u32 s27, s52, 181888
    buffer_load_dwordx4 v6, s[68:71], s27 offen nt lds
    s_add_u32 s26, s53, 88768
    s_mov_b32 m0, s26
    s_add_u32 s27, s52, 182784
    buffer_load_dwordx4 v6, s[68:71], s27 offen nt lds
    s_add_u32 s26, s53, 89680
    s_mov_b32 m0, s26
    s_add_u32 s27, s52, 183680
    buffer_load_dwordx4 v6, s[68:71], s27 offen nt lds
    s_add_u32 s26, s53, 90592
    s_mov_b32 m0, s26
    s_add_u32 s27, s52, 184576
    buffer_load_dwordx4 v6, s[68:71], s27 offen nt lds
    s_add_u32 s26, s53, 91504
    s_mov_b32 m0, s26
    s_add_u32 s27, s52, 185472
    buffer_load_dwordx4 v6, s[68:71], s27 offen nt lds
    s_mov_b64 exec, -1
    v_lshlrev_b32 v253, 2, v0
    buffer_load_dword v252, v253, s[12:15], 0 offen sc1
    s_waitcnt vmcnt(18)
    s_barrier
    ds_read_b128 v[144:147], v10 offset:0
    ds_read_b128 v[148:151], v10 offset:576
    ds_read_b128 v[152:155], v10 offset:4160
    ds_read_b128 v[156:159], v10 offset:4608
    ds_read_b64_tr_b16 v[176:177], v11 offset:0
    ds_read_b64_tr_b16 v[178:179], v11 offset:3648
    ds_read_b64_tr_b16 v[180:181], v11 offset:32
    ds_read_b64_tr_b16 v[182:183], v11 offset:3680
    ds_read_b64_tr_b16 v[184:185], v11 offset:64
    ds_read_b64_tr_b16 v[186:187], v11 offset:3712
    ds_read_b64_tr_b16 v[188:189], v11 offset:96
    ds_read_b64_tr_b16 v[190:191], v11 offset:3744
    ds_read_b64_tr_b16 v[192:193], v11 offset:128
    ds_read_b64_tr_b16 v[194:195], v11 offset:3776
    ds_read_b64_tr_b16 v[196:197], v11 offset:160
    ds_read_b64_tr_b16 v[198:199], v11 offset:3808
    ds_read_b64_tr_b16 v[200:201], v11 offset:192
    ds_read_b64_tr_b16 v[202:203], v11 offset:3840
    ds_read_b128 v[160:163], v10 offset:64
    ds_read_b128 v[164:167], v10 offset:512
    ds_read_b128 v[168:171], v10 offset:4096
    ds_read_b128 v[172:175], v10 offset:4672
    ds_read_b64_tr_b16 v[204:205], v11 offset:29184
    ds_read_b64_tr_b16 v[206:207], v11 offset:32832
    ds_read_b64_tr_b16 v[208:209], v11 offset:29216
    ds_read_b64_tr_b16 v[210:211], v11 offset:32864
    ds_read_b64_tr_b16 v[212:213], v11 offset:29248
    ds_read_b64_tr_b16 v[214:215], v11 offset:32896
    ds_read_b64_tr_b16 v[216:217], v11 offset:29280
    ds_read_b64_tr_b16 v[218:219], v11 offset:32928
    ds_read_b64_tr_b16 v[220:221], v11 offset:29312
    ds_read_b64_tr_b16 v[222:223], v11 offset:32960
    ds_read_b64_tr_b16 v[224:225], v11 offset:29344
    ds_read_b64_tr_b16 v[226:227], v11 offset:32992
    ds_read_b64_tr_b16 v[228:229], v11 offset:29376
    ds_read_b64_tr_b16 v[230:231], v11 offset:33024
    s_waitcnt lgkmcnt(15)
    v_mfma_f32_16x16x32_bf16 v[32:35], v[144:147], v[176:179], v[32:35]
    v_mfma_f32_16x16x32_bf16 v[60:63], v[148:151], v[176:179], v[60:63]
    v_mfma_f32_16x16x32_bf16 v[88:91], v[152:155], v[176:179], v[88:91]
    v_mfma_f32_16x16x32_bf16 v[116:119], v[156:159], v[176:179], v[116:119]
    v_mfma_f32_16x16x32_bf16 v[36:39], v[144:147], v[180:183], v[36:39]
    v_mfma_f32_16x16x32_bf16 v[64:67], v[148:151], v[180:183], v[64:67]
    v_mfma_f32_16x16x32_bf16 v[92:95], v[152:155], v[180:183], v[92:95]
    v_mfma_f32_16x16x32_bf16 v[120:123], v[156:159], v[180:183], v[120:123]
    v_mfma_f32_16x16x32_bf16 v[40:43], v[144:147], v[184:187], v[40:43]
    v_mfma_f32_16x16x32_bf16 v[68:71], v[148:151], v[184:187], v[68:71]
    v_mfma_f32_16x16x32_bf16 v[96:99], v[152:155], v[184:187], v[96:99]
    v_mfma_f32_16x16x32_bf16 v[124:127], v[156:159], v[184:187], v[124:127]
    v_mfma_f32_16x16x32_bf16 v[44:47], v[144:147], v[188:191], v[44:47]
    v_mfma_f32_16x16x32_bf16 v[72:75], v[148:151], v[188:191], v[72:75]
    v_mfma_f32_16x16x32_bf16 v[100:103], v[152:155], v[188:191], v[100:103]
    v_mfma_f32_16x16x32_bf16 v[128:131], v[156:159], v[188:191], v[128:131]
    v_mfma_f32_16x16x32_bf16 v[48:51], v[144:147], v[192:195], v[48:51]
    v_mfma_f32_16x16x32_bf16 v[76:79], v[148:151], v[192:195], v[76:79]
    v_mfma_f32_16x16x32_bf16 v[104:107], v[152:155], v[192:195], v[104:107]
    v_mfma_f32_16x16x32_bf16 v[132:135], v[156:159], v[192:195], v[132:135]
    v_mfma_f32_16x16x32_bf16 v[52:55], v[144:147], v[196:199], v[52:55]
    v_mfma_f32_16x16x32_bf16 v[80:83], v[148:151], v[196:199], v[80:83]
    v_mfma_f32_16x16x32_bf16 v[108:111], v[152:155], v[196:199], v[108:111]
    v_mfma_f32_16x16x32_bf16 v[136:139], v[156:159], v[196:199], v[136:139]
    v_mfma_f32_16x16x32_bf16 v[56:59], v[144:147], v[200:203], v[56:59]
    v_mfma_f32_16x16x32_bf16 v[84:87], v[148:151], v[200:203], v[84:87]
    v_mfma_f32_16x16x32_bf16 v[112:115], v[152:155], v[200:203], v[112:115]
    v_mfma_f32_16x16x32_bf16 v[140:143], v[156:159], v[200:203], v[140:143]
    s_waitcnt lgkmcnt(0)
    v_mfma_f32_16x16x32_bf16 v[32:35], v[160:163], v[204:207], v[32:35]
    v_mfma_f32_16x16x32_bf16 v[60:63], v[164:167], v[204:207], v[60:63]
    v_mfma_f32_16x16x32_bf16 v[88:91], v[168:171], v[204:207], v[88:91]
    v_mfma_f32_16x16x32_bf16 v[116:119], v[172:175], v[204:207], v[116:119]
    v_mfma_f32_16x16x32_bf16 v[36:39], v[160:163], v[208:211], v[36:39]
    v_mfma_f32_16x16x32_bf16 v[64:67], v[164:167], v[208:211], v[64:67]
    v_mfma_f32_16x16x32_bf16 v[92:95], v[168:171], v[208:211], v[92:95]
    v_mfma_f32_16x16x32_bf16 v[120:123], v[172:175], v[208:211], v[120:123]
    v_mfma_f32_16x16x32_bf16 v[40:43], v[160:163], v[212:215], v[40:43]
    v_mfma_f32_16x16x32_bf16 v[68:71], v[164:167], v[212:215], v[68:71]
    v_mfma_f32_16x16x32_bf16 v[96:99], v[168:171], v[212:215], v[96:99]
    v_mfma_f32_16x16x32_bf16 v[124:127], v[172:175], v[212:215], v[124:127]
    v_mfma_f32_16x16x32_bf16 v[44:47], v[160:163], v[216:219], v[44:47]
    v_mfma_f32_16x16x32_bf16 v[72:75], v[164:167], v[216:219], v[72:75]
    v_mfma_f32_16x16x32_bf16 v[100:103], v[168:171], v[216:219], v[100:103]
    v_mfma_f32_16x16x32_bf16 v[128:131], v[172:175], v[216:219], v[128:131]
    v_mfma_f32_16x16x32_bf16 v[48:51], v[160:163], v[220:223], v[48:51]
    v_mfma_f32_16x16x32_bf16 v[76:79], v[164:167], v[220:223], v[76:79]
    v_mfma_f32_16x16x32_bf16 v[104:107], v[168:171], v[220:223], v[104:107]
    v_mfma_f32_16x16x32_bf16 v[132:135], v[172:175], v[220:223], v[132:135]
    v_mfma_f32_16x16x32_bf16 v[52:55], v[160:163], v[224:227], v[52:55]
    v_mfma_f32_16x16x32_bf16 v[80:83], v[164:167], v[224:227], v[80:83]
    v_mfma_f32_16x16x32_bf16 v[108:111], v[168:171], v[224:227], v[108:111]
    v_mfma_f32_16x16x32_bf16 v[136:139], v[172:175], v[224:227], v[136:139]
    v_mfma_f32_16x16x32_bf16 v[56:59], v[160:163], v[228:231], v[56:59]
    v_mfma_f32_16x16x32_bf16 v[84:87], v[164:167], v[228:231], v[84:87]
    v_mfma_f32_16x16x32_bf16 v[112:115], v[168:171], v[228:231], v[112:115]
    v_mfma_f32_16x16x32_bf16 v[140:143], v[172:175], v[228:231], v[140:143]
    v_add_u32 v10, 69632, v10
    v_add_u32 v11, 69632, v11
    s_waitcnt vmcnt(0)
    s_barrier
    ds_read_b128 v[144:147], v10 offset:0
    ds_read_b128 v[148:151], v10 offset:576
    ds_read_b128 v[152:155], v10 offset:4160
    ds_read_b128 v[156:159], v10 offset:4608
    ds_read_b64_tr_b16 v[176:177], v11 offset:0
    ds_read_b64_tr_b16 v[178:179], v11 offset:3648
    ds_read_b64_tr_b16 v[180:181], v11 offset:32
    ds_read_b64_tr_b16 v[182:183], v11 offset:3680
    ds_read_b64_tr_b16 v[184:185], v11 offset:64
    ds_read_b64_tr_b16 v[186:187], v11 offset:3712
    ds_read_b64_tr_b16 v[188:189], v11 offset:96
    ds_read_b64_tr_b16 v[190:191], v11 offset:3744
    ds_read_b64_tr_b16 v[192:193], v11 offset:128
    ds_read_b64_tr_b16 v[194:195], v11 offset:3776
    ds_read_b64_tr_b16 v[196:197], v11 offset:160
    ds_read_b64_tr_b16 v[198:199], v11 offset:3808
    ds_read_b64_tr_b16 v[200:201], v11 offset:192
    ds_read_b64_tr_b16 v[202:203], v11 offset:3840
    ds_read_b128 v[160:163], v10 offset:64
    ds_read_b128 v[164:167], v10 offset:512
    ds_read_b128 v[168:171], v10 offset:4096
    ds_read_b128 v[172:175], v10 offset:4672
    ds_read_b64_tr_b16 v[204:205], v11 offset:29184
    ds_read_b64_tr_b16 v[206:207], v11 offset:32832
    ds_read_b64_tr_b16 v[208:209], v11 offset:29216
    ds_read_b64_tr_b16 v[210:211], v11 offset:32864
    ds_read_b64_tr_b16 v[212:213], v11 offset:29248
    ds_read_b64_tr_b16 v[214:215], v11 offset:32896
    ds_read_b64_tr_b16 v[216:217], v11 offset:29280
    ds_read_b64_tr_b16 v[218:219], v11 offset:32928
    ds_read_b64_tr_b16 v[220:221], v11 offset:29312
    ds_read_b64_tr_b16 v[222:223], v11 offset:32960
    ds_read_b64_tr_b16 v[224:225], v11 offset:29344
    ds_read_b64_tr_b16 v[226:227], v11 offset:32992
    ds_read_b64_tr_b16 v[228:229], v11 offset:29376
    ds_read_b64_tr_b16 v[230:231], v11 offset:33024
    s_waitcnt lgkmcnt(15)
    v_mfma_f32_16x16x32_bf16 v[32:35], v[144:147], v[176:179], v[32:35]
    v_mfma_f32_16x16x32_bf16 v[60:63], v[148:151], v[176:179], v[60:63]
    v_mfma_f32_16x16x32_bf16 v[88:91], v[152:155], v[176:179], v[88:91]
    v_mfma_f32_16x16x32_bf16 v[116:119], v[156:159], v[176:179], v[116:119]
    v_mfma_f32_16x16x32_bf16 v[36:39], v[144:147], v[180:183], v[36:39]
    v_mfma_f32_16x16x32_bf16 v[64:67], v[148:151], v[180:183], v[64:67]
    v_mfma_f32_16x16x32_bf16 v[92:95], v[152:155], v[180:183], v[92:95]
    v_mfma_f32_16x16x32_bf16 v[120:123], v[156:159], v[180:183], v[120:123]
    v_mfma_f32_16x16x32_bf16 v[40:43], v[144:147], v[184:187], v[40:43]
    v_mfma_f32_16x16x32_bf16 v[68:71], v[148:151], v[184:187], v[68:71]
    v_mfma_f32_16x16x32_bf16 v[96:99], v[152:155], v[184:187], v[96:99]
    v_mfma_f32_16x16x32_bf16 v[124:127], v[156:159], v[184:187], v[124:127]
    v_mfma_f32_16x16x32_bf16 v[44:47], v[144:147], v[188:191], v[44:47]
    v_mfma_f32_16x16x32_bf16 v[72:75], v[148:151], v[188:191], v[72:75]
    v_mfma_f32_16x16x32_bf16 v[100:103], v[152:155], v[188:191], v[100:103]
    v_mfma_f32_16x16x32_bf16 v[128:131], v[156:159], v[188:191], v[128:131]
    v_mfma_f32_16x16x32_bf16 v[48:51], v[144:147], v[192:195], v[48:51]
    v_mfma_f32_16x16x32_bf16 v[76:79], v[148:151], v[192:195], v[76:79]
    v_mfma_f32_16x16x32_bf16 v[104:107], v[152:155], v[192:195], v[104:107]
    v_mfma_f32_16x16x32_bf16 v[132:135], v[156:159], v[192:195], v[132:135]
    v_mfma_f32_16x16x32_bf16 v[52:55], v[144:147], v[196:199], v[52:55]
    v_mfma_f32_16x16x32_bf16 v[80:83], v[148:151], v[196:199], v[80:83]
    v_mfma_f32_16x16x32_bf16 v[108:111], v[152:155], v[196:199], v[108:111]
    v_mfma_f32_16x16x32_bf16 v[136:139], v[156:159], v[196:199], v[136:139]
    v_mfma_f32_16x16x32_bf16 v[56:59], v[144:147], v[200:203], v[56:59]
    v_mfma_f32_16x16x32_bf16 v[84:87], v[148:151], v[200:203], v[84:87]
    v_mfma_f32_16x16x32_bf16 v[112:115], v[152:155], v[200:203], v[112:115]
    v_mfma_f32_16x16x32_bf16 v[140:143], v[156:159], v[200:203], v[140:143]
    s_waitcnt lgkmcnt(0)
    v_mfma_f32_16x16x32_bf16 v[32:35], v[160:163], v[204:207], v[32:35]
    v_mfma_f32_16x16x32_bf16 v[60:63], v[164:167], v[204:207], v[60:63]
    v_mfma_f32_16x16x32_bf16 v[88:91], v[168:171], v[204:207], v[88:91]
    v_mfma_f32_16x16x32_bf16 v[116:119], v[172:175], v[204:207], v[116:119]
    v_mfma_f32_16x16x32_bf16 v[36:39], v[160:163], v[208:211], v[36:39]
    v_mfma_f32_16x16x32_bf16 v[64:67], v[164:167], v[208:211], v[64:67]
    v_mfma_f32_16x16x32_bf16 v[92:95], v[168:171], v[208:211], v[92:95]
    v_mfma_f32_16x16x32_bf16 v[120:123], v[172:175], v[208:211], v[120:123]
    v_mfma_f32_16x16x32_bf16 v[40:43], v[160:163], v[212:215], v[40:43]
    v_mfma_f32_16x16x32_bf16 v[68:71], v[164:167], v[212:215], v[68:71]
    v_mfma_f32_16x16x32_bf16 v[96:99], v[168:171], v[212:215], v[96:99]
    v_mfma_f32_16x16x32_bf16 v[124:127], v[172:175], v[212:215], v[124:127]
    v_mfma_f32_16x16x32_bf16 v[44:47], v[160:163], v[216:219], v[44:47]
    v_mfma_f32_16x16x32_bf16 v[72:75], v[164:167], v[216:219], v[72:75]
    v_mfma_f32_16x16x32_bf16 v[100:103], v[168:171], v[216:219], v[100:103]
    v_mfma_f32_16x16x32_bf16 v[128:131], v[172:175], v[216:219], v[128:131]
    v_mfma_f32_16x16x32_bf16 v[48:51], v[160:163], v[220:223], v[48:51]
    v_mfma_f32_16x16x32_bf16 v[76:79], v[164:167], v[220:223], v[76:79]
    v_mfma_f32_16x16x32_bf16 v[104:107], v[168:171], v[220:223], v[104:107]
    v_mfma_f32_16x16x32_bf16 v[132:135], v[172:175], v[220:223], v[132:135]
    v_mfma_f32_16x16x32_bf16 v[52:55], v[160:163], v[224:227], v[52:55]
    v_mfma_f32_16x16x32_bf16 v[80:83], v[164:167], v[224:227], v[80:83]
    v_mfma_f32_16x16x32_bf16 v[108:111], v[168:171], v[224:227], v[108:111]
    v_mfma_f32_16x16x32_bf16 v[136:139], v[172:175], v[224:227], v[136:139]
    v_mfma_f32_16x16x32_bf16 v[56:59], v[160:163], v[228:231], v[56:59]
    v_mfma_f32_16x16x32_bf16 v[84:87], v[164:167], v[228:231], v[84:87]
    v_mfma_f32_16x16x32_bf16 v[112:115], v[168:171], v[228:231], v[112:115]
    v_mfma_f32_16x16x32_bf16 v[140:143], v[172:175], v[228:231], v[140:143]
    v_lshlrev_b32 v5, 4, v0
    s_mul_i32 s54, s9, 7
    v_cvt_pk_bf16_f32 v144, v32, v33
    v_cvt_pk_bf16_f32 v145, v34, v35
    v_cvt_pk_bf16_f32 v146, v60, v61
    v_cvt_pk_bf16_f32 v147, v62, v63
    s_add_u32 s26, s54, 0
    s_lshr_b32 s27, s26, 1
    s_and_b32 s26, s26, 1
    s_lshl_b32 s27, s27, 4
    s_add_u32 s27, s27, s43
    s_lshl_b32 s27, s27, 1
    s_add_u32 s27, s27, s26
    s_mul_i32 s27, s27, 7
    s_add_u32 s27, s27, s48
    s_lshl_b32 s27, s27, 11
    s_add_u32 s27, s27, 10354688
    buffer_store_dwordx4 v[144:147], v5, s[4:7], s27 offen offset:0 sc1
    v_cvt_pk_bf16_f32 v148, v88, v89
    v_cvt_pk_bf16_f32 v149, v90, v91
    v_cvt_pk_bf16_f32 v150, v116, v117
    v_cvt_pk_bf16_f32 v151, v118, v119
    s_add_u32 s26, s54, 0
    s_lshr_b32 s27, s26, 1
    s_and_b32 s26, s26, 1
    s_lshl_b32 s27, s27, 4
    s_add_u32 s27, s27, s43
    s_lshl_b32 s27, s27, 1
    s_add_u32 s27, s27, s26
    s_mul_i32 s27, s27, 7
    s_add_u32 s27, s27, s48
    s_lshl_b32 s27, s27, 11
    s_add_u32 s27, s27, 10354688
    buffer_store_dwordx4 v[148:151], v5, s[4:7], s27 offen offset:1024 sc1
    v_cvt_pk_bf16_f32 v152, v36, v37
    v_cvt_pk_bf16_f32 v153, v38, v39
    v_cvt_pk_bf16_f32 v154, v64, v65
    v_cvt_pk_bf16_f32 v155, v66, v67
    s_add_u32 s26, s54, 1
    s_lshr_b32 s27, s26, 1
    s_and_b32 s26, s26, 1
    s_lshl_b32 s27, s27, 4
    s_add_u32 s27, s27, s43
    s_lshl_b32 s27, s27, 1
    s_add_u32 s27, s27, s26
    s_mul_i32 s27, s27, 7
    s_add_u32 s27, s27, s48
    s_lshl_b32 s27, s27, 11
    s_add_u32 s27, s27, 10354688
    buffer_store_dwordx4 v[152:155], v5, s[4:7], s27 offen offset:0 sc1
    v_cvt_pk_bf16_f32 v156, v92, v93
    v_cvt_pk_bf16_f32 v157, v94, v95
    v_cvt_pk_bf16_f32 v158, v120, v121
    v_cvt_pk_bf16_f32 v159, v122, v123
    s_add_u32 s26, s54, 1
    s_lshr_b32 s27, s26, 1
    s_and_b32 s26, s26, 1
    s_lshl_b32 s27, s27, 4
    s_add_u32 s27, s27, s43
    s_lshl_b32 s27, s27, 1
    s_add_u32 s27, s27, s26
    s_mul_i32 s27, s27, 7
    s_add_u32 s27, s27, s48
    s_lshl_b32 s27, s27, 11
    s_add_u32 s27, s27, 10354688
    buffer_store_dwordx4 v[156:159], v5, s[4:7], s27 offen offset:1024 sc1
    v_cvt_pk_bf16_f32 v160, v40, v41
    v_cvt_pk_bf16_f32 v161, v42, v43
    v_cvt_pk_bf16_f32 v162, v68, v69
    v_cvt_pk_bf16_f32 v163, v70, v71
    s_add_u32 s26, s54, 2
    s_lshr_b32 s27, s26, 1
    s_and_b32 s26, s26, 1
    s_lshl_b32 s27, s27, 4
    s_add_u32 s27, s27, s43
    s_lshl_b32 s27, s27, 1
    s_add_u32 s27, s27, s26
    s_mul_i32 s27, s27, 7
    s_add_u32 s27, s27, s48
    s_lshl_b32 s27, s27, 11
    s_add_u32 s27, s27, 10354688
    buffer_store_dwordx4 v[160:163], v5, s[4:7], s27 offen offset:0 sc1
    v_cvt_pk_bf16_f32 v164, v96, v97
    v_cvt_pk_bf16_f32 v165, v98, v99
    v_cvt_pk_bf16_f32 v166, v124, v125
    v_cvt_pk_bf16_f32 v167, v126, v127
    s_add_u32 s26, s54, 2
    s_lshr_b32 s27, s26, 1
    s_and_b32 s26, s26, 1
    s_lshl_b32 s27, s27, 4
    s_add_u32 s27, s27, s43
    s_lshl_b32 s27, s27, 1
    s_add_u32 s27, s27, s26
    s_mul_i32 s27, s27, 7
    s_add_u32 s27, s27, s48
    s_lshl_b32 s27, s27, 11
    s_add_u32 s27, s27, 10354688
    buffer_store_dwordx4 v[164:167], v5, s[4:7], s27 offen offset:1024 sc1
    v_cvt_pk_bf16_f32 v168, v44, v45
    v_cvt_pk_bf16_f32 v169, v46, v47
    v_cvt_pk_bf16_f32 v170, v72, v73
    v_cvt_pk_bf16_f32 v171, v74, v75
    s_add_u32 s26, s54, 3
    s_lshr_b32 s27, s26, 1
    s_and_b32 s26, s26, 1
    s_lshl_b32 s27, s27, 4
    s_add_u32 s27, s27, s43
    s_lshl_b32 s27, s27, 1
    s_add_u32 s27, s27, s26
    s_mul_i32 s27, s27, 7
    s_add_u32 s27, s27, s48
    s_lshl_b32 s27, s27, 11
    s_add_u32 s27, s27, 10354688
    buffer_store_dwordx4 v[168:171], v5, s[4:7], s27 offen offset:0 sc1
    v_cvt_pk_bf16_f32 v172, v100, v101
    v_cvt_pk_bf16_f32 v173, v102, v103
    v_cvt_pk_bf16_f32 v174, v128, v129
    v_cvt_pk_bf16_f32 v175, v130, v131
    s_add_u32 s26, s54, 3
    s_lshr_b32 s27, s26, 1
    s_and_b32 s26, s26, 1
    s_lshl_b32 s27, s27, 4
    s_add_u32 s27, s27, s43
    s_lshl_b32 s27, s27, 1
    s_add_u32 s27, s27, s26
    s_mul_i32 s27, s27, 7
    s_add_u32 s27, s27, s48
    s_lshl_b32 s27, s27, 11
    s_add_u32 s27, s27, 10354688
    buffer_store_dwordx4 v[172:175], v5, s[4:7], s27 offen offset:1024 sc1
    v_cvt_pk_bf16_f32 v144, v48, v49
    v_cvt_pk_bf16_f32 v145, v50, v51
    v_cvt_pk_bf16_f32 v146, v76, v77
    v_cvt_pk_bf16_f32 v147, v78, v79
    s_add_u32 s26, s54, 4
    s_lshr_b32 s27, s26, 1
    s_and_b32 s26, s26, 1
    s_lshl_b32 s27, s27, 4
    s_add_u32 s27, s27, s43
    s_lshl_b32 s27, s27, 1
    s_add_u32 s27, s27, s26
    s_mul_i32 s27, s27, 7
    s_add_u32 s27, s27, s48
    s_lshl_b32 s27, s27, 11
    s_add_u32 s27, s27, 10354688
    buffer_store_dwordx4 v[144:147], v5, s[4:7], s27 offen offset:0 sc1
    v_cvt_pk_bf16_f32 v148, v104, v105
    v_cvt_pk_bf16_f32 v149, v106, v107
    v_cvt_pk_bf16_f32 v150, v132, v133
    v_cvt_pk_bf16_f32 v151, v134, v135
    s_add_u32 s26, s54, 4
    s_lshr_b32 s27, s26, 1
    s_and_b32 s26, s26, 1
    s_lshl_b32 s27, s27, 4
    s_add_u32 s27, s27, s43
    s_lshl_b32 s27, s27, 1
    s_add_u32 s27, s27, s26
    s_mul_i32 s27, s27, 7
    s_add_u32 s27, s27, s48
    s_lshl_b32 s27, s27, 11
    s_add_u32 s27, s27, 10354688
    buffer_store_dwordx4 v[148:151], v5, s[4:7], s27 offen offset:1024 sc1
    v_cvt_pk_bf16_f32 v152, v52, v53
    v_cvt_pk_bf16_f32 v153, v54, v55
    v_cvt_pk_bf16_f32 v154, v80, v81
    v_cvt_pk_bf16_f32 v155, v82, v83
    s_add_u32 s26, s54, 5
    s_lshr_b32 s27, s26, 1
    s_and_b32 s26, s26, 1
    s_lshl_b32 s27, s27, 4
    s_add_u32 s27, s27, s43
    s_lshl_b32 s27, s27, 1
    s_add_u32 s27, s27, s26
    s_mul_i32 s27, s27, 7
    s_add_u32 s27, s27, s48
    s_lshl_b32 s27, s27, 11
    s_add_u32 s27, s27, 10354688
    buffer_store_dwordx4 v[152:155], v5, s[4:7], s27 offen offset:0 sc1
    v_cvt_pk_bf16_f32 v156, v108, v109
    v_cvt_pk_bf16_f32 v157, v110, v111
    v_cvt_pk_bf16_f32 v158, v136, v137
    v_cvt_pk_bf16_f32 v159, v138, v139
    s_add_u32 s26, s54, 5
    s_lshr_b32 s27, s26, 1
    s_and_b32 s26, s26, 1
    s_lshl_b32 s27, s27, 4
    s_add_u32 s27, s27, s43
    s_lshl_b32 s27, s27, 1
    s_add_u32 s27, s27, s26
    s_mul_i32 s27, s27, 7
    s_add_u32 s27, s27, s48
    s_lshl_b32 s27, s27, 11
    s_add_u32 s27, s27, 10354688
    buffer_store_dwordx4 v[156:159], v5, s[4:7], s27 offen offset:1024 sc1
    v_cvt_pk_bf16_f32 v160, v56, v57
    v_cvt_pk_bf16_f32 v161, v58, v59
    v_cvt_pk_bf16_f32 v162, v84, v85
    v_cvt_pk_bf16_f32 v163, v86, v87
    s_add_u32 s26, s54, 6
    s_lshr_b32 s27, s26, 1
    s_and_b32 s26, s26, 1
    s_lshl_b32 s27, s27, 4
    s_add_u32 s27, s27, s43
    s_lshl_b32 s27, s27, 1
    s_add_u32 s27, s27, s26
    s_mul_i32 s27, s27, 7
    s_add_u32 s27, s27, s48
    s_lshl_b32 s27, s27, 11
    s_add_u32 s27, s27, 10354688
    buffer_store_dwordx4 v[160:163], v5, s[4:7], s27 offen offset:0 sc1
    v_cvt_pk_bf16_f32 v164, v112, v113
    v_cvt_pk_bf16_f32 v165, v114, v115
    v_cvt_pk_bf16_f32 v166, v140, v141
    v_cvt_pk_bf16_f32 v167, v142, v143
    s_add_u32 s26, s54, 6
    s_lshr_b32 s27, s26, 1
    s_and_b32 s26, s26, 1
    s_lshl_b32 s27, s27, 4
    s_add_u32 s27, s27, s43
    s_lshl_b32 s27, s27, 1
    s_add_u32 s27, s27, s26
    s_mul_i32 s27, s27, 7
    s_add_u32 s27, s27, s48
    s_lshl_b32 s27, s27, 11
    s_add_u32 s27, s27, 10354688
    buffer_store_dwordx4 v[164:167], v5, s[4:7], s27 offen offset:1024 sc1
    s_branch standalone__memory_aug_recurrent_mem_tr__prompt_kernel_prep_done
standalone__memory_aug_recurrent_mem_tr__prompt_kernel_misc:
    s_mov_b32 s64, s28
    s_mov_b32 s65, s29
    s_mov_b32 s66, 1835008
    s_mov_b32 s67, 0x00020000
    s_mov_b32 s68, s30
    s_mov_b32 s69, s31
    s_mov_b32 s70, 7168
    s_mov_b32 s71, 0x00020000
    s_lshl_b32 s26, s25, 8
    v_add_u32 v16, s26, v6
    v_lshlrev_b32 v17, 4, v0
    s_lshl_b32 s50, s25, 6
    s_lshl_b32 s51, s9, 4
    s_add_u32 s50, s50, s51
    s_mul_i32 s50, s50, 896
    s_mul_i32 s51, s51, 912
    s_mov_b32 s52, -1
    s_mov_b32 s53, 0x00ffffff
    s_mov_b64 exec, s[52:53]
    s_add_u32 s26, s51, 0
    s_mov_b32 m0, s26
    s_add_u32 s27, s50, 0
    buffer_load_dwordx4 v17, s[64:67], s27 offen nt lds
    s_add_u32 s26, s51, 912
    s_mov_b32 m0, s26
    s_add_u32 s27, s50, 896
    buffer_load_dwordx4 v17, s[64:67], s27 offen nt lds
    s_add_u32 s26, s51, 1824
    s_mov_b32 m0, s26
    s_add_u32 s27, s50, 1792
    buffer_load_dwordx4 v17, s[64:67], s27 offen nt lds
    s_add_u32 s26, s51, 2736
    s_mov_b32 m0, s26
    s_add_u32 s27, s50, 2688
    buffer_load_dwordx4 v17, s[64:67], s27 offen nt lds
    s_add_u32 s26, s51, 3648
    s_mov_b32 m0, s26
    s_add_u32 s27, s50, 3584
    buffer_load_dwordx4 v17, s[64:67], s27 offen nt lds
    s_add_u32 s26, s51, 4560
    s_mov_b32 m0, s26
    s_add_u32 s27, s50, 4480
    buffer_load_dwordx4 v17, s[64:67], s27 offen nt lds
    s_add_u32 s26, s51, 5472
    s_mov_b32 m0, s26
    s_add_u32 s27, s50, 5376
    buffer_load_dwordx4 v17, s[64:67], s27 offen nt lds
    s_add_u32 s26, s51, 6384
    s_mov_b32 m0, s26
    s_add_u32 s27, s50, 6272
    buffer_load_dwordx4 v17, s[64:67], s27 offen nt lds
    s_add_u32 s26, s51, 7296
    s_mov_b32 m0, s26
    s_add_u32 s27, s50, 7168
    buffer_load_dwordx4 v17, s[64:67], s27 offen nt lds
    s_add_u32 s26, s51, 8208
    s_mov_b32 m0, s26
    s_add_u32 s27, s50, 8064
    buffer_load_dwordx4 v17, s[64:67], s27 offen nt lds
    s_add_u32 s26, s51, 9120
    s_mov_b32 m0, s26
    s_add_u32 s27, s50, 8960
    buffer_load_dwordx4 v17, s[64:67], s27 offen nt lds
    s_add_u32 s26, s51, 10032
    s_mov_b32 m0, s26
    s_add_u32 s27, s50, 9856
    buffer_load_dwordx4 v17, s[64:67], s27 offen nt lds
    s_add_u32 s26, s51, 10944
    s_mov_b32 m0, s26
    s_add_u32 s27, s50, 10752
    buffer_load_dwordx4 v17, s[64:67], s27 offen nt lds
    s_add_u32 s26, s51, 11856
    s_mov_b32 m0, s26
    s_add_u32 s27, s50, 11648
    buffer_load_dwordx4 v17, s[64:67], s27 offen nt lds
    s_add_u32 s26, s51, 12768
    s_mov_b32 m0, s26
    s_add_u32 s27, s50, 12544
    buffer_load_dwordx4 v17, s[64:67], s27 offen nt lds
    s_add_u32 s26, s51, 13680
    s_mov_b32 m0, s26
    s_add_u32 s27, s50, 13440
    buffer_load_dwordx4 v17, s[64:67], s27 offen nt lds
    s_mov_b64 exec, -1
    s_cmp_lg_u32 s9, 0
    s_cbranch_scc1 standalone__memory_aug_recurrent_mem_tr__prompt_kernel_registered3
    s_mov_b64 exec, 1
    s_cmp_lg_u32 s2, 0
    s_cbranch_scc1 standalone__memory_aug_recurrent_mem_tr__prompt_kernel_notag3
    s_memrealtime s[26:27]
    s_waitcnt lgkmcnt(0)
    s_andn2_b32 s26, s26, 15
    s_or_b32 s26, s26, 8
    s_or_b32 s26, s26, s3
    v_mov_b32 v250, s26
    v_mov_b32 v251, 32
    buffer_store_dword v250, v251, s[12:15], 0 offen sc1
    s_nop 1
standalone__memory_aug_recurrent_mem_tr__prompt_kernel_notag3:
    s_lshl_b32 s26, s3, 2
    v_mov_b32 v250, 1
    v_mov_b32 v251, s26
    buffer_atomic_add v250, v251, s[12:15], 0 offen sc0
    s_mov_b64 exec, -1
standalone__memory_aug_recurrent_mem_tr__prompt_kernel_registered3:
    v_and_b32 v5, 7, v16
    v_bfe_u32 v6, v16, 3, 1
    v_bfe_u32 v7, v16, 4, 2
    v_lshrrev_b32 v8, 6, v16
    v_mul_u32_u24 v5, 896, v5
    v_lshlrev_b32 v8, 7, v8
    v_lshlrev_b32 v7, 5, v7
    v_lshlrev_b32 v6, 2, v6
    v_add3_u32 v5, v5, v8, v7
    v_add_u32 v5, v5, v6
    v_lshlrev_b32 v18, 4, v16
    v_cmp_gt_u32 vcc, 448, v16
    v_mov_b32 v9, 0x7fff0000
    s_nop 0
    v_cndmask_b32 v5, v9, v5, vcc
    v_cndmask_b32 v9, v9, v18, vcc
    buffer_load_dword v144, v5, s[68:71], 0 offen
    buffer_load_dword v145, v5, s[68:71], 0 offen offset:8
    buffer_load_dword v146, v5, s[68:71], 0 offen offset:16
    buffer_load_dword v147, v5, s[68:71], 0 offen offset:24
    v_mov_b32 v148, -1
    v_mov_b32 v149, -1
    v_mov_b32 v150, -1
    v_mov_b32 v151, -1
    v_mov_b32 v152, 0
    v_mov_b32 v153, 0
    v_mov_b32 v154, 0
    v_mov_b32 v155, 0
    s_mov_b32 s26, 16784384
    buffer_store_dwordx4 v[148:151], v18, s[4:7], s26 offen sc1
    s_mov_b32 s26, 16915456
    buffer_store_dwordx4 v[148:151], v18, s[4:7], s26 offen sc1
    s_mov_b32 s26, 17046528
    buffer_store_dwordx4 v[148:151], v18, s[4:7], s26 offen sc1
    v_cmp_gt_u32 vcc, 4096, v16
    v_mov_b32 v5, 0x7fff0000
    s_nop 0
    v_cndmask_b32 v5, v5, v18, vcc
    s_mov_b32 s26, 17177600
    buffer_store_dwordx4 v[148:151], v5, s[4:7], s26 offen sc1
    s_mov_b32 s26, 17244160
    buffer_store_dwordx4 v[148:151], v18, s[4:7], s26 offen sc1
    s_mov_b32 s26, 17375232
    buffer_store_dwordx4 v[148:151], v18, s[4:7], s26 offen sc1
    s_mov_b32 s26, 17506304
    buffer_store_dwordx4 v[148:151], v18, s[4:7], s26 offen sc1
    v_cmp_gt_u32 vcc, 4544, v16
    v_mov_b32 v5, 0x7fff0000
    s_nop 0
    v_cndmask_b32 v5, v5, v18, vcc
    s_mov_b32 s26, 17637376
    buffer_store_dwordx4 v[148:151], v5, s[4:7], s26 offen sc1
    s_mov_b32 s26, 17711104
    buffer_store_dwordx4 v[148:151], v18, s[4:7], s26 offen sc1
    s_mov_b32 s26, 17842176
    buffer_store_dwordx4 v[148:151], v18, s[4:7], s26 offen sc1
    s_mov_b32 s26, 17973248
    buffer_store_dwordx4 v[148:151], v18, s[4:7], s26 offen sc1
    s_mov_b32 s26, 18104320
    buffer_store_dwordx4 v[148:151], v18, s[4:7], s26 offen sc1
    s_mov_b32 s26, 18235392
    buffer_store_dwordx4 v[148:151], v18, s[4:7], s26 offen sc1
    v_cmp_gt_u32 vcc, 2048, v16
    v_mov_b32 v5, 0x7fff0000
    s_nop 0
    v_cndmask_b32 v5, v5, v18, vcc
    s_mov_b32 s26, 57688064
    buffer_store_dwordx4 v[152:155], v5, s[4:7], s26 offen sc1
    v_and_b32 v5, 31, v0
    v_mul_u32_u24 v5, 912, v5
    v_lshrrev_b32 v6, 5, v0
    v_lshl_add_u32 v5, v6, 4, v5
    s_lshr_b32 s50, s9, 1
    s_and_b32 s51, s9, 1
    s_mul_i32 s52, s50, 29184
    s_mul_i32 s53, s51, 448
    s_add_u32 s52, s52, s53
    v_add_u32 v19, s52, v5
    s_lshl_b32 s52, s25, 1
    s_add_u32 s52, s52, s50
    s_mul_i32 s52, s52, 28672
    s_mul_i32 s53, s51, 14336
    s_add_u32 s52, s52, s53
    s_add_u32 s52, s52, 0
    v_mul_u32_u24 v5, 912, v4
    s_mul_i32 s53, s9, 224
    v_add_u32 v5, s53, v5
    v_lshl_add_u32 v20, v3, 4, v5
    v_lshrrev_b32 v6, 1, v3
    v_and_b32 v7, 1, v3
    v_cmp_eq_u32 s[72:73], 1, v7
    v_lshlrev_b32 v7, 4, v6
    v_add_u32 v7, 128, v7
    v_lshlrev_b32 v8, 3, v6
    v_add_u32 v8, 192, v8
    v_cndmask_b32 v10, v7, v8, s[72:73]
    v_add_u32 v21, v5, v10
    v_add_u32 v7, 32, v7
    v_add_u32 v8, 16, v8
    v_cndmask_b32 v10, v7, v8, s[72:73]
    v_add_u32 v22, v5, v10
    s_lshl_b32 s54, s25, 16
    s_lshl_b32 s55, s9, 13
    s_add_u32 s54, s54, s55
    s_add_u32 s54, s54, 1835008
    s_waitcnt vmcnt(0)
    s_barrier
    v_lshlrev_b32 v253, 2, v0
    buffer_load_dword v252, v253, s[12:15], 0 offen sc1
    ds_read_b128 v[24:27], v19 offset:0
    ds_read_b128 v[28:31], v19 offset:32
    ds_read_b128 v[32:35], v19 offset:64
    ds_read_b128 v[36:39], v19 offset:96
    ds_read_b128 v[40:43], v19 offset:128
    ds_read_b128 v[44:47], v19 offset:160
    ds_read_b128 v[48:51], v19 offset:192
    ds_read_b128 v[52:55], v19 offset:224
    ds_read_b128 v[56:59], v19 offset:256
    ds_read_b128 v[60:63], v19 offset:288
    ds_read_b128 v[64:67], v19 offset:320
    ds_read_b128 v[68:71], v19 offset:352
    ds_read_b128 v[72:75], v19 offset:384
    ds_read_b128 v[76:79], v19 offset:416
    ds_read_b128 v[80:83], v20 offset:0
    ds_read_b128 v[84:87], v20 offset:64
    ds_read_b128 v[88:91], v20 offset:14592
    ds_read_b128 v[92:95], v20 offset:14656
    ds_read_b128 v[96:99], v20 offset:29184
    ds_read_b128 v[100:103], v20 offset:29248
    ds_read_b128 v[104:107], v20 offset:43776
    ds_read_b128 v[108:111], v20 offset:43840
    s_waitcnt lgkmcnt(8)
    s_add_u32 s26, s52, 0
    buffer_store_dwordx4 v[24:27], v17, s[4:7], s26 offen sc1
    s_add_u32 s26, s52, 1024
    buffer_store_dwordx4 v[28:31], v17, s[4:7], s26 offen sc1
    s_add_u32 s26, s52, 2048
    buffer_store_dwordx4 v[32:35], v17, s[4:7], s26 offen sc1
    s_add_u32 s26, s52, 3072
    buffer_store_dwordx4 v[36:39], v17, s[4:7], s26 offen sc1
    s_add_u32 s26, s52, 4096
    buffer_store_dwordx4 v[40:43], v17, s[4:7], s26 offen sc1
    s_add_u32 s26, s52, 5120
    buffer_store_dwordx4 v[44:47], v17, s[4:7], s26 offen sc1
    s_add_u32 s26, s52, 6144
    buffer_store_dwordx4 v[48:51], v17, s[4:7], s26 offen sc1
    s_add_u32 s26, s52, 7168
    buffer_store_dwordx4 v[52:55], v17, s[4:7], s26 offen sc1
    s_add_u32 s26, s52, 8192
    buffer_store_dwordx4 v[56:59], v17, s[4:7], s26 offen sc1
    s_add_u32 s26, s52, 9216
    buffer_store_dwordx4 v[60:63], v17, s[4:7], s26 offen sc1
    s_add_u32 s26, s52, 10240
    buffer_store_dwordx4 v[64:67], v17, s[4:7], s26 offen sc1
    s_add_u32 s26, s52, 11264
    buffer_store_dwordx4 v[68:71], v17, s[4:7], s26 offen sc1
    s_add_u32 s26, s52, 12288
    buffer_store_dwordx4 v[72:75], v17, s[4:7], s26 offen sc1
    s_add_u32 s26, s52, 13312
    buffer_store_dwordx4 v[76:79], v17, s[4:7], s26 offen sc1
    ds_read_b64 v[112:113], v21 offset:0
    ds_read_b64 v[114:115], v21 offset:8
    ds_read_b64 v[116:117], v22 offset:0
    ds_read_b64 v[118:119], v22 offset:8
    ds_read_b64 v[120:121], v21 offset:14592
    ds_read_b64 v[122:123], v21 offset:14600
    ds_read_b64 v[124:125], v22 offset:14592
    ds_read_b64 v[126:127], v22 offset:14600
    ds_read_b64 v[128:129], v21 offset:29184
    ds_read_b64 v[130:131], v21 offset:29192
    ds_read_b64 v[132:133], v22 offset:29184
    ds_read_b64 v[134:135], v22 offset:29192
    ds_read_b64 v[136:137], v21 offset:43776
    ds_read_b64 v[138:139], v21 offset:43784
    ds_read_b64 v[140:141], v22 offset:43776
    ds_read_b64 v[142:143], v22 offset:43784
    s_waitcnt lgkmcnt(0)
    s_add_u32 s26, s54, 0
    buffer_store_dwordx4 v[80:83], v17, s[4:7], s26 offen sc1
    s_add_u32 s26, s54, 1024
    buffer_store_dwordx4 v[84:87], v17, s[4:7], s26 offen sc1
    s_add_u32 s26, s54, 2048
    buffer_store_dwordx4 v[88:91], v17, s[4:7], s26 offen sc1
    s_add_u32 s26, s54, 3072
    buffer_store_dwordx4 v[92:95], v17, s[4:7], s26 offen sc1
    v_cndmask_b32 v114, v114, v113, s[72:73]
    v_cndmask_b32 v113, v113, 0, s[72:73]
    v_cndmask_b32 v115, v115, 0, s[72:73]
    s_add_u32 s26, s54, 4096
    buffer_store_dwordx4 v[112:115], v17, s[4:7], s26 offen sc1
    v_cndmask_b32 v118, v118, v117, s[72:73]
    v_cndmask_b32 v117, v117, 0, s[72:73]
    v_cndmask_b32 v119, v119, 0, s[72:73]
    s_add_u32 s26, s54, 5120
    buffer_store_dwordx4 v[116:119], v17, s[4:7], s26 offen sc1
    v_cndmask_b32 v122, v122, v121, s[72:73]
    v_cndmask_b32 v121, v121, 0, s[72:73]
    v_cndmask_b32 v123, v123, 0, s[72:73]
    s_add_u32 s26, s54, 6144
    buffer_store_dwordx4 v[120:123], v17, s[4:7], s26 offen sc1
    v_cndmask_b32 v126, v126, v125, s[72:73]
    v_cndmask_b32 v125, v125, 0, s[72:73]
    v_cndmask_b32 v127, v127, 0, s[72:73]
    s_add_u32 s26, s54, 7168
    buffer_store_dwordx4 v[124:127], v17, s[4:7], s26 offen sc1
    s_add_u32 s26, s54, 32768
    buffer_store_dwordx4 v[96:99], v17, s[4:7], s26 offen sc1
    s_add_u32 s26, s54, 33792
    buffer_store_dwordx4 v[100:103], v17, s[4:7], s26 offen sc1
    s_add_u32 s26, s54, 34816
    buffer_store_dwordx4 v[104:107], v17, s[4:7], s26 offen sc1
    s_add_u32 s26, s54, 35840
    buffer_store_dwordx4 v[108:111], v17, s[4:7], s26 offen sc1
    v_cndmask_b32 v130, v130, v129, s[72:73]
    v_cndmask_b32 v129, v129, 0, s[72:73]
    v_cndmask_b32 v131, v131, 0, s[72:73]
    s_add_u32 s26, s54, 36864
    buffer_store_dwordx4 v[128:131], v17, s[4:7], s26 offen sc1
    v_cndmask_b32 v134, v134, v133, s[72:73]
    v_cndmask_b32 v133, v133, 0, s[72:73]
    v_cndmask_b32 v135, v135, 0, s[72:73]
    s_add_u32 s26, s54, 37888
    buffer_store_dwordx4 v[132:135], v17, s[4:7], s26 offen sc1
    v_cndmask_b32 v138, v138, v137, s[72:73]
    v_cndmask_b32 v137, v137, 0, s[72:73]
    v_cndmask_b32 v139, v139, 0, s[72:73]
    s_add_u32 s26, s54, 38912
    buffer_store_dwordx4 v[136:139], v17, s[4:7], s26 offen sc1
    v_cndmask_b32 v142, v142, v141, s[72:73]
    v_cndmask_b32 v141, v141, 0, s[72:73]
    v_cndmask_b32 v143, v143, 0, s[72:73]
    s_add_u32 s26, s54, 39936
    buffer_store_dwordx4 v[140:143], v17, s[4:7], s26 offen sc1
    s_mov_b32 s26, 16777216
    buffer_store_dwordx4 v[144:147], v9, s[4:7], s26 offen sc1
standalone__memory_aug_recurrent_mem_tr__prompt_kernel_prep_done:
    v_mbcnt_lo_u32_b32 v0, -1, 0
    v_mbcnt_hi_u32_b32 v0, -1, v0
    s_cmp_lg_u32 s9, 0
    s_cbranch_scc1 standalone__memory_aug_recurrent_mem_tr__prompt_kernel_role_known
    s_waitcnt vmcnt(31)
standalone__memory_aug_recurrent_mem_tr__prompt_kernel_reg_check:
    v_readlane_b32 s32, v252, 0
    v_readlane_b32 s33, v252, 1
    v_readlane_b32 s34, v252, 2
    v_readlane_b32 s35, v252, 3
    v_readlane_b32 s36, v252, 4
    v_readlane_b32 s37, v252, 5
    v_readlane_b32 s38, v252, 6
    v_readlane_b32 s39, v252, 7
    v_readlane_b32 s18, v252, 8
    v_readlane_b32 s25, v250, 0
    s_add_u32 s26, s32, s33
    s_add_u32 s26, s26, s34
    s_add_u32 s26, s26, s35
    s_add_u32 s26, s26, s36
    s_add_u32 s26, s26, s37
    s_add_u32 s26, s26, s38
    s_add_u32 s26, s26, s39
    s_cmp_ge_u32 s26, 256
    s_cselect_b32 s26, 1, 0
    s_cmp_lg_u32 s18, 0
    s_cselect_b32 s26, s26, 0
    s_cmp_lg_u32 s26, 0
    s_cbranch_scc1 standalone__memory_aug_recurrent_mem_tr__prompt_kernel_reg_done
    s_cmp_eq_u32 s17, 0
    s_cbranch_scc1 standalone__memory_aug_recurrent_mem_tr__prompt_kernel_reg_done
    s_sub_u32 s17, s17, 1
    v_lshlrev_b32 v253, 2, v0
    buffer_load_dword v252, v253, s[12:15], 0 offen sc1
    s_waitcnt vmcnt(0)
    s_branch standalone__memory_aug_recurrent_mem_tr__prompt_kernel_reg_check
standalone__memory_aug_recurrent_mem_tr__prompt_kernel_reg_done:
    s_mov_b32 s27, 99
    s_cmp_ge_u32 s39, 30
    s_cselect_b32 s27, 7, s27
    s_cmp_ge_u32 s38, 30
    s_cselect_b32 s27, 6, s27
    s_cmp_ge_u32 s37, 30
    s_cselect_b32 s27, 5, s27
    s_cmp_ge_u32 s36, 30
    s_cselect_b32 s27, 4, s27
    s_cmp_ge_u32 s35, 30
    s_cselect_b32 s27, 3, s27
    s_cmp_ge_u32 s34, 30
    s_cselect_b32 s27, 2, s27
    s_cmp_ge_u32 s33, 30
    s_cselect_b32 s27, 1, s27
    s_cmp_ge_u32 s32, 30
    s_cselect_b32 s27, 0, s27
    s_and_b32 s24, s18, 7
    s_mov_b32 s31, 0
    s_cmp_eq_u32 s24, 0
    s_cselect_b32 s31, s32, s31
    s_cmp_eq_u32 s24, 1
    s_cselect_b32 s31, s33, s31
    s_cmp_eq_u32 s24, 2
    s_cselect_b32 s31, s34, s31
    s_cmp_eq_u32 s24, 3
    s_cselect_b32 s31, s35, s31
    s_cmp_eq_u32 s24, 4
    s_cselect_b32 s31, s36, s31
    s_cmp_eq_u32 s24, 5
    s_cselect_b32 s31, s37, s31
    s_cmp_eq_u32 s24, 6
    s_cselect_b32 s31, s38, s31
    s_cmp_eq_u32 s24, 7
    s_cselect_b32 s31, s39, s31
    s_cmp_ge_u32 s31, 30
    s_cselect_b32 s27, s24, s27
    s_mov_b32 s28, 0
    s_mov_b32 s29, 0
    s_mov_b32 s30, 0
    s_cmp_gt_u32 s3, 0
    s_cselect_b32 s31, s32, 0
    s_add_u32 s28, s28, s31
    s_cmp_eq_u32 s27, 0
    s_cselect_b32 s31, 0, s31
    s_cselect_b32 s30, s32, s30
    s_add_u32 s29, s29, s31
    s_cmp_gt_u32 s3, 1
    s_cselect_b32 s31, s33, 0
    s_add_u32 s28, s28, s31
    s_cmp_eq_u32 s27, 1
    s_cselect_b32 s31, 0, s31
    s_cselect_b32 s30, s33, s30
    s_add_u32 s29, s29, s31
    s_cmp_gt_u32 s3, 2
    s_cselect_b32 s31, s34, 0
    s_add_u32 s28, s28, s31
    s_cmp_eq_u32 s27, 2
    s_cselect_b32 s31, 0, s31
    s_cselect_b32 s30, s34, s30
    s_add_u32 s29, s29, s31
    s_cmp_gt_u32 s3, 3
    s_cselect_b32 s31, s35, 0
    s_add_u32 s28, s28, s31
    s_cmp_eq_u32 s27, 3
    s_cselect_b32 s31, 0, s31
    s_cselect_b32 s30, s35, s30
    s_add_u32 s29, s29, s31
    s_cmp_gt_u32 s3, 4
    s_cselect_b32 s31, s36, 0
    s_add_u32 s28, s28, s31
    s_cmp_eq_u32 s27, 4
    s_cselect_b32 s31, 0, s31
    s_cselect_b32 s30, s36, s30
    s_add_u32 s29, s29, s31
    s_cmp_gt_u32 s3, 5
    s_cselect_b32 s31, s37, 0
    s_add_u32 s28, s28, s31
    s_cmp_eq_u32 s27, 5
    s_cselect_b32 s31, 0, s31
    s_cselect_b32 s30, s37, s30
    s_add_u32 s29, s29, s31
    s_cmp_gt_u32 s3, 6
    s_cselect_b32 s31, s38, 0
    s_add_u32 s28, s28, s31
    s_cmp_eq_u32 s27, 6
    s_cselect_b32 s31, 0, s31
    s_cselect_b32 s30, s38, s30
    s_add_u32 s29, s29, s31
    s_cmp_gt_u32 s3, 7
    s_cselect_b32 s31, s39, 0
    s_add_u32 s28, s28, s31
    s_cmp_eq_u32 s27, 7
    s_cselect_b32 s31, 0, s31
    s_cselect_b32 s30, s39, s30
    s_add_u32 s29, s29, s31

    s_cmp_eq_u32 s27, 99
    s_cbranch_scc1 standalone__memory_aug_recurrent_mem_tr__prompt_kernel_slow_roles
    s_mov_b32 s16, 0
    s_cmp_eq_u32 s3, s27
    s_cbranch_scc1 standalone__memory_aug_recurrent_mem_tr__prompt_kernel_on_chain_die
    s_add_u32 s31, s29, s25
    s_branch standalone__memory_aug_recurrent_mem_tr__prompt_kernel_side_role
standalone__memory_aug_recurrent_mem_tr__prompt_kernel_on_chain_die:
    s_cmp_lt_u32 s25, 30
    s_cbranch_scc1 standalone__memory_aug_recurrent_mem_tr__prompt_kernel_chain_role_rank
    s_sub_u32 s31, 256, s30
    s_add_u32 s31, s31, s25
    s_sub_u32 s31, s31, 30
    s_branch standalone__memory_aug_recurrent_mem_tr__prompt_kernel_side_role
standalone__memory_aug_recurrent_mem_tr__prompt_kernel_chain_role_rank:
    s_mov_b32 s31, s25
    s_branch standalone__memory_aug_recurrent_mem_tr__prompt_kernel_chain_role
standalone__memory_aug_recurrent_mem_tr__prompt_kernel_slow_roles:
    s_mov_b32 s16, 1
    s_add_u32 s31, s28, s25
    s_cmp_lt_u32 s31, 30
    s_cbranch_scc1 standalone__memory_aug_recurrent_mem_tr__prompt_kernel_chain_role
    s_sub_u32 s31, s31, 30
standalone__memory_aug_recurrent_mem_tr__prompt_kernel_side_role:
    s_mov_b32 s10, 5
    s_mov_b32 s11, 0
    s_cmp_lt_u32 s31, 212
    s_cselect_b32 s10, 4, s10
    s_cmp_lt_u32 s31, 128
    s_cselect_b32 s10, 3, s10
    s_cmp_lt_u32 s31, 64
    s_cselect_b32 s10, 2, s10
    s_sub_u32 s11, s31, 128
    s_cmp_ge_u32 s31, 224
    s_cbranch_scc0 standalone__memory_aug_recurrent_mem_tr__prompt_kernel_not_helper
    s_mov_b32 s10, 6
    s_sub_u32 s11, s31, 224
    s_branch standalone__memory_aug_recurrent_mem_tr__prompt_kernel_role_done
standalone__memory_aug_recurrent_mem_tr__prompt_kernel_not_helper:
    s_cmp_lt_u32 s31, 128
    s_cbranch_scc0 standalone__memory_aug_recurrent_mem_tr__prompt_kernel_role_done
    s_and_b32 s11, s31, 63
    s_branch standalone__memory_aug_recurrent_mem_tr__prompt_kernel_role_done
standalone__memory_aug_recurrent_mem_tr__prompt_kernel_chain_role:
    s_mov_b32 s10, 0
    s_mov_b32 s11, s31
    s_cmp_lt_u32 s31, 16
    s_cbranch_scc1 standalone__memory_aug_recurrent_mem_tr__prompt_kernel_role_done
    s_mov_b32 s10, 1
    s_sub_u32 s11, s31, 16
standalone__memory_aug_recurrent_mem_tr__prompt_kernel_role_done:
    s_lshl_b32 s24, s11, 8
    s_or_b32 s24, s24, s10
    s_lshl_b32 s25, s16, 16
    s_or_b32 s24, s24, s25
    v_mov_b32 v2, s24
    v_mov_b32 v3, s18
    v_mov_b32 v5, 163824
    ds_write_b64 v5, v[2:3]
standalone__memory_aug_recurrent_mem_tr__prompt_kernel_role_known:
    s_waitcnt vmcnt(0) lgkmcnt(0)
    s_barrier
    v_mov_b32 v3, 163824
    ds_read_b64 v[4:5], v3
    s_waitcnt lgkmcnt(0)
    v_readfirstlane_b32 s24, v4
    v_readfirstlane_b32 s18, v5
    s_nop 1
    s_and_b32 s10, s24, 255
    s_bfe_u32 s11, s24, 0x80008
    s_lshr_b32 s16, s24, 16
    s_cmp_lg_u32 s9, 0
    s_cbranch_scc1 standalone__memory_aug_recurrent_mem_tr__prompt_kernel_published
    s_and_b32 s25, s2, 7
    s_lshr_b32 s26, s2, 3
    s_sub_u32 s27, s25, 1
    s_lshl_b32 s27, s27, 5
    s_cmp_eq_u32 s25, 0
    s_cselect_b32 s27, 224, s27
    s_add_u32 s27, s27, s26
    s_lshl_b32 s27, s27, 7
    s_add_u32 s27, s27, 57753600
    v_mov_b32 v2, s18
    v_mov_b32 v3, s27
    s_mov_b64 exec, 1
    buffer_store_dword v2, v3, s[4:7], 0 offen sc1
    s_mov_b64 exec, -1
standalone__memory_aug_recurrent_mem_tr__prompt_kernel_published:

    s_cmp_eq_u32 s10, 0
    s_cbranch_scc0 standalone__memory_aug_recurrent_mem_tr__prompt_kernel_n0
    s_cmp_eq_u32 s16, 0
    s_cbranch_scc1 sc0_start
    s_branch sc1_start
standalone__memory_aug_recurrent_mem_tr__prompt_kernel_n0:
    s_cmp_eq_u32 s10, 1
    s_cbranch_scc0 standalone__memory_aug_recurrent_mem_tr__prompt_kernel_n1
    s_cmp_eq_u32 s16, 0
    s_cbranch_scc1 va0_start
    s_branch va1_start
standalone__memory_aug_recurrent_mem_tr__prompt_kernel_n1:
    s_cmp_eq_u32 s10, 6
    s_cbranch_scc1 hp_start
    s_cmp_eq_u32 s10, 2
    s_cbranch_scc1 dp_start
    s_cmp_eq_u32 s10, 3
    s_cbranch_scc1 ts_start
    s_cmp_eq_u32 s10, 4
    s_cbranch_scc1 to_start
standalone__memory_aug_recurrent_mem_tr__prompt_kernel_end:
    s_endpgm
sc0_start:

    v_lshrrev_b32 v17, 4, v0
    v_and_b32 v18, 15, v0
    v_bfe_u32 v19, v0, 3, 1
    v_mul_u32_u24 v1, 0xaaaa, v19
    v_add_u32 v1, 0x4444, v1
    v_lshlrev_b32 v16, 4, v0
    s_lshl_b32 s24, s9, 1
    s_min_u32 s24, s24, 5
    s_lshl_b32 s25, s24, 10
    v_add_u32 v2, s25, v16
    v_add_u32 v3, 65536, v2
    s_lshl_b32 s50, s24, 11
    s_add_u32 s51, s50, 2048
    s_cmp_eq_u32 s9, 0
    s_cselect_b32 s25, 2, 0
    s_lshl_b32 s52, s25, 11
    s_add_u32 s53, s52, 2048
    s_lshl_b32 s25, s25, 10
    s_add_u32 s25, s25, 65536
    v_add_u32 v4, s25, v16
    s_cmp_lt_u32 s9, 2
    s_cselect_b32 s25, 4, 2
    s_lshl_b32 s54, s25, 11
    s_add_u32 s55, s54, 2048
    s_lshl_b32 s25, s25, 10
    s_add_u32 s25, s25, 65536
    v_add_u32 v5, s25, v16
    s_cmp_eq_u32 s9, 3
    s_cselect_b32 s25, 4, 6
    s_lshl_b32 s56, s25, 11
    s_lshl_b32 s25, s25, 10
    s_add_u32 s25, s25, 65536
    v_add_u32 v6, s25, v16
    s_lshl_b32 s24, s11, 2
    s_add_u32 s24, s24, s9
    s_mul_i32 s24, s24, 100352
    s_add_u32 s24, s24, 3932160

    s_mov_b32 s62, s24
    s_lshr_b32 s70, s50, 11
    s_lshr_b32 s71, s51, 11
    s_lshr_b32 s72, s52, 11
    s_lshr_b32 s73, s53, 11
    s_lshr_b32 s74, s54, 11
    s_lshr_b32 s75, s55, 11
    s_lshr_b32 s76, s56, 11
    s_mov_b32 s24, 224
    v_mbcnt_lo_u32_b32 v114, -1, 0
    v_mbcnt_hi_u32_b32 v114, -1, v114
    v_cmp_gt_u32 vcc, 32, v114
    v_add_u32 v114, s24, v114
    v_lshlrev_b32 v114, 7, v114
    v_add_u32 v114, 57753600, v114
    v_mov_b32 v112, 0x7fff0000
    v_cndmask_b32 v114, v112, v114, vcc
wm1:
    buffer_load_dword v112, v114, s[4:7], 0 offen sc1
    s_waitcnt vmcnt(0)
    v_cmp_eq_u32 s[80:81], s18, v112
    s_cmp_eq_u32 s80, -1
    s_cbranch_scc1 wm1_ok
    s_cmp_eq_u32 s17, 0
    s_cbranch_scc1 wm1_ok
    s_sub_u32 s17, s17, 1
    s_sleep 8
    s_branch wm1
wm1_ok:
    s_lshl_b32 s25, s9, 13
    s_mov_b32 s47, s25
    s_add_u32 s46, s25, 1835008
    s_mov_b32 m0, s47
    s_nop 0
    buffer_load_dwordx4 v16, s[4:7], s46 offen offset:0 sc1 lds
    buffer_load_dwordx4 v16, s[4:7], s46 offen offset:1024 sc1 lds
    buffer_load_dwordx4 v16, s[4:7], s46 offen offset:2048 sc1 lds
    buffer_load_dwordx4 v16, s[4:7], s46 offen offset:3072 sc1 lds
    s_add_u32 s24, s47, 4096
    s_mov_b32 m0, s24
    s_add_u32 s25, s46, 4096
    buffer_load_dwordx4 v16, s[4:7], s25 offen offset:0 sc1 lds
    buffer_load_dwordx4 v16, s[4:7], s25 offen offset:1024 sc1 lds
    buffer_load_dwordx4 v16, s[4:7], s25 offen offset:2048 sc1 lds
    buffer_load_dwordx4 v16, s[4:7], s25 offen offset:3072 sc1 lds
    s_add_u32 s46, s46, 32768
    s_xor_b32 s47, s47, 32768
    s_mul_i32 s24, s11, 14
    s_add_u32 s24, s24, 0
    v_mbcnt_lo_u32_b32 v114, -1, 0
    v_mbcnt_hi_u32_b32 v114, -1, v114
    v_cmp_gt_u32 vcc, 7, v114
    v_add_u32 v114, s24, v114
    v_lshlrev_b32 v114, 7, v114
    v_add_u32 v114, 57753600, v114
    v_mov_b32 v112, 0x7fff0000
    v_cndmask_b32 v114, v112, v114, vcc
    s_mov_b32 s89, 0
sl2:
    buffer_load_dword v112, v114, s[4:7], 0 offen sc1
    s_waitcnt vmcnt(0)
    v_cmp_eq_u32 s[80:81], s18, v112
    s_bitcmp1_b32 s89, 0
    s_cbranch_scc1 sl2_0
    s_bitcmp1_b32 s80, s70
    s_cbranch_scc0 sl2_0
    s_add_u32 s25, s62, s50
    buffer_load_dwordx4 a[0:3], v16, s[4:7], s25 offen sc1
    buffer_load_dwordx4 a[4:7], v16, s[4:7], s25 offen offset:1024 sc1
    s_add_u32 s25, s25, 14336
    buffer_load_dwordx4 a[56:59], v16, s[4:7], s25 offen sc1
    buffer_load_dwordx4 a[60:63], v16, s[4:7], s25 offen offset:1024 sc1
    s_add_u32 s25, s25, 14336
    buffer_load_dwordx4 a[112:115], v16, s[4:7], s25 offen sc1
    buffer_load_dwordx4 a[116:119], v16, s[4:7], s25 offen offset:1024 sc1
    s_add_u32 s25, s25, 14336
    buffer_load_dwordx4 a[168:171], v16, s[4:7], s25 offen sc1
    buffer_load_dwordx4 a[172:175], v16, s[4:7], s25 offen offset:1024 sc1
    s_add_u32 s25, s25, 14336
    buffer_load_dwordx4 a[224:227], v16, s[4:7], s25 offen sc1
    buffer_load_dwordx4 a[228:231], v16, s[4:7], s25 offen offset:1024 sc1
    s_add_u32 s25, s25, 14336
    buffer_load_dwordx4 v[144:147], v16, s[4:7], s25 offen sc1
    buffer_load_dwordx4 v[148:151], v16, s[4:7], s25 offen offset:1024 sc1
    s_add_u32 s25, s25, 14336
    buffer_load_dwordx4 v[200:203], v16, s[4:7], s25 offen sc1
    buffer_load_dwordx4 v[204:207], v16, s[4:7], s25 offen offset:1024 sc1
    s_bitset1_b32 s89, 0
sl2_0:
    s_bitcmp1_b32 s89, 1
    s_cbranch_scc1 sl2_1
    s_bitcmp1_b32 s80, s71
    s_cbranch_scc0 sl2_1
    s_add_u32 s25, s62, s51
    buffer_load_dwordx4 a[8:11], v16, s[4:7], s25 offen sc1
    buffer_load_dwordx4 a[12:15], v16, s[4:7], s25 offen offset:1024 sc1
    s_add_u32 s25, s25, 14336
    buffer_load_dwordx4 a[64:67], v16, s[4:7], s25 offen sc1
    buffer_load_dwordx4 a[68:71], v16, s[4:7], s25 offen offset:1024 sc1
    s_add_u32 s25, s25, 14336
    buffer_load_dwordx4 a[120:123], v16, s[4:7], s25 offen sc1
    buffer_load_dwordx4 a[124:127], v16, s[4:7], s25 offen offset:1024 sc1
    s_add_u32 s25, s25, 14336
    buffer_load_dwordx4 a[176:179], v16, s[4:7], s25 offen sc1
    buffer_load_dwordx4 a[180:183], v16, s[4:7], s25 offen offset:1024 sc1
    s_add_u32 s25, s25, 14336
    buffer_load_dwordx4 a[232:235], v16, s[4:7], s25 offen sc1
    buffer_load_dwordx4 a[236:239], v16, s[4:7], s25 offen offset:1024 sc1
    s_add_u32 s25, s25, 14336
    buffer_load_dwordx4 v[152:155], v16, s[4:7], s25 offen sc1
    buffer_load_dwordx4 v[156:159], v16, s[4:7], s25 offen offset:1024 sc1
    s_add_u32 s25, s25, 14336
    buffer_load_dwordx4 v[208:211], v16, s[4:7], s25 offen sc1
    buffer_load_dwordx4 v[212:215], v16, s[4:7], s25 offen offset:1024 sc1
    s_bitset1_b32 s89, 1
sl2_1:
    s_bitcmp1_b32 s89, 2
    s_cbranch_scc1 sl2_2
    s_bitcmp1_b32 s80, s72
    s_cbranch_scc0 sl2_2
    s_add_u32 s25, s62, s52
    buffer_load_dwordx4 a[16:19], v16, s[4:7], s25 offen sc1
    buffer_load_dwordx4 a[20:23], v16, s[4:7], s25 offen offset:1024 sc1
    s_add_u32 s25, s25, 14336
    buffer_load_dwordx4 a[72:75], v16, s[4:7], s25 offen sc1
    buffer_load_dwordx4 a[76:79], v16, s[4:7], s25 offen offset:1024 sc1
    s_add_u32 s25, s25, 14336
    buffer_load_dwordx4 a[128:131], v16, s[4:7], s25 offen sc1
    buffer_load_dwordx4 a[132:135], v16, s[4:7], s25 offen offset:1024 sc1
    s_add_u32 s25, s25, 14336
    buffer_load_dwordx4 a[184:187], v16, s[4:7], s25 offen sc1
    buffer_load_dwordx4 a[188:191], v16, s[4:7], s25 offen offset:1024 sc1
    s_add_u32 s25, s25, 14336
    buffer_load_dwordx4 a[240:243], v16, s[4:7], s25 offen sc1
    buffer_load_dwordx4 a[244:247], v16, s[4:7], s25 offen offset:1024 sc1
    s_add_u32 s25, s25, 14336
    buffer_load_dwordx4 v[160:163], v16, s[4:7], s25 offen sc1
    buffer_load_dwordx4 v[164:167], v16, s[4:7], s25 offen offset:1024 sc1
    s_add_u32 s25, s25, 14336
    buffer_load_dwordx4 v[216:219], v16, s[4:7], s25 offen sc1
    buffer_load_dwordx4 v[220:223], v16, s[4:7], s25 offen offset:1024 sc1
    s_bitset1_b32 s89, 2
sl2_2:
    s_bitcmp1_b32 s89, 3
    s_cbranch_scc1 sl2_3
    s_bitcmp1_b32 s80, s73
    s_cbranch_scc0 sl2_3
    s_add_u32 s25, s62, s53
    buffer_load_dwordx4 a[24:27], v16, s[4:7], s25 offen sc1
    buffer_load_dwordx4 a[28:31], v16, s[4:7], s25 offen offset:1024 sc1
    s_add_u32 s25, s25, 14336
    buffer_load_dwordx4 a[80:83], v16, s[4:7], s25 offen sc1
    buffer_load_dwordx4 a[84:87], v16, s[4:7], s25 offen offset:1024 sc1
    s_add_u32 s25, s25, 14336
    buffer_load_dwordx4 a[136:139], v16, s[4:7], s25 offen sc1
    buffer_load_dwordx4 a[140:143], v16, s[4:7], s25 offen offset:1024 sc1
    s_add_u32 s25, s25, 14336
    buffer_load_dwordx4 a[192:195], v16, s[4:7], s25 offen sc1
    buffer_load_dwordx4 a[196:199], v16, s[4:7], s25 offen offset:1024 sc1
    s_add_u32 s25, s25, 14336
    buffer_load_dwordx4 a[248:251], v16, s[4:7], s25 offen sc1
    buffer_load_dwordx4 a[252:255], v16, s[4:7], s25 offen offset:1024 sc1
    s_add_u32 s25, s25, 14336
    buffer_load_dwordx4 v[168:171], v16, s[4:7], s25 offen sc1
    buffer_load_dwordx4 v[172:175], v16, s[4:7], s25 offen offset:1024 sc1
    s_add_u32 s25, s25, 14336
    buffer_load_dwordx4 v[224:227], v16, s[4:7], s25 offen sc1
    buffer_load_dwordx4 v[228:231], v16, s[4:7], s25 offen offset:1024 sc1
    s_bitset1_b32 s89, 3
sl2_3:
    s_bitcmp1_b32 s89, 4
    s_cbranch_scc1 sl2_4
    s_bitcmp1_b32 s80, s74
    s_cbranch_scc0 sl2_4
    s_add_u32 s25, s62, s54
    buffer_load_dwordx4 a[32:35], v16, s[4:7], s25 offen sc1
    buffer_load_dwordx4 a[36:39], v16, s[4:7], s25 offen offset:1024 sc1
    s_add_u32 s25, s25, 14336
    buffer_load_dwordx4 a[88:91], v16, s[4:7], s25 offen sc1
    buffer_load_dwordx4 a[92:95], v16, s[4:7], s25 offen offset:1024 sc1
    s_add_u32 s25, s25, 14336
    buffer_load_dwordx4 a[144:147], v16, s[4:7], s25 offen sc1
    buffer_load_dwordx4 a[148:151], v16, s[4:7], s25 offen offset:1024 sc1
    s_add_u32 s25, s25, 14336
    buffer_load_dwordx4 a[200:203], v16, s[4:7], s25 offen sc1
    buffer_load_dwordx4 a[204:207], v16, s[4:7], s25 offen offset:1024 sc1
    s_add_u32 s25, s25, 14336
    buffer_load_dwordx4 v[120:123], v16, s[4:7], s25 offen sc1
    buffer_load_dwordx4 v[124:127], v16, s[4:7], s25 offen offset:1024 sc1
    s_add_u32 s25, s25, 14336
    buffer_load_dwordx4 v[176:179], v16, s[4:7], s25 offen sc1
    buffer_load_dwordx4 v[180:183], v16, s[4:7], s25 offen offset:1024 sc1
    s_add_u32 s25, s25, 14336
    buffer_load_dwordx4 v[232:235], v16, s[4:7], s25 offen sc1
    buffer_load_dwordx4 v[236:239], v16, s[4:7], s25 offen offset:1024 sc1
    s_bitset1_b32 s89, 4
sl2_4:
    s_bitcmp1_b32 s89, 5
    s_cbranch_scc1 sl2_5
    s_bitcmp1_b32 s80, s75
    s_cbranch_scc0 sl2_5
    s_add_u32 s25, s62, s55
    buffer_load_dwordx4 a[40:43], v16, s[4:7], s25 offen sc1
    buffer_load_dwordx4 a[44:47], v16, s[4:7], s25 offen offset:1024 sc1
    s_add_u32 s25, s25, 14336
    buffer_load_dwordx4 a[96:99], v16, s[4:7], s25 offen sc1
    buffer_load_dwordx4 a[100:103], v16, s[4:7], s25 offen offset:1024 sc1
    s_add_u32 s25, s25, 14336
    buffer_load_dwordx4 a[152:155], v16, s[4:7], s25 offen sc1
    buffer_load_dwordx4 a[156:159], v16, s[4:7], s25 offen offset:1024 sc1
    s_add_u32 s25, s25, 14336
    buffer_load_dwordx4 a[208:211], v16, s[4:7], s25 offen sc1
    buffer_load_dwordx4 a[212:215], v16, s[4:7], s25 offen offset:1024 sc1
    s_add_u32 s25, s25, 14336
    buffer_load_dwordx4 v[128:131], v16, s[4:7], s25 offen sc1
    buffer_load_dwordx4 v[132:135], v16, s[4:7], s25 offen offset:1024 sc1
    s_add_u32 s25, s25, 14336
    buffer_load_dwordx4 v[184:187], v16, s[4:7], s25 offen sc1
    buffer_load_dwordx4 v[188:191], v16, s[4:7], s25 offen offset:1024 sc1
    s_add_u32 s25, s25, 14336
    buffer_load_dwordx4 v[240:243], v16, s[4:7], s25 offen sc1
    buffer_load_dwordx4 v[244:247], v16, s[4:7], s25 offen offset:1024 sc1
    s_bitset1_b32 s89, 5
sl2_5:
    s_bitcmp1_b32 s89, 6
    s_cbranch_scc1 sl2_6
    s_bitcmp1_b32 s80, s76
    s_cbranch_scc0 sl2_6
    s_add_u32 s25, s62, s56
    buffer_load_dwordx4 a[48:51], v16, s[4:7], s25 offen sc1
    buffer_load_dwordx4 a[52:55], v16, s[4:7], s25 offen offset:1024 sc1
    s_add_u32 s25, s25, 14336
    buffer_load_dwordx4 a[104:107], v16, s[4:7], s25 offen sc1
    buffer_load_dwordx4 a[108:111], v16, s[4:7], s25 offen offset:1024 sc1
    s_add_u32 s25, s25, 14336
    buffer_load_dwordx4 a[160:163], v16, s[4:7], s25 offen sc1
    buffer_load_dwordx4 a[164:167], v16, s[4:7], s25 offen offset:1024 sc1
    s_add_u32 s25, s25, 14336
    buffer_load_dwordx4 a[216:219], v16, s[4:7], s25 offen sc1
    buffer_load_dwordx4 a[220:223], v16, s[4:7], s25 offen offset:1024 sc1
    s_add_u32 s25, s25, 14336
    buffer_load_dwordx4 v[136:139], v16, s[4:7], s25 offen sc1
    buffer_load_dwordx4 v[140:143], v16, s[4:7], s25 offen offset:1024 sc1
    s_add_u32 s25, s25, 14336
    buffer_load_dwordx4 v[192:195], v16, s[4:7], s25 offen sc1
    buffer_load_dwordx4 v[196:199], v16, s[4:7], s25 offen offset:1024 sc1
    s_add_u32 s25, s25, 14336
    buffer_load_dwordx4 v[248:251], v16, s[4:7], s25 offen sc1
    buffer_load_dwordx4 v[252:255], v16, s[4:7], s25 offen offset:1024 sc1
    s_bitset1_b32 s89, 6
sl2_6:
    s_cmp_eq_u32 s89, 127
    s_cbranch_scc1 sl2_ok
    s_cmp_eq_u32 s17, 0
    s_cbranch_scc1 sl2_ok
    s_sub_u32 s17, s17, 1
    s_sleep 8
    s_branch sl2
sl2_ok:

    s_lshl_b32 s25, s9, 13
    v_add_u32 v7, s25, v16
    v_and_b32 v19, 7, v18
    v_lshlrev_b32 v19, 4, v19
    v_add_u32 v19, 65536, v19
    s_mul_i32 s25, s9, 1792
    v_add_u32 v19, s25, v19
    v_lshrrev_b32 v112, 1, v17
    v_and_b32 v113, 1, v17
    v_lshlrev_b32 v114, 8, v112
    v_lshlrev_b32 v115, 3, v113
    v_add3_u32 v8, v19, v114, v115
    v_lshlrev_b32 v114, 3, v112
    v_add_u32 v114, 1024, v114
    v_lshlrev_b32 v115, 2, v112
    v_add_u32 v115, 1536, v115
    v_cmp_eq_u32 vcc, 1, v113
    s_nop 1
    v_cndmask_b32 v116, v114, v115, vcc
    v_add_u32 v9, v19, v116
    v_mov_b32 v116, 4
    v_mov_b32 v117, 128
    v_cndmask_b32 v116, v116, v117, vcc
    v_add_u32 v10, v9, v116
    v_add_u32 v114, 256, v114
    v_add_u32 v115, 8, v115
    v_cndmask_b32 v117, v114, v115, vcc
    v_add_u32 v11, v19, v117
    v_add_u32 v12, v11, v116
    v_lshlrev_b32 v114, 2, v113
    v_lshl_add_u32 v114, v112, 1, v114
    v_lshlrev_b32 v114, 6, v114
    v_add_u32 v114, v114, v18
    s_lshl_b32 s25, s9, 9
    v_add_u32 v114, s25, v114
    v_lshlrev_b32 v114, 2, v114
    v_add_u32 v13, 73728, v114
    v_lshrrev_b32 v114, 5, v0
    s_lshl_b32 s25, s9, 1
    v_add_u32 v114, s25, v114
    v_and_b32 v115, 31, v0
    v_lshlrev_b32 v116, 1, v115
    v_add_u32 v117, 8, v116
    v_cmp_gt_u32 vcc, 4, v115
    s_nop 1
    v_cndmask_b32 v117, v117, v116, vcc
    v_mov_b32 v118, 48
    v_cmp_gt_u32 vcc, 20, v115
    s_nop 1
    v_cndmask_b32 v117, v118, v117, vcc
    v_lshlrev_b32 v118, 6, v114
    v_add_u32 v118, v118, v117
    v_lshlrev_b32 v118, 2, v118
    v_add_u32 v14, 73728, v118
    v_lshlrev_b32 v118, 4, v114
    v_and_b32 v119, 3, v115
    v_lshl_add_u32 v118, v119, 2, v118
    v_lshrrev_b32 v119, 2, v115
    v_lshl_add_u32 v118, v119, 7, v118
    v_mov_b32 v119, 0x7fff0000
    v_cndmask_b32 v15, v119, v118, vcc
    v_mov_b32 v118, 0x7f800000
    v_mov_b32 v119, 0x42700000
    v_cndmask_b32 v17, v118, v119, vcc
    v_and_b32 v114, 7, v18
    v_lshlrev_b32 v115, 2, v113
    v_sub_u32 v114, v114, v115
    v_and_b32 v115, 1, v114
    v_mov_b32 v116, 0x3f80
    v_mov_b32 v117, 0x3f800000
    v_cmp_eq_u32 vcc, 1, v115
    s_nop 1
    v_cndmask_b32 v116, v116, v117, vcc
    v_lshrrev_b32 v115, 1, v114
    v_lshrrev_b32 v117, 3, v18
    v_lshlrev_b32 v117, 1, v117
    v_add_u32 v117, v117, v115
    v_cmp_gt_u32 vcc, 4, v114
    v_mov_b32 v115, 99
    s_nop 0
    v_cndmask_b32 v117, v115, v117, vcc

    v_cmp_eq_u32 vcc, 0, v117
    s_nop 1
    v_cndmask_b32 v20, 0, v116, vcc
    v_cmp_eq_u32 vcc, 1, v117
    s_nop 1
    v_cndmask_b32 v21, 0, v116, vcc
    v_cmp_eq_u32 vcc, 2, v117
    s_nop 1
    v_cndmask_b32 v22, 0, v116, vcc
    v_cmp_eq_u32 vcc, 3, v117
    s_nop 1
    v_cndmask_b32 v23, 0, v116, vcc

    v_mov_b32 v114, 0
    v_mov_b32 v115, 0
    v_lshlrev_b32 v116, 3, v0
    v_add_u32 v116, 72704, v116
    ds_write_b64 v116, v[114:115]
    v_lshrrev_b32 v116, 3, v0
    v_lshlrev_b32 v116, 6, v116
    v_and_b32 v117, 7, v0
    v_lshlrev_b32 v117, 1, v117
    v_add3_u32 v116, v116, v117, 48
    s_lshl_b32 s25, s9, 9
    v_add_u32 v116, s25, v116
    v_lshlrev_b32 v116, 2, v116
    v_add_u32 v116, 73728, v116
    s_cmp_eq_u32 s9, 0
    s_cselect_b32 s25, 0xff800000, 0
    v_mov_b32 v114, s25
    v_mov_b32 v115, s25
    ds_write_b64 v116, v[114:115]
    s_mov_b32 s48, 1035512379
    s_mov_b32 s49, 1035512379
    s_mov_b32 s8, 0
    s_mov_b32 s44, 16777216
    s_mul_i32 s45, s11, 640
    s_add_u32 s45, s45, 17711104
    s_waitcnt vmcnt(0) lgkmcnt(0)
    s_barrier

    v_mov_b32 v52, 0
    v_mov_b32 v53, 0
    v_mov_b32 v54, 0
    v_mov_b32 v55, 0
    v_mov_b32 v56, 0
    v_mov_b32 v57, 0
    v_mov_b32 v58, 0
    v_mov_b32 v59, 0
    v_mov_b32 v60, 0
    v_mov_b32 v61, 0
    v_mov_b32 v62, 0
    v_mov_b32 v63, 0
    v_mov_b32 v64, 0
    v_mov_b32 v65, 0
    v_mov_b32 v66, 0
    v_mov_b32 v67, 0
    v_mov_b32 v68, 0
    v_mov_b32 v69, 0
    v_mov_b32 v70, 0
    v_mov_b32 v71, 0
    v_mov_b32 v72, 0
    v_mov_b32 v73, 0
    v_mov_b32 v74, 0
    v_mov_b32 v75, 0
    v_mov_b32 v76, 0
    v_mov_b32 v77, 0
    v_mov_b32 v78, 0
    v_mov_b32 v79, 0
    v_mov_b32 v84, 0
    v_mov_b32 v85, 0
    v_mov_b32 v86, 0
    v_mov_b32 v87, 0
    v_mov_b32 v88, 0
    v_mov_b32 v89, 0
    v_mov_b32 v90, 0
    v_mov_b32 v91, 0
    v_mov_b32 v92, 0
    v_mov_b32 v93, 0
    v_mov_b32 v94, 0
    v_mov_b32 v95, 0
sc0_loop:
    buffer_load_dwordx4 v[24:27], v2, s[4:7], s44 offen sc1
    buffer_load_dwordx4 v[28:31], v2, s[4:7], s44 offen offset:1024 sc1
    buffer_load_dwordx4 v[96:99], v2, s[4:7], s44 offen sc1
    buffer_load_dwordx4 v[100:103], v2, s[4:7], s44 offen offset:1024 sc1
sc0_poll:
    s_waitcnt vmcnt(2)
    v_max3_u32 v112, v24, v25, v26
    v_max3_u32 v113, v27, v28, v29
    v_max3_u32 v112, v112, v30, v31
    v_max_u32 v112, v112, v113
    v_cmp_eq_u32 vcc, -1, v112
    s_cbranch_vccnz sc0_notA
sc0_goA:
    v_smfmac_f32_16x16x64_bf16 v[52:55], v[24:27], a[0:7], v1
    ds_write_b128 v3, v[24:27]
    v_smfmac_f32_16x16x64_bf16 v[56:59], v[24:27], a[56:63], v1
    ds_write_b128 v3, v[28:31] offset:1024
    v_smfmac_f32_16x16x64_bf16 v[60:63], v[24:27], a[112:119], v1
    v_smfmac_f32_16x16x64_bf16 v[64:67], v[24:27], a[168:175], v1
    v_smfmac_f32_16x16x64_bf16 v[68:71], v[24:27], a[224:231], v1
    v_smfmac_f32_16x16x64_bf16 v[72:75], v[24:27], v[144:151], v1
    v_smfmac_f32_16x16x64_bf16 v[76:79], v[24:27], v[200:207], v1
    v_smfmac_f32_16x16x64_bf16 v[52:55], v[28:31], a[8:15], v1
    v_smfmac_f32_16x16x64_bf16 v[56:59], v[28:31], a[64:71], v1
    s_waitcnt lgkmcnt(0)
    s_barrier
    ds_read_b128 v[32:35], v4
    ds_read_b128 v[36:39], v4 offset:1024
    v_smfmac_f32_16x16x64_bf16 v[60:63], v[28:31], a[120:127], v1
    ds_read_b128 v[40:43], v5
    ds_read_b128 v[44:47], v5 offset:1024
    v_smfmac_f32_16x16x64_bf16 v[64:67], v[28:31], a[176:183], v1
    ds_read_b128 v[48:51], v6
    v_smfmac_f32_16x16x64_bf16 v[68:71], v[28:31], a[232:239], v1
    v_smfmac_f32_16x16x64_bf16 v[72:75], v[28:31], v[152:159], v1
    v_smfmac_f32_16x16x64_bf16 v[76:79], v[28:31], v[208:215], v1
sc0_p2:
    s_waitcnt lgkmcnt(4)
    v_smfmac_f32_16x16x64_bf16 v[52:55], v[32:35], a[16:23], v1
    v_smfmac_f32_16x16x64_bf16 v[56:59], v[32:35], a[72:79], v1
    s_waitcnt lgkmcnt(3)
    v_smfmac_f32_16x16x64_bf16 v[52:55], v[36:39], a[24:31], v1
    v_smfmac_f32_16x16x64_bf16 v[56:59], v[36:39], a[80:87], v1
    s_waitcnt lgkmcnt(2)
    v_smfmac_f32_16x16x64_bf16 v[52:55], v[40:43], a[32:39], v1
    v_smfmac_f32_16x16x64_bf16 v[56:59], v[40:43], a[88:95], v1
    s_waitcnt lgkmcnt(1)
    v_smfmac_f32_16x16x64_bf16 v[52:55], v[44:47], a[40:47], v1
    v_smfmac_f32_16x16x64_bf16 v[56:59], v[44:47], a[96:103], v1
    s_waitcnt lgkmcnt(0)
    v_smfmac_f32_16x16x64_bf16 v[52:55], v[48:51], a[48:55], v1
    v_smfmac_f32_16x16x64_bf16 v[56:59], v[48:51], a[104:111], v1
    s_waitcnt vmcnt(0)
    ds_read_b128 v[96:99], v7 offset:0
    v_smfmac_f32_16x16x64_bf16 v[60:63], v[32:35], a[128:135], v1
    ds_read_b128 v[100:103], v7 offset:1024
    v_cvt_pk_bf16_f32 v80, v52, v53
    v_smfmac_f32_16x16x64_bf16 v[60:63], v[36:39], a[136:143], v1
    ds_read_b128 v[104:107], v7 offset:2048
    v_cvt_pk_bf16_f32 v81, v54, v55
    v_smfmac_f32_16x16x64_bf16 v[60:63], v[40:43], a[144:151], v1
    ds_read_b128 v[108:111], v7 offset:3072
    v_cvt_pk_bf16_f32 v82, v56, v57
    v_smfmac_f32_16x16x64_bf16 v[60:63], v[44:47], a[152:159], v1
    ds_read2_b32 v[24:25], v8 offset0:0 offset1:32
    v_cvt_pk_bf16_f32 v83, v58, v59
    v_smfmac_f32_16x16x64_bf16 v[60:63], v[48:51], a[160:167], v1
    v_mfma_f32_16x16x32_bf16 v[52:55], v[80:83], v[20:23], 0
    v_smfmac_f32_16x16x64_bf16 v[64:67], v[32:35], a[184:191], v1
    ds_read2_b32 v[26:27], v8 offset0:1 offset1:33
    v_smfmac_f32_16x16x64_bf16 v[64:67], v[36:39], a[192:199], v1
    ds_read2_b32 v[28:29], v8 offset0:128 offset1:160
    v_cvt_pk_bf16_f32 v56, v52, v53
    v_smfmac_f32_16x16x64_bf16 v[64:67], v[40:43], a[200:207], v1
    ds_read2_b32 v[30:31], v8 offset0:129 offset1:161
    v_cvt_pk_bf16_f32 v57, v54, v55
    v_smfmac_f32_16x16x64_bf16 v[64:67], v[44:47], a[208:215], v1
    v_cvt_pk_bf16_f32 v80, v60, v61
    v_smfmac_f32_16x16x64_bf16 v[64:67], v[48:51], a[216:223], v1
    v_cvt_pk_bf16_f32 v81, v62, v63
    v_smfmac_f32_16x16x64_bf16 v[68:71], v[32:35], a[240:247], v1
    v_smfmac_f32_16x16x64_bf16 v[68:71], v[36:39], a[248:255], v1
    v_cvt_pk_bf16_f32 v82, v64, v65
    v_smfmac_f32_16x16x64_bf16 v[68:71], v[40:43], v[120:127], v1
    v_cvt_pk_bf16_f32 v83, v66, v67
    v_smfmac_f32_16x16x64_bf16 v[68:71], v[44:47], v[128:135], v1
    s_waitcnt lgkmcnt(0)
    v_mfma_f32_16x16x32_bf16 v[60:63], v[80:83], v[20:23], 0
    v_smfmac_f32_16x16x64_bf16 v[68:71], v[48:51], v[136:143], v1
    ds_read2_b32 v[64:65], v11 offset0:0 offset1:32
    v_smfmac_f32_16x16x64_bf16 v[72:75], v[32:35], v[160:167], v1
    ds_read2_b32 v[66:67], v12 offset0:0 offset1:32
    v_cvt_pk_bf16_f32 v58, v60, v61
    v_smfmac_f32_16x16x64_bf16 v[72:75], v[36:39], v[168:175], v1
    v_cvt_pk_bf16_f32 v59, v62, v63
    v_smfmac_f32_16x16x64_bf16 v[72:75], v[40:43], v[176:183], v1
    ds_read2_b32 v[60:61], v9 offset0:0 offset1:32
    v_cvt_pk_bf16_f32 v80, v68, v69
    v_smfmac_f32_16x16x64_bf16 v[72:75], v[44:47], v[184:191], v1
    ds_read2_b32 v[62:63], v10 offset0:0 offset1:32
    v_cvt_pk_bf16_f32 v81, v70, v71
    v_smfmac_f32_16x16x64_bf16 v[72:75], v[48:51], v[192:199], v1
    v_smfmac_f32_16x16x64_bf16 v[76:79], v[32:35], v[216:223], v1
    ds_read_b128 v[32:35], v7 offset:4096
    v_smfmac_f32_16x16x64_bf16 v[76:79], v[36:39], v[224:231], v1
    ds_read_b128 v[36:39], v7 offset:5120
    v_cvt_pk_bf16_f32 v82, v72, v73
    v_smfmac_f32_16x16x64_bf16 v[76:79], v[40:43], v[232:239], v1
    ds_read_b128 v[40:43], v7 offset:6144
    v_cvt_pk_bf16_f32 v83, v74, v75
    v_smfmac_f32_16x16x64_bf16 v[76:79], v[44:47], v[240:247], v1
    ds_read_b128 v[44:47], v7 offset:7168
    v_smfmac_f32_16x16x64_bf16 v[76:79], v[48:51], v[248:255], v1
    v_mfma_f32_16x16x32_bf16 v[68:71], v[80:83], v[20:23], 0
    v_smfmac_f32_16x16x64_bf16 v[88:91], v[56:59], v[96:103], v1
    v_cvt_pk_bf16_f32 v112, v76, v77
    v_cvt_pk_bf16_f32 v113, v78, v79
    v_smfmac_f32_16x16x64_bf16 v[92:95], v[56:59], v[104:111], v1
    v_cvt_pk_bf16_f32 v52, v68, v69
    v_cvt_pk_bf16_f32 v53, v70, v71
    v_mfma_f32_16x16x16_bf16 v[76:79], v[112:113], v[20:21], 0
    v_smfmac_f32_16x16x64_bf16 v[84:87], v[56:59], v[24:31], v1
    s_nop 3
    v_cvt_pk_bf16_f32 v54, v76, v77
    v_cvt_pk_bf16_f32 v55, v78, v79
    s_waitcnt lgkmcnt(0)
    s_nop 0
    v_smfmac_f32_16x16x64_bf16 v[88:91], v[52:55], v[32:39], v1
    v_smfmac_f32_16x16x64_bf16 v[92:95], v[52:55], v[40:47], v1
    v_smfmac_f32_16x16x64_bf16 v[84:87], v[52:55], v[60:67], v1
    v_permlane32_swap_b32 v88, v90
    v_permlane32_swap_b32 v89, v91
    v_pk_add_f32 v[88:89], v[88:89], v[90:91]
    ds_write2_b32 v13, v88, v89 offset0:16 offset1:80
    v_permlane32_swap_b32 v92, v94
    v_permlane32_swap_b32 v93, v95
    v_pk_add_f32 v[92:93], v[92:93], v[94:95]
    ds_write2_b32 v13, v92, v93 offset0:32 offset1:96
    v_permlane32_swap_b32 v84, v86
    v_permlane32_swap_b32 v85, v87
    v_pk_add_f32 v[84:85], v[84:85], v[86:87]
    ds_write2_b32 v13, v84, v85 offset0:0 offset1:64
    s_waitcnt lgkmcnt(0)
    s_barrier
    ds_read2st64_b64 v[24:27], v14 offset0:0 offset1:4
    ds_read2st64_b64 v[28:31], v14 offset0:8 offset1:12
    s_waitcnt lgkmcnt(0)
    v_pk_add_f32 v[24:25], v[24:25], v[26:27]
    v_pk_add_f32 v[28:29], v[28:29], v[30:31]
    v_pk_add_f32 v[24:25], v[24:25], v[28:29]
    v_pk_mul_f32 v[24:25], v[24:25], s[48:49]
    v_exp_f32 v28, v24
    v_exp_f32 v29, v25
    v_max_f32 v27, |v24|, |v25|
    v_cmp_gt_f32 vcc, v27, v17
    v_add_f32 v26, v28, v29
    s_nop 1
    v_add_f32_dpp v26, v26, v26 row_ror:8 row_mask:0xf bank_mask:0xf
    s_nop 1
    v_add_f32_dpp v26, v26, v26 row_ror:4 row_mask:0xf bank_mask:0xf
    s_nop 1
    v_add_f32_dpp v26, v26, v26 row_ror:2 row_mask:0xf bank_mask:0xf
    s_nop 1
    v_add_f32_dpp v26, v26, v26 row_ror:1 row_mask:0xf bank_mask:0xf
    v_mov_b32 v27, v26
    s_nop 1
    v_permlane16_swap_b32 v26, v27
    v_add_f32 v26, v26, v27
    s_cbranch_vccnz sc0_sm_slow
sc0_sm_back:
    v_rcp_f32 v26, v26
    s_nop 0
    v_pk_mul_f32 v[28:29], v[28:29], v[26:27] op_sel_hi:[1,0]
    v_cvt_pk_bf16_f32 v24, v28, v29
    buffer_store_dword v24, v15, s[4:7], s45 offen
    s_mov_b32 m0, s47
    s_nop 0
    buffer_load_dwordx4 v16, s[4:7], s46 offen offset:0 sc1 lds
    buffer_load_dwordx4 v16, s[4:7], s46 offen offset:1024 sc1 lds
    buffer_load_dwordx4 v16, s[4:7], s46 offen offset:2048 sc1 lds
    buffer_load_dwordx4 v16, s[4:7], s46 offen offset:3072 sc1 lds
    s_add_u32 s24, s47, 4096
    s_mov_b32 m0, s24
    s_add_u32 s25, s46, 4096
    buffer_load_dwordx4 v16, s[4:7], s25 offen offset:0 sc1 lds
    buffer_load_dwordx4 v16, s[4:7], s25 offen offset:1024 sc1 lds
    buffer_load_dwordx4 v16, s[4:7], s25 offen offset:2048 sc1 lds
    buffer_load_dwordx4 v16, s[4:7], s25 offen offset:3072 sc1 lds
    v_mov_b32 v52, 0
    v_mov_b32 v53, 0
    v_mov_b32 v54, 0
    v_mov_b32 v55, 0
    v_mov_b32 v56, 0
    v_mov_b32 v57, 0
    v_mov_b32 v58, 0
    v_mov_b32 v59, 0
    v_mov_b32 v60, 0
    v_mov_b32 v61, 0
    v_mov_b32 v62, 0
    v_mov_b32 v63, 0
    v_mov_b32 v64, 0
    v_mov_b32 v65, 0
    v_mov_b32 v66, 0
    v_mov_b32 v67, 0
    v_mov_b32 v68, 0
    v_mov_b32 v69, 0
    v_mov_b32 v70, 0
    v_mov_b32 v71, 0
    v_mov_b32 v72, 0
    v_mov_b32 v73, 0
    v_mov_b32 v74, 0
    v_mov_b32 v75, 0
    v_mov_b32 v76, 0
    v_mov_b32 v77, 0
    v_mov_b32 v78, 0
    v_mov_b32 v79, 0
    v_mov_b32 v84, 0
    v_mov_b32 v85, 0
    v_mov_b32 v86, 0
    v_mov_b32 v87, 0
    v_mov_b32 v88, 0
    v_mov_b32 v89, 0
    v_mov_b32 v90, 0
    v_mov_b32 v91, 0
    v_mov_b32 v92, 0
    v_mov_b32 v93, 0
    v_mov_b32 v94, 0
    v_mov_b32 v95, 0
    s_add_u32 s8, s8, 1
    s_add_u32 s44, s44, 7168
    s_add_u32 s45, s45, 10240
    s_add_u32 s46, s46, 32768
    s_xor_b32 s47, s47, 32768
    v_xor_b32 v7, 32768, v7
    s_cmp_lt_u32 s8, 63
    s_cbranch_scc1 sc0_loop
    s_endpgm
sc0_notA:
    buffer_load_dwordx4 v[24:27], v2, s[4:7], s44 offen sc1
    buffer_load_dwordx4 v[28:31], v2, s[4:7], s44 offen offset:1024 sc1
    s_waitcnt vmcnt(2)
    v_max3_u32 v112, v96, v97, v98
    v_max3_u32 v113, v99, v100, v101
    v_max3_u32 v112, v112, v102, v103
    v_max_u32 v112, v112, v113
    v_cmp_eq_u32 vcc, -1, v112
    s_cbranch_vccz sc0_goB
    s_cmp_eq_u32 s17, 0
    s_cbranch_scc1 sc0_goB
    s_sub_u32 s17, s17, 1
    buffer_load_dwordx4 v[96:99], v2, s[4:7], s44 offen sc1
    buffer_load_dwordx4 v[100:103], v2, s[4:7], s44 offen offset:1024 sc1
    s_branch sc0_poll
sc0_goB:
    v_smfmac_f32_16x16x64_bf16 v[52:55], v[96:99], a[0:7], v1
    ds_write_b128 v3, v[96:99]
    v_smfmac_f32_16x16x64_bf16 v[56:59], v[96:99], a[56:63], v1
    ds_write_b128 v3, v[100:103] offset:1024
    v_smfmac_f32_16x16x64_bf16 v[60:63], v[96:99], a[112:119], v1
    v_smfmac_f32_16x16x64_bf16 v[64:67], v[96:99], a[168:175], v1
    v_smfmac_f32_16x16x64_bf16 v[68:71], v[96:99], a[224:231], v1
    v_smfmac_f32_16x16x64_bf16 v[72:75], v[96:99], v[144:151], v1
    v_smfmac_f32_16x16x64_bf16 v[76:79], v[96:99], v[200:207], v1
    v_smfmac_f32_16x16x64_bf16 v[52:55], v[100:103], a[8:15], v1
    v_smfmac_f32_16x16x64_bf16 v[56:59], v[100:103], a[64:71], v1
    s_waitcnt lgkmcnt(0)
    s_barrier
    ds_read_b128 v[32:35], v4
    ds_read_b128 v[36:39], v4 offset:1024
    v_smfmac_f32_16x16x64_bf16 v[60:63], v[100:103], a[120:127], v1
    ds_read_b128 v[40:43], v5
    ds_read_b128 v[44:47], v5 offset:1024
    v_smfmac_f32_16x16x64_bf16 v[64:67], v[100:103], a[176:183], v1
    ds_read_b128 v[48:51], v6
    v_smfmac_f32_16x16x64_bf16 v[68:71], v[100:103], a[232:239], v1
    v_smfmac_f32_16x16x64_bf16 v[72:75], v[100:103], v[152:159], v1
    v_smfmac_f32_16x16x64_bf16 v[76:79], v[100:103], v[208:215], v1
    s_branch sc0_p2
sc0_sm_slow:
    v_max_f32 v26, v24, v25
    s_nop 1
    v_max_f32_dpp v26, v26, v26 row_ror:8 row_mask:0xf bank_mask:0xf
    s_nop 1
    v_max_f32_dpp v26, v26, v26 row_ror:4 row_mask:0xf bank_mask:0xf
    s_nop 1
    v_max_f32_dpp v26, v26, v26 row_ror:2 row_mask:0xf bank_mask:0xf
    s_nop 1
    v_max_f32_dpp v26, v26, v26 row_ror:1 row_mask:0xf bank_mask:0xf
    v_mov_b32 v27, v26
    s_nop 1
    v_permlane16_swap_b32 v26, v27
    v_max_f32 v26, v26, v27
    v_sub_f32 v24, v24, v26
    v_sub_f32 v25, v25, v26
    v_exp_f32 v28, v24
    v_exp_f32 v29, v25
    s_nop 0
    v_add_f32 v26, v28, v29
    s_nop 1
    v_add_f32_dpp v26, v26, v26 row_ror:8 row_mask:0xf bank_mask:0xf
    s_nop 1
    v_add_f32_dpp v26, v26, v26 row_ror:4 row_mask:0xf bank_mask:0xf
    s_nop 1
    v_add_f32_dpp v26, v26, v26 row_ror:2 row_mask:0xf bank_mask:0xf
    s_nop 1
    v_add_f32_dpp v26, v26, v26 row_ror:1 row_mask:0xf bank_mask:0xf
    v_mov_b32 v27, v26
    s_nop 1
    v_permlane16_swap_b32 v26, v27
    v_add_f32 v26, v26, v27
    s_branch sc0_sm_back
va0_start:

    v_lshrrev_b32 v16, 4, v0
    v_and_b32 v17, 15, v0
    v_bfe_u32 v18, v0, 3, 1
    v_mul_u32_u24 v1, 0xaaaa, v18
    v_add_u32 v1, 0x4444, v1
    v_lshlrev_b32 v13, 4, v0
    s_lshl_b32 s24, s9, 1
    s_min_u32 s24, s24, 5
    s_lshl_b32 s25, s24, 10
    v_add_u32 v2, s25, v13
    v_add_u32 v3, 98304, v2
    v_add_u32 v4, 98304, v13
    s_lshl_b32 s25, s9, 13
    v_add_u32 v6, s25, v13
    v_add_u32 v5, 65536, v6
    s_lshl_b32 s24, s11, 4
    s_lshl_b32 s25, s9, 2
    s_add_u32 s24, s24, s25
    s_mul_i32 s24, s24, 28672
    s_add_u32 s24, s24, 10354688

    s_mov_b32 s62, s24
    v_mbcnt_lo_u32_b32 v38, -1, 0
    v_mbcnt_hi_u32_b32 v38, -1, v38
    v_mul_u32_u24 v37, 37, v38
    v_lshrrev_b32 v37, 8, v37
    v_mul_u32_u24 v37, 7, v37
    v_cmp_gt_u32 vcc, 28, v38
    v_add_u32 v38, v38, v37
    s_mul_i32 s24, s9, 56
    s_add_u32 s24, s24, 7
    v_add_u32 v38, s24, v38
    v_lshlrev_b32 v38, 7, v38
    v_add_u32 v38, 57753600, v38
    v_mov_b32 v37, 0x7fff0000
    v_cndmask_b32 v38, v37, v38, vcc
    s_mov_b32 s89, 0
sl3:
    buffer_load_dword v36, v38, s[4:7], 0 offen sc1
    s_waitcnt vmcnt(0)
    v_cmp_eq_u32 s[80:81], s18, v36
    s_bitcmp1_b32 s89, 0
    s_cbranch_scc1 sl3_0
    s_bitcmp1_b32 s80, 0
    s_cbranch_scc0 sl3_0
    s_add_u32 s26, s62, 0
    buffer_load_dwordx4 a[0:3], v13, s[4:7], s26 offen sc1
    buffer_load_dwordx4 a[4:7], v13, s[4:7], s26 offen offset:1024 sc1
    s_add_u32 s26, s62, 14336
    buffer_load_dwordx4 a[56:59], v13, s[4:7], s26 offen sc1
    buffer_load_dwordx4 a[60:63], v13, s[4:7], s26 offen offset:1024 sc1
    s_bitset1_b32 s89, 0
sl3_0:
    s_bitcmp1_b32 s89, 1
    s_cbranch_scc1 sl3_1
    s_bitcmp1_b32 s80, 1
    s_cbranch_scc0 sl3_1
    s_add_u32 s26, s62, 2048
    buffer_load_dwordx4 a[8:11], v13, s[4:7], s26 offen sc1
    buffer_load_dwordx4 a[12:15], v13, s[4:7], s26 offen offset:1024 sc1
    s_add_u32 s26, s62, 16384
    buffer_load_dwordx4 a[64:67], v13, s[4:7], s26 offen sc1
    buffer_load_dwordx4 a[68:71], v13, s[4:7], s26 offen offset:1024 sc1
    s_bitset1_b32 s89, 1
sl3_1:
    s_bitcmp1_b32 s89, 2
    s_cbranch_scc1 sl3_2
    s_bitcmp1_b32 s80, 2
    s_cbranch_scc0 sl3_2
    s_add_u32 s26, s62, 4096
    buffer_load_dwordx4 a[16:19], v13, s[4:7], s26 offen sc1
    buffer_load_dwordx4 a[20:23], v13, s[4:7], s26 offen offset:1024 sc1
    s_add_u32 s26, s62, 18432
    buffer_load_dwordx4 a[72:75], v13, s[4:7], s26 offen sc1
    buffer_load_dwordx4 a[76:79], v13, s[4:7], s26 offen offset:1024 sc1
    s_bitset1_b32 s89, 2
sl3_2:
    s_bitcmp1_b32 s89, 3
    s_cbranch_scc1 sl3_3
    s_bitcmp1_b32 s80, 3
    s_cbranch_scc0 sl3_3
    s_add_u32 s26, s62, 6144
    buffer_load_dwordx4 a[24:27], v13, s[4:7], s26 offen sc1
    buffer_load_dwordx4 a[28:31], v13, s[4:7], s26 offen offset:1024 sc1
    s_add_u32 s26, s62, 20480
    buffer_load_dwordx4 a[80:83], v13, s[4:7], s26 offen sc1
    buffer_load_dwordx4 a[84:87], v13, s[4:7], s26 offen offset:1024 sc1
    s_bitset1_b32 s89, 3
sl3_3:
    s_bitcmp1_b32 s89, 4
    s_cbranch_scc1 sl3_4
    s_bitcmp1_b32 s80, 4
    s_cbranch_scc0 sl3_4
    s_add_u32 s26, s62, 8192
    buffer_load_dwordx4 a[32:35], v13, s[4:7], s26 offen sc1
    buffer_load_dwordx4 a[36:39], v13, s[4:7], s26 offen offset:1024 sc1
    s_add_u32 s26, s62, 22528
    buffer_load_dwordx4 a[88:91], v13, s[4:7], s26 offen sc1
    buffer_load_dwordx4 a[92:95], v13, s[4:7], s26 offen offset:1024 sc1
    s_bitset1_b32 s89, 4
sl3_4:
    s_bitcmp1_b32 s89, 5
    s_cbranch_scc1 sl3_5
    s_bitcmp1_b32 s80, 5
    s_cbranch_scc0 sl3_5
    s_add_u32 s26, s62, 10240
    buffer_load_dwordx4 a[40:43], v13, s[4:7], s26 offen sc1
    buffer_load_dwordx4 a[44:47], v13, s[4:7], s26 offen offset:1024 sc1
    s_add_u32 s26, s62, 24576
    buffer_load_dwordx4 a[96:99], v13, s[4:7], s26 offen sc1
    buffer_load_dwordx4 a[100:103], v13, s[4:7], s26 offen offset:1024 sc1
    s_bitset1_b32 s89, 5
sl3_5:
    s_bitcmp1_b32 s89, 6
    s_cbranch_scc1 sl3_6
    s_bitcmp1_b32 s80, 6
    s_cbranch_scc0 sl3_6
    s_add_u32 s26, s62, 12288
    buffer_load_dwordx4 a[48:51], v13, s[4:7], s26 offen sc1
    buffer_load_dwordx4 a[52:55], v13, s[4:7], s26 offen offset:1024 sc1
    s_add_u32 s26, s62, 26624
    buffer_load_dwordx4 a[104:107], v13, s[4:7], s26 offen sc1
    buffer_load_dwordx4 a[108:111], v13, s[4:7], s26 offen offset:1024 sc1
    s_bitset1_b32 s89, 6
sl3_6:
    s_bitcmp1_b32 s89, 7
    s_cbranch_scc1 sl3_7
    s_bitcmp1_b32 s80, 7
    s_cbranch_scc0 sl3_7
    s_add_u32 s26, s62, 28672
    buffer_load_dwordx4 a[112:115], v13, s[4:7], s26 offen sc1
    buffer_load_dwordx4 a[116:119], v13, s[4:7], s26 offen offset:1024 sc1
    s_add_u32 s26, s62, 43008
    buffer_load_dwordx4 a[168:171], v13, s[4:7], s26 offen sc1
    buffer_load_dwordx4 a[172:175], v13, s[4:7], s26 offen offset:1024 sc1
    s_bitset1_b32 s89, 7
sl3_7:
    s_bitcmp1_b32 s89, 8
    s_cbranch_scc1 sl3_8
    s_bitcmp1_b32 s80, 8
    s_cbranch_scc0 sl3_8
    s_add_u32 s26, s62, 30720
    buffer_load_dwordx4 a[120:123], v13, s[4:7], s26 offen sc1
    buffer_load_dwordx4 a[124:127], v13, s[4:7], s26 offen offset:1024 sc1
    s_add_u32 s26, s62, 45056
    buffer_load_dwordx4 a[176:179], v13, s[4:7], s26 offen sc1
    buffer_load_dwordx4 a[180:183], v13, s[4:7], s26 offen offset:1024 sc1
    s_bitset1_b32 s89, 8
sl3_8:
    s_bitcmp1_b32 s89, 9
    s_cbranch_scc1 sl3_9
    s_bitcmp1_b32 s80, 9
    s_cbranch_scc0 sl3_9
    s_add_u32 s26, s62, 32768
    buffer_load_dwordx4 a[128:131], v13, s[4:7], s26 offen sc1
    buffer_load_dwordx4 a[132:135], v13, s[4:7], s26 offen offset:1024 sc1
    s_add_u32 s26, s62, 47104
    buffer_load_dwordx4 a[184:187], v13, s[4:7], s26 offen sc1
    buffer_load_dwordx4 a[188:191], v13, s[4:7], s26 offen offset:1024 sc1
    s_bitset1_b32 s89, 9
sl3_9:
    s_bitcmp1_b32 s89, 10
    s_cbranch_scc1 sl3_10
    s_bitcmp1_b32 s80, 10
    s_cbranch_scc0 sl3_10
    s_add_u32 s26, s62, 34816
    buffer_load_dwordx4 a[136:139], v13, s[4:7], s26 offen sc1
    buffer_load_dwordx4 a[140:143], v13, s[4:7], s26 offen offset:1024 sc1
    s_add_u32 s26, s62, 49152
    buffer_load_dwordx4 a[192:195], v13, s[4:7], s26 offen sc1
    buffer_load_dwordx4 a[196:199], v13, s[4:7], s26 offen offset:1024 sc1
    s_bitset1_b32 s89, 10
sl3_10:
    s_bitcmp1_b32 s89, 11
    s_cbranch_scc1 sl3_11
    s_bitcmp1_b32 s80, 11
    s_cbranch_scc0 sl3_11
    s_add_u32 s26, s62, 36864
    buffer_load_dwordx4 a[144:147], v13, s[4:7], s26 offen sc1
    buffer_load_dwordx4 a[148:151], v13, s[4:7], s26 offen offset:1024 sc1
    s_add_u32 s26, s62, 51200
    buffer_load_dwordx4 a[200:203], v13, s[4:7], s26 offen sc1
    buffer_load_dwordx4 a[204:207], v13, s[4:7], s26 offen offset:1024 sc1
    s_bitset1_b32 s89, 11
sl3_11:
    s_bitcmp1_b32 s89, 12
    s_cbranch_scc1 sl3_12
    s_bitcmp1_b32 s80, 12
    s_cbranch_scc0 sl3_12
    s_add_u32 s26, s62, 38912
    buffer_load_dwordx4 a[152:155], v13, s[4:7], s26 offen sc1
    buffer_load_dwordx4 a[156:159], v13, s[4:7], s26 offen offset:1024 sc1
    s_add_u32 s26, s62, 53248
    buffer_load_dwordx4 a[208:211], v13, s[4:7], s26 offen sc1
    buffer_load_dwordx4 a[212:215], v13, s[4:7], s26 offen offset:1024 sc1
    s_bitset1_b32 s89, 12
sl3_12:
    s_bitcmp1_b32 s89, 13
    s_cbranch_scc1 sl3_13
    s_bitcmp1_b32 s80, 13
    s_cbranch_scc0 sl3_13
    s_add_u32 s26, s62, 40960
    buffer_load_dwordx4 a[160:163], v13, s[4:7], s26 offen sc1
    buffer_load_dwordx4 a[164:167], v13, s[4:7], s26 offen offset:1024 sc1
    s_add_u32 s26, s62, 55296
    buffer_load_dwordx4 a[216:219], v13, s[4:7], s26 offen sc1
    buffer_load_dwordx4 a[220:223], v13, s[4:7], s26 offen offset:1024 sc1
    s_bitset1_b32 s89, 13
sl3_13:
    s_bitcmp1_b32 s89, 14
    s_cbranch_scc1 sl3_14
    s_bitcmp1_b32 s80, 14
    s_cbranch_scc0 sl3_14
    s_add_u32 s26, s62, 57344
    buffer_load_dwordx4 a[224:227], v13, s[4:7], s26 offen sc1
    buffer_load_dwordx4 a[228:231], v13, s[4:7], s26 offen offset:1024 sc1
    s_add_u32 s26, s62, 71680
    buffer_load_dwordx4 v[120:123], v13, s[4:7], s26 offen sc1
    buffer_load_dwordx4 v[124:127], v13, s[4:7], s26 offen offset:1024 sc1
    s_bitset1_b32 s89, 14
sl3_14:
    s_bitcmp1_b32 s89, 15
    s_cbranch_scc1 sl3_15
    s_bitcmp1_b32 s80, 15
    s_cbranch_scc0 sl3_15
    s_add_u32 s26, s62, 59392
    buffer_load_dwordx4 a[232:235], v13, s[4:7], s26 offen sc1
    buffer_load_dwordx4 a[236:239], v13, s[4:7], s26 offen offset:1024 sc1
    s_add_u32 s26, s62, 73728
    buffer_load_dwordx4 v[128:131], v13, s[4:7], s26 offen sc1
    buffer_load_dwordx4 v[132:135], v13, s[4:7], s26 offen offset:1024 sc1
    s_bitset1_b32 s89, 15
sl3_15:
    s_bitcmp1_b32 s89, 16
    s_cbranch_scc1 sl3_16
    s_bitcmp1_b32 s80, 16
    s_cbranch_scc0 sl3_16
    s_add_u32 s26, s62, 61440
    buffer_load_dwordx4 a[240:243], v13, s[4:7], s26 offen sc1
    buffer_load_dwordx4 a[244:247], v13, s[4:7], s26 offen offset:1024 sc1
    s_add_u32 s26, s62, 75776
    buffer_load_dwordx4 v[136:139], v13, s[4:7], s26 offen sc1
    buffer_load_dwordx4 v[140:143], v13, s[4:7], s26 offen offset:1024 sc1
    s_bitset1_b32 s89, 16
sl3_16:
    s_bitcmp1_b32 s89, 17
    s_cbranch_scc1 sl3_17
    s_bitcmp1_b32 s80, 17
    s_cbranch_scc0 sl3_17
    s_add_u32 s26, s62, 63488
    buffer_load_dwordx4 a[248:251], v13, s[4:7], s26 offen sc1
    buffer_load_dwordx4 a[252:255], v13, s[4:7], s26 offen offset:1024 sc1
    s_add_u32 s26, s62, 77824
    buffer_load_dwordx4 v[144:147], v13, s[4:7], s26 offen sc1
    buffer_load_dwordx4 v[148:151], v13, s[4:7], s26 offen offset:1024 sc1
    s_bitset1_b32 s89, 17
sl3_17:
    s_bitcmp1_b32 s89, 18
    s_cbranch_scc1 sl3_18
    s_bitcmp1_b32 s80, 18
    s_cbranch_scc0 sl3_18
    s_add_u32 s26, s62, 65536
    buffer_load_dwordx4 v[96:99], v13, s[4:7], s26 offen sc1
    buffer_load_dwordx4 v[100:103], v13, s[4:7], s26 offen offset:1024 sc1
    s_add_u32 s26, s62, 79872
    buffer_load_dwordx4 v[152:155], v13, s[4:7], s26 offen sc1
    buffer_load_dwordx4 v[156:159], v13, s[4:7], s26 offen offset:1024 sc1
    s_bitset1_b32 s89, 18
sl3_18:
    s_bitcmp1_b32 s89, 19
    s_cbranch_scc1 sl3_19
    s_bitcmp1_b32 s80, 19
    s_cbranch_scc0 sl3_19
    s_add_u32 s26, s62, 67584
    buffer_load_dwordx4 v[104:107], v13, s[4:7], s26 offen sc1
    buffer_load_dwordx4 v[108:111], v13, s[4:7], s26 offen offset:1024 sc1
    s_add_u32 s26, s62, 81920
    buffer_load_dwordx4 v[160:163], v13, s[4:7], s26 offen sc1
    buffer_load_dwordx4 v[164:167], v13, s[4:7], s26 offen offset:1024 sc1
    s_bitset1_b32 s89, 19
sl3_19:
    s_bitcmp1_b32 s89, 20
    s_cbranch_scc1 sl3_20
    s_bitcmp1_b32 s80, 20
    s_cbranch_scc0 sl3_20
    s_add_u32 s26, s62, 69632
    buffer_load_dwordx4 v[112:115], v13, s[4:7], s26 offen sc1
    buffer_load_dwordx4 v[116:119], v13, s[4:7], s26 offen offset:1024 sc1
    s_add_u32 s26, s62, 83968
    buffer_load_dwordx4 v[168:171], v13, s[4:7], s26 offen sc1
    buffer_load_dwordx4 v[172:175], v13, s[4:7], s26 offen offset:1024 sc1
    s_bitset1_b32 s89, 20
sl3_20:
    s_bitcmp1_b32 s89, 21
    s_cbranch_scc1 sl3_21
    s_bitcmp1_b32 s80, 21
    s_cbranch_scc0 sl3_21
    s_add_u32 s26, s62, 86016
    buffer_load_dwordx4 v[176:179], v13, s[4:7], s26 offen sc1
    buffer_load_dwordx4 v[180:183], v13, s[4:7], s26 offen offset:1024 sc1
    s_add_u32 s26, s62, 100352
    buffer_load_dwordx4 v[232:235], v13, s[4:7], s26 offen sc1
    buffer_load_dwordx4 v[236:239], v13, s[4:7], s26 offen offset:1024 sc1
    s_bitset1_b32 s89, 21
sl3_21:
    s_bitcmp1_b32 s89, 22
    s_cbranch_scc1 sl3_22
    s_bitcmp1_b32 s80, 22
    s_cbranch_scc0 sl3_22
    s_add_u32 s26, s62, 88064
    buffer_load_dwordx4 v[184:187], v13, s[4:7], s26 offen sc1
    buffer_load_dwordx4 v[188:191], v13, s[4:7], s26 offen offset:1024 sc1
    s_add_u32 s26, s62, 102400
    buffer_load_dwordx4 v[240:243], v13, s[4:7], s26 offen sc1
    buffer_load_dwordx4 v[244:247], v13, s[4:7], s26 offen offset:1024 sc1
    s_bitset1_b32 s89, 22
sl3_22:
    s_bitcmp1_b32 s89, 23
    s_cbranch_scc1 sl3_23
    s_bitcmp1_b32 s80, 23
    s_cbranch_scc0 sl3_23
    s_add_u32 s26, s62, 90112
    buffer_load_dwordx4 v[192:195], v13, s[4:7], s26 offen sc1
    buffer_load_dwordx4 v[196:199], v13, s[4:7], s26 offen offset:1024 sc1
    s_add_u32 s26, s62, 104448
    buffer_load_dwordx4 v[248:251], v13, s[4:7], s26 offen sc1
    buffer_load_dwordx4 v[252:255], v13, s[4:7], s26 offen offset:1024 sc1
    s_bitset1_b32 s89, 23
sl3_23:
    s_bitcmp1_b32 s89, 24
    s_cbranch_scc1 sl3_24
    s_bitcmp1_b32 s80, 24
    s_cbranch_scc0 sl3_24
    s_add_u32 s26, s62, 92160
    buffer_load_dwordx4 v[200:203], v13, s[4:7], s26 offen sc1
    buffer_load_dwordx4 v[204:207], v13, s[4:7], s26 offen offset:1024 sc1
    s_add_u32 s26, s62, 106496
    s_lshl_b32 s25, s9, 13
    s_add_u32 s25, s25, 65536
    s_mov_b32 m0, s25
    s_nop 0
    buffer_load_dwordx4 v13, s[4:7], s26 offen sc1 lds
    buffer_load_dwordx4 v13, s[4:7], s26 offen offset:1024 sc1 lds
    s_bitset1_b32 s89, 24
sl3_24:
    s_bitcmp1_b32 s89, 25
    s_cbranch_scc1 sl3_25
    s_bitcmp1_b32 s80, 25
    s_cbranch_scc0 sl3_25
    s_add_u32 s26, s62, 94208
    buffer_load_dwordx4 v[208:211], v13, s[4:7], s26 offen sc1
    buffer_load_dwordx4 v[212:215], v13, s[4:7], s26 offen offset:1024 sc1
    s_add_u32 s26, s62, 108544
    s_lshl_b32 s25, s9, 13
    s_add_u32 s25, s25, 67584
    s_mov_b32 m0, s25
    s_nop 0
    buffer_load_dwordx4 v13, s[4:7], s26 offen sc1 lds
    buffer_load_dwordx4 v13, s[4:7], s26 offen offset:1024 sc1 lds
    s_bitset1_b32 s89, 25
sl3_25:
    s_bitcmp1_b32 s89, 26
    s_cbranch_scc1 sl3_26
    s_bitcmp1_b32 s80, 26
    s_cbranch_scc0 sl3_26
    s_add_u32 s26, s62, 96256
    buffer_load_dwordx4 v[216:219], v13, s[4:7], s26 offen sc1
    buffer_load_dwordx4 v[220:223], v13, s[4:7], s26 offen offset:1024 sc1
    s_add_u32 s26, s62, 110592
    s_lshl_b32 s25, s9, 13
    s_add_u32 s25, s25, 69632
    s_mov_b32 m0, s25
    s_nop 0
    buffer_load_dwordx4 v13, s[4:7], s26 offen sc1 lds
    buffer_load_dwordx4 v13, s[4:7], s26 offen offset:1024 sc1 lds
    s_bitset1_b32 s89, 26
sl3_26:
    s_bitcmp1_b32 s89, 27
    s_cbranch_scc1 sl3_27
    s_bitcmp1_b32 s80, 27
    s_cbranch_scc0 sl3_27
    s_add_u32 s26, s62, 98304
    buffer_load_dwordx4 v[224:227], v13, s[4:7], s26 offen sc1
    buffer_load_dwordx4 v[228:231], v13, s[4:7], s26 offen offset:1024 sc1
    s_add_u32 s26, s62, 112640
    s_lshl_b32 s25, s9, 13
    s_add_u32 s25, s25, 71680
    s_mov_b32 m0, s25
    s_nop 0
    buffer_load_dwordx4 v13, s[4:7], s26 offen sc1 lds
    buffer_load_dwordx4 v13, s[4:7], s26 offen offset:1024 sc1 lds
    s_bitset1_b32 s89, 27
sl3_27:
    s_cmp_eq_u32 s89, 268435455
    s_cbranch_scc1 sl3_ok
    s_cmp_eq_u32 s17, 0
    s_cbranch_scc1 sl3_ok
    s_sub_u32 s17, s17, 1
    s_sleep 8
    s_branch sl3
sl3_ok:
    s_mov_b32 s24, 224
    v_mbcnt_lo_u32_b32 v38, -1, 0
    v_mbcnt_hi_u32_b32 v38, -1, v38
    v_cmp_gt_u32 vcc, 32, v38
    v_add_u32 v38, s24, v38
    v_lshlrev_b32 v38, 7, v38
    v_add_u32 v38, 57753600, v38
    v_mov_b32 v36, 0x7fff0000
    v_cndmask_b32 v38, v36, v38, vcc
wm4:
    buffer_load_dword v36, v38, s[4:7], 0 offen sc1
    s_waitcnt vmcnt(0)
    v_cmp_eq_u32 s[80:81], s18, v36
    s_cmp_eq_u32 s80, -1
    s_cbranch_scc1 wm4_ok
    s_cmp_eq_u32 s17, 0
    s_cbranch_scc1 wm4_ok
    s_sub_u32 s17, s17, 1
    s_sleep 8
    s_branch wm4
wm4_ok:

    v_and_b32 v19, 7, v0
    v_lshrrev_b32 v20, 1, v16
    v_and_b32 v21, 1, v16
    s_mul_i32 s25, s9, 2560
    v_lshlrev_b32 v22, 1, v20
    v_add_u32 v22, v22, v18
    v_mul_u32_u24 v22, 640, v22
    v_lshlrev_b32 v23, 4, v19
    v_add3_u32 v7, v22, v23, s25
    v_mul_u32_u24 v22, 640, v20
    v_lshlrev_b32 v23, 1, v21
    v_add3_u32 v23, v23, v18, 1
    v_lshlrev_b32 v23, 7, v23
    v_add3_u32 v22, v22, v23, s25
    v_lshlrev_b32 v23, 4, v19
    v_add_u32 v8, v22, v23
    v_lshlrev_b32 v22, 2, v21
    v_lshl_add_u32 v22, v20, 1, v22
    v_lshlrev_b32 v22, 5, v22
    v_add_u32 v22, v22, v17
    s_lshl_b32 s25, s9, 8
    v_add_u32 v22, s25, v22
    v_lshlrev_b32 v22, 2, v22
    v_add_u32 v10, 106496, v22
    v_lshrrev_b32 v19, 3, v0
    v_and_b32 v20, 7, v0
    v_lshlrev_b32 v22, 5, v19
    v_and_b32 v23, 3, v20
    v_lshlrev_b32 v23, 1, v23
    v_lshrrev_b32 v21, 2, v20
    v_add_u32 v23, v23, v21
    v_lshlrev_b32 v23, 1, v23
    s_and_b32 s25, s9, 1
    s_lshl_b32 s26, s25, 4
    v_add3_u32 v22, v22, v23, s26
    v_lshlrev_b32 v22, 2, v22
    v_add_u32 v11, 106496, v22
    s_and_b32 s26, s11, 1
    s_lshl_b32 s26, s26, 1
    s_add_u32 s26, s26, s25
    s_lshl_b32 s26, s26, 8
    s_lshr_b32 s27, s11, 1
    s_lshl_b32 s27, s27, 10
    s_add_u32 s26, s26, s27
    v_lshrrev_b32 v22, 2, v20
    v_lshlrev_b32 v22, 3, v22
    v_add_u32 v22, v22, v19
    v_lshlrev_b32 v22, 4, v22
    v_and_b32 v23, 3, v20
    v_lshlrev_b32 v23, 2, v23
    v_add3_u32 v12, v22, v23, s26
    s_mov_b32 s8, 0
    s_mov_b32 s44, 16777216
    s_mov_b32 s48, 16784384
    s_mov_b32 s45, 17711104
    s_lshl_b32 s25, s9, 13
    s_mov_b32 s47, s25
    s_lshl_b32 s24, s11, 15
    s_add_u32 s24, s24, s25
    s_add_u32 s46, s24, 18366464
    s_mov_b32 s51, 57688064
    v_mov_b32 v15, s51
    buffer_load_dword v14, v15, s[4:7], 0 offen sc1

va0_cda:
    s_waitcnt vmcnt(0)
    v_readfirstlane_b32 s24, v14
    s_nop 0
    s_cmp_ge_u32 s24, 16
    s_cbranch_scc1 va0_cda_go
    s_cmp_eq_u32 s17, 0
    s_cbranch_scc1 va0_cda_go
    s_sub_u32 s17, s17, 1
    v_mov_b32 v15, s51
    buffer_load_dword v14, v15, s[4:7], 0 offen sc1
    s_branch va0_cda
va0_cda_go:
    s_mov_b32 m0, s47
    s_nop 0
    buffer_load_dwordx4 v13, s[4:7], s46 offen offset:0 sc1 lds
    buffer_load_dwordx4 v13, s[4:7], s46 offen offset:1024 sc1 lds
    buffer_load_dwordx4 v13, s[4:7], s46 offen offset:2048 sc1 lds
    buffer_load_dwordx4 v13, s[4:7], s46 offen offset:3072 sc1 lds
    s_add_u32 s24, s47, 4096
    s_mov_b32 m0, s24
    s_add_u32 s25, s46, 4096
    buffer_load_dwordx4 v13, s[4:7], s25 offen offset:0 sc1 lds
    buffer_load_dwordx4 v13, s[4:7], s25 offen offset:1024 sc1 lds
    buffer_load_dwordx4 v13, s[4:7], s25 offen offset:2048 sc1 lds
    buffer_load_dwordx4 v13, s[4:7], s25 offen offset:3072 sc1 lds
    s_add_u32 s46, s46, 458752
    s_xor_b32 s47, s47, 32768
    s_add_u32 s51, s51, 128
    v_mov_b32 v15, s51
    buffer_load_dword v14, v15, s[4:7], 0 offen sc1

va0_cdb:
    s_waitcnt vmcnt(0)
    v_readfirstlane_b32 s24, v14
    s_nop 0
    s_cmp_ge_u32 s24, 16
    s_cbranch_scc1 va0_cdb_go
    s_cmp_eq_u32 s17, 0
    s_cbranch_scc1 va0_cdb_go
    s_sub_u32 s17, s17, 1
    v_mov_b32 v15, s51
    buffer_load_dword v14, v15, s[4:7], 0 offen sc1
    s_branch va0_cdb
va0_cdb_go:
    s_add_u32 s51, s51, 128
    s_mov_b32 s53, 16
    s_waitcnt vmcnt(0) lgkmcnt(0)
    s_barrier
va0_loop:
    v_mov_b32 v40, 0
    v_mov_b32 v41, 0
    v_mov_b32 v42, 0
    v_mov_b32 v43, 0
    v_mov_b32 v44, 0
    v_mov_b32 v45, 0
    v_mov_b32 v46, 0
    v_mov_b32 v47, 0
    v_mov_b32 v48, 0
    v_mov_b32 v49, 0
    v_mov_b32 v50, 0
    v_mov_b32 v51, 0
    v_mov_b32 v52, 0
    v_mov_b32 v53, 0
    v_mov_b32 v54, 0
    v_mov_b32 v55, 0
    v_mov_b32 v56, 0
    v_mov_b32 v57, 0
    v_mov_b32 v58, 0
    v_mov_b32 v59, 0
    v_mov_b32 v60, 0
    v_mov_b32 v61, 0
    v_mov_b32 v62, 0
    v_mov_b32 v63, 0
    v_mov_b32 v64, 0
    v_mov_b32 v65, 0
    v_mov_b32 v66, 0
    v_mov_b32 v67, 0
    v_mov_b32 v68, 0
    v_mov_b32 v69, 0
    v_mov_b32 v70, 0
    v_mov_b32 v71, 0
    v_mov_b32 v88, 0
    v_mov_b32 v89, 0
    v_mov_b32 v90, 0
    v_mov_b32 v91, 0
    v_mov_b32 v92, 0
    v_mov_b32 v93, 0
    v_mov_b32 v94, 0
    v_mov_b32 v95, 0
va0_mpoll:
    buffer_load_dwordx4 v[16:19], v2, s[4:7], s44 offen sc1
    buffer_load_dwordx4 v[20:23], v2, s[4:7], s44 offen offset:1024 sc1
    s_waitcnt vmcnt(0)
    ds_write_b128 v3, v[16:19]
    ds_write_b128 v3, v[20:23] offset:1024
    v_max3_u32 v28, v16, v17, v18
    v_max3_u32 v29, v19, v20, v21
    v_max3_u32 v28, v28, v22, v23
    v_max_u32 v28, v28, v29
    v_cmp_eq_u32 vcc, -1, v28
    s_cbranch_vccnz va0_mpoll_retry
va0_mgo:
    s_waitcnt lgkmcnt(0)
    s_barrier

    s_cmp_ge_u32 s53, 16
    s_cbranch_scc0 va0_cdslow
va0_cdok:
    v_mov_b32 v15, s51
    ds_read_b128 v[16:19], v4
    s_waitcnt lgkmcnt(0)
    ds_read_b128 v[20:23], v4 offset:1024
    v_smfmac_f32_16x16x64_bf16 v[40:43], v[16:19], a[0:7], v1
    v_smfmac_f32_16x16x64_bf16 v[44:47], v[16:19], a[56:63], v1
    v_smfmac_f32_16x16x64_bf16 v[48:51], v[16:19], a[112:119], v1
    buffer_load_dword v14, v15, s[4:7], 0 offen sc1
    v_smfmac_f32_16x16x64_bf16 v[52:55], v[16:19], a[168:175], v1
    v_smfmac_f32_16x16x64_bf16 v[56:59], v[16:19], a[224:231], v1
    v_smfmac_f32_16x16x64_bf16 v[60:63], v[16:19], v[120:127], v1
    v_smfmac_f32_16x16x64_bf16 v[64:67], v[16:19], v[176:183], v1
    s_mov_b32 m0, s47
    s_nop 0
    buffer_load_dwordx4 v13, s[4:7], s46 offen offset:0 sc1 lds
    v_smfmac_f32_16x16x64_bf16 v[68:71], v[16:19], v[232:239], v1
    s_waitcnt lgkmcnt(0)
    ds_read_b128 v[16:19], v4 offset:2048
    v_smfmac_f32_16x16x64_bf16 v[40:43], v[20:23], a[8:15], v1
    v_smfmac_f32_16x16x64_bf16 v[44:47], v[20:23], a[64:71], v1
    v_smfmac_f32_16x16x64_bf16 v[48:51], v[20:23], a[120:127], v1
    buffer_load_dwordx4 v13, s[4:7], s46 offen offset:1024 sc1 lds
    v_smfmac_f32_16x16x64_bf16 v[52:55], v[20:23], a[176:183], v1
    v_smfmac_f32_16x16x64_bf16 v[56:59], v[20:23], a[232:239], v1
    v_smfmac_f32_16x16x64_bf16 v[60:63], v[20:23], v[128:135], v1
    v_smfmac_f32_16x16x64_bf16 v[64:67], v[20:23], v[184:191], v1
    buffer_load_dwordx4 v13, s[4:7], s46 offen offset:2048 sc1 lds
    v_smfmac_f32_16x16x64_bf16 v[68:71], v[20:23], v[240:247], v1
    s_waitcnt lgkmcnt(0)
    ds_read_b128 v[20:23], v4 offset:3072
    v_smfmac_f32_16x16x64_bf16 v[40:43], v[16:19], a[16:23], v1
    ds_read_b128 v[32:35], v5 offset:0
    ds_read_b128 v[36:39], v5 offset:1024
    v_smfmac_f32_16x16x64_bf16 v[44:47], v[16:19], a[72:79], v1
    v_smfmac_f32_16x16x64_bf16 v[48:51], v[16:19], a[128:135], v1
    buffer_load_dwordx4 v13, s[4:7], s46 offen offset:3072 sc1 lds
    v_smfmac_f32_16x16x64_bf16 v[52:55], v[16:19], a[184:191], v1
    v_smfmac_f32_16x16x64_bf16 v[56:59], v[16:19], a[240:247], v1
    v_smfmac_f32_16x16x64_bf16 v[60:63], v[16:19], v[136:143], v1
    v_smfmac_f32_16x16x64_bf16 v[64:67], v[16:19], v[192:199], v1
    s_add_u32 s24, s47, 4096
    s_mov_b32 m0, s24
    s_add_u32 s25, s46, 4096
    buffer_load_dwordx4 v13, s[4:7], s25 offen offset:0 sc1 lds
    v_smfmac_f32_16x16x64_bf16 v[68:71], v[16:19], v[248:255], v1
    s_waitcnt lgkmcnt(0)
    ds_read_b128 v[16:19], v4 offset:4096
    v_smfmac_f32_16x16x64_bf16 v[40:43], v[20:23], a[24:31], v1
    ds_read_b128 v[24:27], v5 offset:2048
    ds_read_b128 v[28:31], v5 offset:3072
    v_smfmac_f32_16x16x64_bf16 v[44:47], v[20:23], a[80:87], v1
    v_smfmac_f32_16x16x64_bf16 v[48:51], v[20:23], a[136:143], v1
    buffer_load_dwordx4 v13, s[4:7], s25 offen offset:1024 sc1 lds
    v_smfmac_f32_16x16x64_bf16 v[52:55], v[20:23], a[192:199], v1
    v_smfmac_f32_16x16x64_bf16 v[56:59], v[20:23], a[248:255], v1
    v_smfmac_f32_16x16x64_bf16 v[60:63], v[20:23], v[144:151], v1
    v_smfmac_f32_16x16x64_bf16 v[64:67], v[20:23], v[200:207], v1
    buffer_load_dwordx4 v13, s[4:7], s25 offen offset:2048 sc1 lds
    v_smfmac_f32_16x16x64_bf16 v[68:71], v[20:23], v[32:39], v1
    s_waitcnt lgkmcnt(0)
    ds_read_b128 v[20:23], v4 offset:5120
    v_smfmac_f32_16x16x64_bf16 v[40:43], v[16:19], a[32:39], v1
    ds_read_b128 v[32:35], v5 offset:4096
    ds_read_b128 v[36:39], v5 offset:5120
    v_smfmac_f32_16x16x64_bf16 v[44:47], v[16:19], a[88:95], v1
    v_smfmac_f32_16x16x64_bf16 v[48:51], v[16:19], a[144:151], v1
    buffer_load_dwordx4 v13, s[4:7], s25 offen offset:3072 sc1 lds
    v_smfmac_f32_16x16x64_bf16 v[52:55], v[16:19], a[200:207], v1
    v_smfmac_f32_16x16x64_bf16 v[56:59], v[16:19], v[96:103], v1
    v_smfmac_f32_16x16x64_bf16 v[60:63], v[16:19], v[152:159], v1
    v_smfmac_f32_16x16x64_bf16 v[64:67], v[16:19], v[208:215], v1
    v_smfmac_f32_16x16x64_bf16 v[68:71], v[16:19], v[24:31], v1
    s_waitcnt lgkmcnt(0)
    ds_read_b128 v[16:19], v4 offset:6144
    v_smfmac_f32_16x16x64_bf16 v[40:43], v[20:23], a[40:47], v1
    ds_read_b128 v[24:27], v5 offset:6144
    ds_read_b128 v[28:31], v5 offset:7168
    v_smfmac_f32_16x16x64_bf16 v[44:47], v[20:23], a[96:103], v1
    v_smfmac_f32_16x16x64_bf16 v[48:51], v[20:23], a[152:159], v1
    v_smfmac_f32_16x16x64_bf16 v[52:55], v[20:23], a[208:215], v1
    v_smfmac_f32_16x16x64_bf16 v[56:59], v[20:23], v[104:111], v1
    v_smfmac_f32_16x16x64_bf16 v[60:63], v[20:23], v[160:167], v1
    v_smfmac_f32_16x16x64_bf16 v[64:67], v[20:23], v[216:223], v1
    v_smfmac_f32_16x16x64_bf16 v[68:71], v[20:23], v[32:39], v1
    s_waitcnt lgkmcnt(0)
    v_smfmac_f32_16x16x64_bf16 v[40:43], v[16:19], a[48:55], v1
    v_smfmac_f32_16x16x64_bf16 v[44:47], v[16:19], a[104:111], v1
    v_smfmac_f32_16x16x64_bf16 v[48:51], v[16:19], a[160:167], v1
    v_smfmac_f32_16x16x64_bf16 v[52:55], v[16:19], a[216:223], v1
    v_smfmac_f32_16x16x64_bf16 v[56:59], v[16:19], v[112:119], v1
    v_smfmac_f32_16x16x64_bf16 v[60:63], v[16:19], v[168:175], v1
    v_smfmac_f32_16x16x64_bf16 v[64:67], v[16:19], v[224:231], v1
    v_smfmac_f32_16x16x64_bf16 v[68:71], v[16:19], v[24:31], v1
    v_cvt_pk_bf16_f32 v72, v40, v41
    v_cvt_pk_bf16_f32 v74, v42, v43
    v_cvt_pk_bf16_f32 v80, v44, v45
    v_cvt_pk_bf16_f32 v82, v46, v47
    v_cvt_pk_bf16_f32 v73, v48, v49
    v_cvt_pk_bf16_f32 v75, v50, v51
    v_cvt_pk_bf16_f32 v81, v52, v53
    v_cvt_pk_bf16_f32 v83, v54, v55
    v_cvt_pk_bf16_f32 v76, v56, v57
    v_cvt_pk_bf16_f32 v78, v58, v59
    v_cvt_pk_bf16_f32 v84, v60, v61
    v_cvt_pk_bf16_f32 v86, v62, v63
    v_cvt_pk_bf16_f32 v77, v64, v65
    v_cvt_pk_bf16_f32 v79, v66, v67
    v_cvt_pk_bf16_f32 v85, v68, v69
    v_cvt_pk_bf16_f32 v87, v70, v71
    ds_read_b128 v[40:43], v6 offset:0
    ds_read_b128 v[44:47], v6 offset:2048
    ds_read_b128 v[48:51], v6 offset:4096
    ds_read_b128 v[52:55], v6 offset:6144
    ds_read_b128 v[56:59], v6 offset:1024
    ds_read_b128 v[60:63], v6 offset:3072
    ds_read_b128 v[64:67], v6 offset:5120
    ds_read_b128 v[68:71], v6 offset:7168
    s_waitcnt lgkmcnt(0)
va0_ppoll0:
va0_ppoll:
    buffer_load_dwordx4 v[16:19], v7, s[4:7], s45 offen sc1
    buffer_load_dwordx4 v[20:23], v8, s[4:7], s45 offen sc1
    buffer_load_dwordx4 v[24:27], v8, s[4:7], s45 offen offset:1280 sc1
    s_waitcnt vmcnt(0)
    v_max3_u32 v9, v16, v20, v24
    v_cmp_eq_u32 vcc, -1, v9
    s_cbranch_vccnz va0_ppoll_retry
va0_pgo:
    v_smfmac_f32_16x16x64_bf16 v[88:91], v[16:19], v[72:79], v1
    v_smfmac_f32_16x16x64_bf16 v[92:95], v[16:19], v[80:87], v1
    v_max3_u32 v9, v17, v18, v19
    v_max3_u32 v0, v21, v22, v23
    v_smfmac_f32_16x16x64_bf16 v[88:91], v[20:23], v[40:47], v1
    v_max3_u32 v9, v9, v25, v26
    v_max3_u32 v9, v9, v27, v0
    v_smfmac_f32_16x16x64_bf16 v[92:95], v[20:23], v[56:63], v1
    v_cmp_eq_u32 vcc, -1, v9
    v_smfmac_f32_16x16x64_bf16 v[88:91], v[24:27], v[48:55], v1
    v_readfirstlane_b32 s53, v14
    v_smfmac_f32_16x16x64_bf16 v[92:95], v[24:27], v[64:71], v1
    s_cbranch_vccnz va0_pfail
va0_pok:
    s_nop 2
    v_permlane32_swap_b32 v88, v90
    v_permlane32_swap_b32 v89, v91
    v_pk_add_f32 v[88:89], v[88:89], v[90:91]
    s_nop 0
    v_permlane32_swap_b32 v92, v94
    v_permlane32_swap_b32 v93, v95
    v_pk_add_f32 v[92:93], v[92:93], v[94:95]
    ds_write2_b32 v10, v88, v92 offset0:0 offset1:16
    ds_write2_b32 v10, v89, v93 offset0:32 offset1:48
    s_cmp_ge_u32 s9, 2
    s_waitcnt lgkmcnt(0)
    s_barrier
    s_cbranch_scc1 va0_nofin
    ds_read2st64_b64 v[40:43], v11 offset0:0 offset1:2
    ds_read2st64_b64 v[44:47], v11 offset0:4 offset1:6
    s_waitcnt lgkmcnt(0)
    v_pk_add_f32 v[40:41], v[40:41], v[42:43]
    v_pk_add_f32 v[44:45], v[44:45], v[46:47]
    v_pk_add_f32 v[40:41], v[40:41], v[44:45]
    v_cvt_pk_bf16_f32 v40, v40, v41
    buffer_store_dword v40, v12, s[4:7], s48 offen
va0_nofin:
    s_add_u32 s46, s46, 458752
    s_xor_b32 s47, s47, 32768
    v_xor_b32 v6, 32768, v6
    s_add_u32 s51, s51, 128
    s_add_u32 s8, s8, 1
    s_add_u32 s44, s44, 7168
    s_add_u32 s48, s48, 7168
    s_add_u32 s45, s45, 10240
    s_cmp_lt_u32 s8, 63
    s_cbranch_scc1 va0_loop
    s_endpgm
va0_mpoll_retry:
    s_cmp_eq_u32 s17, 0
    s_cbranch_scc1 va0_mgo
    s_sub_u32 s17, s17, 1
    s_branch va0_mpoll
va0_cdslow:
    s_sub_u32 s24, s51, 128
    v_mov_b32 v15, s24
va0_cdslow_p:
    buffer_load_dword v14, v15, s[4:7], 0 offen sc1
    s_waitcnt vmcnt(0)
    v_readfirstlane_b32 s24, v14
    s_nop 0
    s_cmp_ge_u32 s24, 16
    s_cbranch_scc1 va0_cdok
    s_cmp_eq_u32 s17, 0
    s_cbranch_scc1 va0_cdok
    s_sub_u32 s17, s17, 1
    s_branch va0_cdslow_p
va0_ppoll_retry:
    s_cmp_eq_u32 s17, 0
    s_cbranch_scc1 va0_pgo
    s_sub_u32 s17, s17, 1
    s_branch va0_ppoll
va0_pfail:
    s_cmp_eq_u32 s17, 0
    s_cbranch_scc1 va0_pfail_go
    s_sub_u32 s17, s17, 1
    s_waitcnt vmcnt(0)
    s_nop 7
    v_mov_b32 v88, 0
    v_mov_b32 v89, 0
    v_mov_b32 v90, 0
    v_mov_b32 v91, 0
    v_mov_b32 v92, 0
    v_mov_b32 v93, 0
    v_mov_b32 v94, 0
    v_mov_b32 v95, 0
    s_branch va0_ppoll0
va0_pfail_go:
    s_nop 7
    s_branch va0_pok
sc1_start:

    v_lshrrev_b32 v17, 4, v0
    v_and_b32 v18, 15, v0
    v_bfe_u32 v19, v0, 3, 1
    v_mul_u32_u24 v1, 0xaaaa, v19
    v_add_u32 v1, 0x4444, v1
    v_lshlrev_b32 v16, 4, v0
    s_lshl_b32 s24, s9, 1
    s_min_u32 s24, s24, 5
    s_lshl_b32 s25, s24, 10
    v_add_u32 v2, s25, v16
    v_add_u32 v3, 65536, v2
    s_lshl_b32 s50, s24, 11
    s_add_u32 s51, s50, 2048
    s_cmp_eq_u32 s9, 0
    s_cselect_b32 s25, 2, 0
    s_lshl_b32 s52, s25, 11
    s_add_u32 s53, s52, 2048
    s_lshl_b32 s25, s25, 10
    s_add_u32 s25, s25, 65536
    v_add_u32 v4, s25, v16
    s_cmp_lt_u32 s9, 2
    s_cselect_b32 s25, 4, 2
    s_lshl_b32 s54, s25, 11
    s_add_u32 s55, s54, 2048
    s_lshl_b32 s25, s25, 10
    s_add_u32 s25, s25, 65536
    v_add_u32 v5, s25, v16
    s_cmp_eq_u32 s9, 3
    s_cselect_b32 s25, 4, 6
    s_lshl_b32 s56, s25, 11
    s_lshl_b32 s25, s25, 10
    s_add_u32 s25, s25, 65536
    v_add_u32 v6, s25, v16
    s_lshl_b32 s24, s11, 2
    s_add_u32 s24, s24, s9
    s_mul_i32 s24, s24, 100352
    s_add_u32 s24, s24, 3932160

    s_mov_b32 s62, s24
    s_lshr_b32 s70, s50, 11
    s_lshr_b32 s71, s51, 11
    s_lshr_b32 s72, s52, 11
    s_lshr_b32 s73, s53, 11
    s_lshr_b32 s74, s54, 11
    s_lshr_b32 s75, s55, 11
    s_lshr_b32 s76, s56, 11
    s_mov_b32 s24, 224
    v_mbcnt_lo_u32_b32 v114, -1, 0
    v_mbcnt_hi_u32_b32 v114, -1, v114
    v_cmp_gt_u32 vcc, 32, v114
    v_add_u32 v114, s24, v114
    v_lshlrev_b32 v114, 7, v114
    v_add_u32 v114, 57753600, v114
    v_mov_b32 v112, 0x7fff0000
    v_cndmask_b32 v114, v112, v114, vcc
wm5:
    buffer_load_dword v112, v114, s[4:7], 0 offen sc1
    s_waitcnt vmcnt(0)
    v_cmp_eq_u32 s[80:81], s18, v112
    s_cmp_eq_u32 s80, -1
    s_cbranch_scc1 wm5_ok
    s_cmp_eq_u32 s17, 0
    s_cbranch_scc1 wm5_ok
    s_sub_u32 s17, s17, 1
    s_sleep 8
    s_branch wm5
wm5_ok:
    s_lshl_b32 s25, s9, 13
    s_mov_b32 s47, s25
    s_add_u32 s46, s25, 1835008
    s_mov_b32 m0, s47
    s_nop 0
    buffer_load_dwordx4 v16, s[4:7], s46 offen offset:0 sc1 lds
    buffer_load_dwordx4 v16, s[4:7], s46 offen offset:1024 sc1 lds
    buffer_load_dwordx4 v16, s[4:7], s46 offen offset:2048 sc1 lds
    buffer_load_dwordx4 v16, s[4:7], s46 offen offset:3072 sc1 lds
    s_add_u32 s24, s47, 4096
    s_mov_b32 m0, s24
    s_add_u32 s25, s46, 4096
    buffer_load_dwordx4 v16, s[4:7], s25 offen offset:0 sc1 lds
    buffer_load_dwordx4 v16, s[4:7], s25 offen offset:1024 sc1 lds
    buffer_load_dwordx4 v16, s[4:7], s25 offen offset:2048 sc1 lds
    buffer_load_dwordx4 v16, s[4:7], s25 offen offset:3072 sc1 lds
    s_add_u32 s46, s46, 32768
    s_xor_b32 s47, s47, 32768
    s_mul_i32 s24, s11, 14
    s_add_u32 s24, s24, 0
    v_mbcnt_lo_u32_b32 v114, -1, 0
    v_mbcnt_hi_u32_b32 v114, -1, v114
    v_cmp_gt_u32 vcc, 7, v114
    v_add_u32 v114, s24, v114
    v_lshlrev_b32 v114, 7, v114
    v_add_u32 v114, 57753600, v114
    v_mov_b32 v112, 0x7fff0000
    v_cndmask_b32 v114, v112, v114, vcc
    s_mov_b32 s89, 0
sl6:
    buffer_load_dword v112, v114, s[4:7], 0 offen sc1
    s_waitcnt vmcnt(0)
    v_cmp_eq_u32 s[80:81], s18, v112
    s_bitcmp1_b32 s89, 0
    s_cbranch_scc1 sl6_0
    s_bitcmp1_b32 s80, s70
    s_cbranch_scc0 sl6_0
    s_add_u32 s25, s62, s50
    buffer_load_dwordx4 a[0:3], v16, s[4:7], s25 offen sc1
    buffer_load_dwordx4 a[4:7], v16, s[4:7], s25 offen offset:1024 sc1
    s_add_u32 s25, s25, 14336
    buffer_load_dwordx4 a[56:59], v16, s[4:7], s25 offen sc1
    buffer_load_dwordx4 a[60:63], v16, s[4:7], s25 offen offset:1024 sc1
    s_add_u32 s25, s25, 14336
    buffer_load_dwordx4 a[112:115], v16, s[4:7], s25 offen sc1
    buffer_load_dwordx4 a[116:119], v16, s[4:7], s25 offen offset:1024 sc1
    s_add_u32 s25, s25, 14336
    buffer_load_dwordx4 a[168:171], v16, s[4:7], s25 offen sc1
    buffer_load_dwordx4 a[172:175], v16, s[4:7], s25 offen offset:1024 sc1
    s_add_u32 s25, s25, 14336
    buffer_load_dwordx4 a[224:227], v16, s[4:7], s25 offen sc1
    buffer_load_dwordx4 a[228:231], v16, s[4:7], s25 offen offset:1024 sc1
    s_add_u32 s25, s25, 14336
    buffer_load_dwordx4 v[144:147], v16, s[4:7], s25 offen sc1
    buffer_load_dwordx4 v[148:151], v16, s[4:7], s25 offen offset:1024 sc1
    s_add_u32 s25, s25, 14336
    buffer_load_dwordx4 v[200:203], v16, s[4:7], s25 offen sc1
    buffer_load_dwordx4 v[204:207], v16, s[4:7], s25 offen offset:1024 sc1
    s_bitset1_b32 s89, 0
sl6_0:
    s_bitcmp1_b32 s89, 1
    s_cbranch_scc1 sl6_1
    s_bitcmp1_b32 s80, s71
    s_cbranch_scc0 sl6_1
    s_add_u32 s25, s62, s51
    buffer_load_dwordx4 a[8:11], v16, s[4:7], s25 offen sc1
    buffer_load_dwordx4 a[12:15], v16, s[4:7], s25 offen offset:1024 sc1
    s_add_u32 s25, s25, 14336
    buffer_load_dwordx4 a[64:67], v16, s[4:7], s25 offen sc1
    buffer_load_dwordx4 a[68:71], v16, s[4:7], s25 offen offset:1024 sc1
    s_add_u32 s25, s25, 14336
    buffer_load_dwordx4 a[120:123], v16, s[4:7], s25 offen sc1
    buffer_load_dwordx4 a[124:127], v16, s[4:7], s25 offen offset:1024 sc1
    s_add_u32 s25, s25, 14336
    buffer_load_dwordx4 a[176:179], v16, s[4:7], s25 offen sc1
    buffer_load_dwordx4 a[180:183], v16, s[4:7], s25 offen offset:1024 sc1
    s_add_u32 s25, s25, 14336
    buffer_load_dwordx4 a[232:235], v16, s[4:7], s25 offen sc1
    buffer_load_dwordx4 a[236:239], v16, s[4:7], s25 offen offset:1024 sc1
    s_add_u32 s25, s25, 14336
    buffer_load_dwordx4 v[152:155], v16, s[4:7], s25 offen sc1
    buffer_load_dwordx4 v[156:159], v16, s[4:7], s25 offen offset:1024 sc1
    s_add_u32 s25, s25, 14336
    buffer_load_dwordx4 v[208:211], v16, s[4:7], s25 offen sc1
    buffer_load_dwordx4 v[212:215], v16, s[4:7], s25 offen offset:1024 sc1
    s_bitset1_b32 s89, 1
sl6_1:
    s_bitcmp1_b32 s89, 2
    s_cbranch_scc1 sl6_2
    s_bitcmp1_b32 s80, s72
    s_cbranch_scc0 sl6_2
    s_add_u32 s25, s62, s52
    buffer_load_dwordx4 a[16:19], v16, s[4:7], s25 offen sc1
    buffer_load_dwordx4 a[20:23], v16, s[4:7], s25 offen offset:1024 sc1
    s_add_u32 s25, s25, 14336
    buffer_load_dwordx4 a[72:75], v16, s[4:7], s25 offen sc1
    buffer_load_dwordx4 a[76:79], v16, s[4:7], s25 offen offset:1024 sc1
    s_add_u32 s25, s25, 14336
    buffer_load_dwordx4 a[128:131], v16, s[4:7], s25 offen sc1
    buffer_load_dwordx4 a[132:135], v16, s[4:7], s25 offen offset:1024 sc1
    s_add_u32 s25, s25, 14336
    buffer_load_dwordx4 a[184:187], v16, s[4:7], s25 offen sc1
    buffer_load_dwordx4 a[188:191], v16, s[4:7], s25 offen offset:1024 sc1
    s_add_u32 s25, s25, 14336
    buffer_load_dwordx4 a[240:243], v16, s[4:7], s25 offen sc1
    buffer_load_dwordx4 a[244:247], v16, s[4:7], s25 offen offset:1024 sc1
    s_add_u32 s25, s25, 14336
    buffer_load_dwordx4 v[160:163], v16, s[4:7], s25 offen sc1
    buffer_load_dwordx4 v[164:167], v16, s[4:7], s25 offen offset:1024 sc1
    s_add_u32 s25, s25, 14336
    buffer_load_dwordx4 v[216:219], v16, s[4:7], s25 offen sc1
    buffer_load_dwordx4 v[220:223], v16, s[4:7], s25 offen offset:1024 sc1
    s_bitset1_b32 s89, 2
sl6_2:
    s_bitcmp1_b32 s89, 3
    s_cbranch_scc1 sl6_3
    s_bitcmp1_b32 s80, s73
    s_cbranch_scc0 sl6_3
    s_add_u32 s25, s62, s53
    buffer_load_dwordx4 a[24:27], v16, s[4:7], s25 offen sc1
    buffer_load_dwordx4 a[28:31], v16, s[4:7], s25 offen offset:1024 sc1
    s_add_u32 s25, s25, 14336
    buffer_load_dwordx4 a[80:83], v16, s[4:7], s25 offen sc1
    buffer_load_dwordx4 a[84:87], v16, s[4:7], s25 offen offset:1024 sc1
    s_add_u32 s25, s25, 14336
    buffer_load_dwordx4 a[136:139], v16, s[4:7], s25 offen sc1
    buffer_load_dwordx4 a[140:143], v16, s[4:7], s25 offen offset:1024 sc1
    s_add_u32 s25, s25, 14336
    buffer_load_dwordx4 a[192:195], v16, s[4:7], s25 offen sc1
    buffer_load_dwordx4 a[196:199], v16, s[4:7], s25 offen offset:1024 sc1
    s_add_u32 s25, s25, 14336
    buffer_load_dwordx4 a[248:251], v16, s[4:7], s25 offen sc1
    buffer_load_dwordx4 a[252:255], v16, s[4:7], s25 offen offset:1024 sc1
    s_add_u32 s25, s25, 14336
    buffer_load_dwordx4 v[168:171], v16, s[4:7], s25 offen sc1
    buffer_load_dwordx4 v[172:175], v16, s[4:7], s25 offen offset:1024 sc1
    s_add_u32 s25, s25, 14336
    buffer_load_dwordx4 v[224:227], v16, s[4:7], s25 offen sc1
    buffer_load_dwordx4 v[228:231], v16, s[4:7], s25 offen offset:1024 sc1
    s_bitset1_b32 s89, 3
sl6_3:
    s_bitcmp1_b32 s89, 4
    s_cbranch_scc1 sl6_4
    s_bitcmp1_b32 s80, s74
    s_cbranch_scc0 sl6_4
    s_add_u32 s25, s62, s54
    buffer_load_dwordx4 a[32:35], v16, s[4:7], s25 offen sc1
    buffer_load_dwordx4 a[36:39], v16, s[4:7], s25 offen offset:1024 sc1
    s_add_u32 s25, s25, 14336
    buffer_load_dwordx4 a[88:91], v16, s[4:7], s25 offen sc1
    buffer_load_dwordx4 a[92:95], v16, s[4:7], s25 offen offset:1024 sc1
    s_add_u32 s25, s25, 14336
    buffer_load_dwordx4 a[144:147], v16, s[4:7], s25 offen sc1
    buffer_load_dwordx4 a[148:151], v16, s[4:7], s25 offen offset:1024 sc1
    s_add_u32 s25, s25, 14336
    buffer_load_dwordx4 a[200:203], v16, s[4:7], s25 offen sc1
    buffer_load_dwordx4 a[204:207], v16, s[4:7], s25 offen offset:1024 sc1
    s_add_u32 s25, s25, 14336
    buffer_load_dwordx4 v[120:123], v16, s[4:7], s25 offen sc1
    buffer_load_dwordx4 v[124:127], v16, s[4:7], s25 offen offset:1024 sc1
    s_add_u32 s25, s25, 14336
    buffer_load_dwordx4 v[176:179], v16, s[4:7], s25 offen sc1
    buffer_load_dwordx4 v[180:183], v16, s[4:7], s25 offen offset:1024 sc1
    s_add_u32 s25, s25, 14336
    buffer_load_dwordx4 v[232:235], v16, s[4:7], s25 offen sc1
    buffer_load_dwordx4 v[236:239], v16, s[4:7], s25 offen offset:1024 sc1
    s_bitset1_b32 s89, 4
sl6_4:
    s_bitcmp1_b32 s89, 5
    s_cbranch_scc1 sl6_5
    s_bitcmp1_b32 s80, s75
    s_cbranch_scc0 sl6_5
    s_add_u32 s25, s62, s55
    buffer_load_dwordx4 a[40:43], v16, s[4:7], s25 offen sc1
    buffer_load_dwordx4 a[44:47], v16, s[4:7], s25 offen offset:1024 sc1
    s_add_u32 s25, s25, 14336
    buffer_load_dwordx4 a[96:99], v16, s[4:7], s25 offen sc1
    buffer_load_dwordx4 a[100:103], v16, s[4:7], s25 offen offset:1024 sc1
    s_add_u32 s25, s25, 14336
    buffer_load_dwordx4 a[152:155], v16, s[4:7], s25 offen sc1
    buffer_load_dwordx4 a[156:159], v16, s[4:7], s25 offen offset:1024 sc1
    s_add_u32 s25, s25, 14336
    buffer_load_dwordx4 a[208:211], v16, s[4:7], s25 offen sc1
    buffer_load_dwordx4 a[212:215], v16, s[4:7], s25 offen offset:1024 sc1
    s_add_u32 s25, s25, 14336
    buffer_load_dwordx4 v[128:131], v16, s[4:7], s25 offen sc1
    buffer_load_dwordx4 v[132:135], v16, s[4:7], s25 offen offset:1024 sc1
    s_add_u32 s25, s25, 14336
    buffer_load_dwordx4 v[184:187], v16, s[4:7], s25 offen sc1
    buffer_load_dwordx4 v[188:191], v16, s[4:7], s25 offen offset:1024 sc1
    s_add_u32 s25, s25, 14336
    buffer_load_dwordx4 v[240:243], v16, s[4:7], s25 offen sc1
    buffer_load_dwordx4 v[244:247], v16, s[4:7], s25 offen offset:1024 sc1
    s_bitset1_b32 s89, 5
sl6_5:
    s_bitcmp1_b32 s89, 6
    s_cbranch_scc1 sl6_6
    s_bitcmp1_b32 s80, s76
    s_cbranch_scc0 sl6_6
    s_add_u32 s25, s62, s56
    buffer_load_dwordx4 a[48:51], v16, s[4:7], s25 offen sc1
    buffer_load_dwordx4 a[52:55], v16, s[4:7], s25 offen offset:1024 sc1
    s_add_u32 s25, s25, 14336
    buffer_load_dwordx4 a[104:107], v16, s[4:7], s25 offen sc1
    buffer_load_dwordx4 a[108:111], v16, s[4:7], s25 offen offset:1024 sc1
    s_add_u32 s25, s25, 14336
    buffer_load_dwordx4 a[160:163], v16, s[4:7], s25 offen sc1
    buffer_load_dwordx4 a[164:167], v16, s[4:7], s25 offen offset:1024 sc1
    s_add_u32 s25, s25, 14336
    buffer_load_dwordx4 a[216:219], v16, s[4:7], s25 offen sc1
    buffer_load_dwordx4 a[220:223], v16, s[4:7], s25 offen offset:1024 sc1
    s_add_u32 s25, s25, 14336
    buffer_load_dwordx4 v[136:139], v16, s[4:7], s25 offen sc1
    buffer_load_dwordx4 v[140:143], v16, s[4:7], s25 offen offset:1024 sc1
    s_add_u32 s25, s25, 14336
    buffer_load_dwordx4 v[192:195], v16, s[4:7], s25 offen sc1
    buffer_load_dwordx4 v[196:199], v16, s[4:7], s25 offen offset:1024 sc1
    s_add_u32 s25, s25, 14336
    buffer_load_dwordx4 v[248:251], v16, s[4:7], s25 offen sc1
    buffer_load_dwordx4 v[252:255], v16, s[4:7], s25 offen offset:1024 sc1
    s_bitset1_b32 s89, 6
sl6_6:
    s_cmp_eq_u32 s89, 127
    s_cbranch_scc1 sl6_ok
    s_cmp_eq_u32 s17, 0
    s_cbranch_scc1 sl6_ok
    s_sub_u32 s17, s17, 1
    s_sleep 8
    s_branch sl6
sl6_ok:

    s_lshl_b32 s25, s9, 13
    v_add_u32 v7, s25, v16
    v_and_b32 v19, 7, v18
    v_lshlrev_b32 v19, 4, v19
    v_add_u32 v19, 65536, v19
    s_mul_i32 s25, s9, 1792
    v_add_u32 v19, s25, v19
    v_lshrrev_b32 v112, 1, v17
    v_and_b32 v113, 1, v17
    v_lshlrev_b32 v114, 8, v112
    v_lshlrev_b32 v115, 3, v113
    v_add3_u32 v8, v19, v114, v115
    v_lshlrev_b32 v114, 3, v112
    v_add_u32 v114, 1024, v114
    v_lshlrev_b32 v115, 2, v112
    v_add_u32 v115, 1536, v115
    v_cmp_eq_u32 vcc, 1, v113
    s_nop 1
    v_cndmask_b32 v116, v114, v115, vcc
    v_add_u32 v9, v19, v116
    v_mov_b32 v116, 4
    v_mov_b32 v117, 128
    v_cndmask_b32 v116, v116, v117, vcc
    v_add_u32 v10, v9, v116
    v_add_u32 v114, 256, v114
    v_add_u32 v115, 8, v115
    v_cndmask_b32 v117, v114, v115, vcc
    v_add_u32 v11, v19, v117
    v_add_u32 v12, v11, v116
    v_lshlrev_b32 v114, 2, v113
    v_lshl_add_u32 v114, v112, 1, v114
    v_lshlrev_b32 v114, 6, v114
    v_add_u32 v114, v114, v18
    s_lshl_b32 s25, s9, 9
    v_add_u32 v114, s25, v114
    v_lshlrev_b32 v114, 2, v114
    v_add_u32 v13, 73728, v114
    v_lshrrev_b32 v114, 5, v0
    s_lshl_b32 s25, s9, 1
    v_add_u32 v114, s25, v114
    v_and_b32 v115, 31, v0
    v_lshlrev_b32 v116, 1, v115
    v_add_u32 v117, 8, v116
    v_cmp_gt_u32 vcc, 4, v115
    s_nop 1
    v_cndmask_b32 v117, v117, v116, vcc
    v_mov_b32 v118, 48
    v_cmp_gt_u32 vcc, 20, v115
    s_nop 1
    v_cndmask_b32 v117, v118, v117, vcc
    v_lshlrev_b32 v118, 6, v114
    v_add_u32 v118, v118, v117
    v_lshlrev_b32 v118, 2, v118
    v_add_u32 v14, 73728, v118
    v_lshlrev_b32 v118, 4, v114
    v_and_b32 v119, 3, v115
    v_lshl_add_u32 v118, v119, 2, v118
    v_lshrrev_b32 v119, 2, v115
    v_lshl_add_u32 v118, v119, 7, v118
    v_mov_b32 v119, 0x7fff0000
    v_cndmask_b32 v15, v119, v118, vcc
    v_mov_b32 v118, 0x7f800000
    v_mov_b32 v119, 0x42700000
    v_cndmask_b32 v17, v118, v119, vcc
    v_and_b32 v114, 7, v18
    v_lshlrev_b32 v115, 2, v113
    v_sub_u32 v114, v114, v115
    v_and_b32 v115, 1, v114
    v_mov_b32 v116, 0x3f80
    v_mov_b32 v117, 0x3f800000
    v_cmp_eq_u32 vcc, 1, v115
    s_nop 1
    v_cndmask_b32 v116, v116, v117, vcc
    v_lshrrev_b32 v115, 1, v114
    v_lshrrev_b32 v117, 3, v18
    v_lshlrev_b32 v117, 1, v117
    v_add_u32 v117, v117, v115
    v_cmp_gt_u32 vcc, 4, v114
    v_mov_b32 v115, 99
    s_nop 0
    v_cndmask_b32 v117, v115, v117, vcc

    v_cmp_eq_u32 vcc, 0, v117
    s_nop 1
    v_cndmask_b32 v20, 0, v116, vcc
    v_cmp_eq_u32 vcc, 1, v117
    s_nop 1
    v_cndmask_b32 v21, 0, v116, vcc
    v_cmp_eq_u32 vcc, 2, v117
    s_nop 1
    v_cndmask_b32 v22, 0, v116, vcc
    v_cmp_eq_u32 vcc, 3, v117
    s_nop 1
    v_cndmask_b32 v23, 0, v116, vcc

    v_mov_b32 v114, 0
    v_mov_b32 v115, 0
    v_lshlrev_b32 v116, 3, v0
    v_add_u32 v116, 72704, v116
    ds_write_b64 v116, v[114:115]
    v_lshrrev_b32 v116, 3, v0
    v_lshlrev_b32 v116, 6, v116
    v_and_b32 v117, 7, v0
    v_lshlrev_b32 v117, 1, v117
    v_add3_u32 v116, v116, v117, 48
    s_lshl_b32 s25, s9, 9
    v_add_u32 v116, s25, v116
    v_lshlrev_b32 v116, 2, v116
    v_add_u32 v116, 73728, v116
    s_cmp_eq_u32 s9, 0
    s_cselect_b32 s25, 0xff800000, 0
    v_mov_b32 v114, s25
    v_mov_b32 v115, s25
    ds_write_b64 v116, v[114:115]
    s_mov_b32 s48, 1035512379
    s_mov_b32 s49, 1035512379
    s_mov_b32 s8, 0
    s_mov_b32 s44, 16777216
    s_mul_i32 s45, s11, 640
    s_add_u32 s45, s45, 17711104
    s_waitcnt vmcnt(0) lgkmcnt(0)
    s_barrier

    v_mov_b32 v52, 0
    v_mov_b32 v53, 0
    v_mov_b32 v54, 0
    v_mov_b32 v55, 0
    v_mov_b32 v56, 0
    v_mov_b32 v57, 0
    v_mov_b32 v58, 0
    v_mov_b32 v59, 0
    v_mov_b32 v60, 0
    v_mov_b32 v61, 0
    v_mov_b32 v62, 0
    v_mov_b32 v63, 0
    v_mov_b32 v64, 0
    v_mov_b32 v65, 0
    v_mov_b32 v66, 0
    v_mov_b32 v67, 0
    v_mov_b32 v68, 0
    v_mov_b32 v69, 0
    v_mov_b32 v70, 0
    v_mov_b32 v71, 0
    v_mov_b32 v72, 0
    v_mov_b32 v73, 0
    v_mov_b32 v74, 0
    v_mov_b32 v75, 0
    v_mov_b32 v76, 0
    v_mov_b32 v77, 0
    v_mov_b32 v78, 0
    v_mov_b32 v79, 0
    v_mov_b32 v84, 0
    v_mov_b32 v85, 0
    v_mov_b32 v86, 0
    v_mov_b32 v87, 0
    v_mov_b32 v88, 0
    v_mov_b32 v89, 0
    v_mov_b32 v90, 0
    v_mov_b32 v91, 0
    v_mov_b32 v92, 0
    v_mov_b32 v93, 0
    v_mov_b32 v94, 0
    v_mov_b32 v95, 0
sc1_loop:
    buffer_load_dwordx4 v[24:27], v2, s[4:7], s44 offen sc1
    buffer_load_dwordx4 v[28:31], v2, s[4:7], s44 offen offset:1024 sc1
    buffer_load_dwordx4 v[96:99], v2, s[4:7], s44 offen sc1
    buffer_load_dwordx4 v[100:103], v2, s[4:7], s44 offen offset:1024 sc1
sc1_poll:
    s_waitcnt vmcnt(2)
    v_max3_u32 v112, v24, v25, v26
    v_max3_u32 v113, v27, v28, v29
    v_max3_u32 v112, v112, v30, v31
    v_max_u32 v112, v112, v113
    v_cmp_eq_u32 vcc, -1, v112
    s_cbranch_vccnz sc1_notA
sc1_goA:
    v_smfmac_f32_16x16x64_bf16 v[52:55], v[24:27], a[0:7], v1
    ds_write_b128 v3, v[24:27]
    v_smfmac_f32_16x16x64_bf16 v[56:59], v[24:27], a[56:63], v1
    ds_write_b128 v3, v[28:31] offset:1024
    v_smfmac_f32_16x16x64_bf16 v[60:63], v[24:27], a[112:119], v1
    v_smfmac_f32_16x16x64_bf16 v[64:67], v[24:27], a[168:175], v1
    v_smfmac_f32_16x16x64_bf16 v[68:71], v[24:27], a[224:231], v1
    v_smfmac_f32_16x16x64_bf16 v[72:75], v[24:27], v[144:151], v1
    v_smfmac_f32_16x16x64_bf16 v[76:79], v[24:27], v[200:207], v1
    v_smfmac_f32_16x16x64_bf16 v[52:55], v[28:31], a[8:15], v1
    v_smfmac_f32_16x16x64_bf16 v[56:59], v[28:31], a[64:71], v1
    s_waitcnt lgkmcnt(0)
    s_barrier
    ds_read_b128 v[32:35], v4
    ds_read_b128 v[36:39], v4 offset:1024
    v_smfmac_f32_16x16x64_bf16 v[60:63], v[28:31], a[120:127], v1
    ds_read_b128 v[40:43], v5
    ds_read_b128 v[44:47], v5 offset:1024
    v_smfmac_f32_16x16x64_bf16 v[64:67], v[28:31], a[176:183], v1
    ds_read_b128 v[48:51], v6
    v_smfmac_f32_16x16x64_bf16 v[68:71], v[28:31], a[232:239], v1
    v_smfmac_f32_16x16x64_bf16 v[72:75], v[28:31], v[152:159], v1
    v_smfmac_f32_16x16x64_bf16 v[76:79], v[28:31], v[208:215], v1
sc1_p2:
    s_waitcnt lgkmcnt(4)
    v_smfmac_f32_16x16x64_bf16 v[52:55], v[32:35], a[16:23], v1
    v_smfmac_f32_16x16x64_bf16 v[56:59], v[32:35], a[72:79], v1
    s_waitcnt lgkmcnt(3)
    v_smfmac_f32_16x16x64_bf16 v[52:55], v[36:39], a[24:31], v1
    v_smfmac_f32_16x16x64_bf16 v[56:59], v[36:39], a[80:87], v1
    s_waitcnt lgkmcnt(2)
    v_smfmac_f32_16x16x64_bf16 v[52:55], v[40:43], a[32:39], v1
    v_smfmac_f32_16x16x64_bf16 v[56:59], v[40:43], a[88:95], v1
    s_waitcnt lgkmcnt(1)
    v_smfmac_f32_16x16x64_bf16 v[52:55], v[44:47], a[40:47], v1
    v_smfmac_f32_16x16x64_bf16 v[56:59], v[44:47], a[96:103], v1
    s_waitcnt lgkmcnt(0)
    v_smfmac_f32_16x16x64_bf16 v[52:55], v[48:51], a[48:55], v1
    v_smfmac_f32_16x16x64_bf16 v[56:59], v[48:51], a[104:111], v1
    s_waitcnt vmcnt(0)
    ds_read_b128 v[96:99], v7 offset:0
    v_smfmac_f32_16x16x64_bf16 v[60:63], v[32:35], a[128:135], v1
    ds_read_b128 v[100:103], v7 offset:1024
    v_cvt_pk_bf16_f32 v80, v52, v53
    v_smfmac_f32_16x16x64_bf16 v[60:63], v[36:39], a[136:143], v1
    ds_read_b128 v[104:107], v7 offset:2048
    v_cvt_pk_bf16_f32 v81, v54, v55
    v_smfmac_f32_16x16x64_bf16 v[60:63], v[40:43], a[144:151], v1
    ds_read_b128 v[108:111], v7 offset:3072
    v_cvt_pk_bf16_f32 v82, v56, v57
    v_smfmac_f32_16x16x64_bf16 v[60:63], v[44:47], a[152:159], v1
    ds_read2_b32 v[24:25], v8 offset0:0 offset1:32
    v_cvt_pk_bf16_f32 v83, v58, v59
    v_smfmac_f32_16x16x64_bf16 v[60:63], v[48:51], a[160:167], v1
    v_mfma_f32_16x16x32_bf16 v[52:55], v[80:83], v[20:23], 0
    v_smfmac_f32_16x16x64_bf16 v[64:67], v[32:35], a[184:191], v1
    ds_read2_b32 v[26:27], v8 offset0:1 offset1:33
    v_smfmac_f32_16x16x64_bf16 v[64:67], v[36:39], a[192:199], v1
    ds_read2_b32 v[28:29], v8 offset0:128 offset1:160
    v_cvt_pk_bf16_f32 v56, v52, v53
    v_smfmac_f32_16x16x64_bf16 v[64:67], v[40:43], a[200:207], v1
    ds_read2_b32 v[30:31], v8 offset0:129 offset1:161
    v_cvt_pk_bf16_f32 v57, v54, v55
    v_smfmac_f32_16x16x64_bf16 v[64:67], v[44:47], a[208:215], v1
    v_cvt_pk_bf16_f32 v80, v60, v61
    v_smfmac_f32_16x16x64_bf16 v[64:67], v[48:51], a[216:223], v1
    v_cvt_pk_bf16_f32 v81, v62, v63
    v_smfmac_f32_16x16x64_bf16 v[68:71], v[32:35], a[240:247], v1
    v_smfmac_f32_16x16x64_bf16 v[68:71], v[36:39], a[248:255], v1
    v_cvt_pk_bf16_f32 v82, v64, v65
    v_smfmac_f32_16x16x64_bf16 v[68:71], v[40:43], v[120:127], v1
    v_cvt_pk_bf16_f32 v83, v66, v67
    v_smfmac_f32_16x16x64_bf16 v[68:71], v[44:47], v[128:135], v1
    s_waitcnt lgkmcnt(0)
    v_mfma_f32_16x16x32_bf16 v[60:63], v[80:83], v[20:23], 0
    v_smfmac_f32_16x16x64_bf16 v[68:71], v[48:51], v[136:143], v1
    ds_read2_b32 v[64:65], v11 offset0:0 offset1:32
    v_smfmac_f32_16x16x64_bf16 v[72:75], v[32:35], v[160:167], v1
    ds_read2_b32 v[66:67], v12 offset0:0 offset1:32
    v_cvt_pk_bf16_f32 v58, v60, v61
    v_smfmac_f32_16x16x64_bf16 v[72:75], v[36:39], v[168:175], v1
    v_cvt_pk_bf16_f32 v59, v62, v63
    v_smfmac_f32_16x16x64_bf16 v[72:75], v[40:43], v[176:183], v1
    ds_read2_b32 v[60:61], v9 offset0:0 offset1:32
    v_cvt_pk_bf16_f32 v80, v68, v69
    v_smfmac_f32_16x16x64_bf16 v[72:75], v[44:47], v[184:191], v1
    ds_read2_b32 v[62:63], v10 offset0:0 offset1:32
    v_cvt_pk_bf16_f32 v81, v70, v71
    v_smfmac_f32_16x16x64_bf16 v[72:75], v[48:51], v[192:199], v1
    v_smfmac_f32_16x16x64_bf16 v[76:79], v[32:35], v[216:223], v1
    ds_read_b128 v[32:35], v7 offset:4096
    v_smfmac_f32_16x16x64_bf16 v[76:79], v[36:39], v[224:231], v1
    ds_read_b128 v[36:39], v7 offset:5120
    v_cvt_pk_bf16_f32 v82, v72, v73
    v_smfmac_f32_16x16x64_bf16 v[76:79], v[40:43], v[232:239], v1
    ds_read_b128 v[40:43], v7 offset:6144
    v_cvt_pk_bf16_f32 v83, v74, v75
    v_smfmac_f32_16x16x64_bf16 v[76:79], v[44:47], v[240:247], v1
    ds_read_b128 v[44:47], v7 offset:7168
    v_smfmac_f32_16x16x64_bf16 v[76:79], v[48:51], v[248:255], v1
    v_mfma_f32_16x16x32_bf16 v[68:71], v[80:83], v[20:23], 0
    v_smfmac_f32_16x16x64_bf16 v[88:91], v[56:59], v[96:103], v1
    v_cvt_pk_bf16_f32 v112, v76, v77
    v_cvt_pk_bf16_f32 v113, v78, v79
    v_smfmac_f32_16x16x64_bf16 v[92:95], v[56:59], v[104:111], v1
    v_cvt_pk_bf16_f32 v52, v68, v69
    v_cvt_pk_bf16_f32 v53, v70, v71
    v_mfma_f32_16x16x16_bf16 v[76:79], v[112:113], v[20:21], 0
    v_smfmac_f32_16x16x64_bf16 v[84:87], v[56:59], v[24:31], v1
    s_nop 3
    v_cvt_pk_bf16_f32 v54, v76, v77
    v_cvt_pk_bf16_f32 v55, v78, v79
    s_waitcnt lgkmcnt(0)
    s_nop 0
    v_smfmac_f32_16x16x64_bf16 v[88:91], v[52:55], v[32:39], v1
    v_smfmac_f32_16x16x64_bf16 v[92:95], v[52:55], v[40:47], v1
    v_smfmac_f32_16x16x64_bf16 v[84:87], v[52:55], v[60:67], v1
    v_permlane32_swap_b32 v88, v90
    v_permlane32_swap_b32 v89, v91
    v_pk_add_f32 v[88:89], v[88:89], v[90:91]
    ds_write2_b32 v13, v88, v89 offset0:16 offset1:80
    v_permlane32_swap_b32 v92, v94
    v_permlane32_swap_b32 v93, v95
    v_pk_add_f32 v[92:93], v[92:93], v[94:95]
    ds_write2_b32 v13, v92, v93 offset0:32 offset1:96
    v_permlane32_swap_b32 v84, v86
    v_permlane32_swap_b32 v85, v87
    v_pk_add_f32 v[84:85], v[84:85], v[86:87]
    ds_write2_b32 v13, v84, v85 offset0:0 offset1:64
    s_waitcnt lgkmcnt(0)
    s_barrier
    ds_read2st64_b64 v[24:27], v14 offset0:0 offset1:4
    ds_read2st64_b64 v[28:31], v14 offset0:8 offset1:12
    s_waitcnt lgkmcnt(0)
    v_pk_add_f32 v[24:25], v[24:25], v[26:27]
    v_pk_add_f32 v[28:29], v[28:29], v[30:31]
    v_pk_add_f32 v[24:25], v[24:25], v[28:29]
    v_pk_mul_f32 v[24:25], v[24:25], s[48:49]
    v_exp_f32 v28, v24
    v_exp_f32 v29, v25
    v_max_f32 v27, |v24|, |v25|
    v_cmp_gt_f32 vcc, v27, v17
    v_add_f32 v26, v28, v29
    s_nop 1
    v_add_f32_dpp v26, v26, v26 row_ror:8 row_mask:0xf bank_mask:0xf
    s_nop 1
    v_add_f32_dpp v26, v26, v26 row_ror:4 row_mask:0xf bank_mask:0xf
    s_nop 1
    v_add_f32_dpp v26, v26, v26 row_ror:2 row_mask:0xf bank_mask:0xf
    s_nop 1
    v_add_f32_dpp v26, v26, v26 row_ror:1 row_mask:0xf bank_mask:0xf
    v_mov_b32 v27, v26
    s_nop 1
    v_permlane16_swap_b32 v26, v27
    v_add_f32 v26, v26, v27
    s_cbranch_vccnz sc1_sm_slow
sc1_sm_back:
    v_rcp_f32 v26, v26
    s_nop 0
    v_pk_mul_f32 v[28:29], v[28:29], v[26:27] op_sel_hi:[1,0]
    v_cvt_pk_bf16_f32 v24, v28, v29
    buffer_store_dword v24, v15, s[4:7], s45 offen sc1
    s_mov_b32 m0, s47
    s_nop 0
    buffer_load_dwordx4 v16, s[4:7], s46 offen offset:0 sc1 lds
    buffer_load_dwordx4 v16, s[4:7], s46 offen offset:1024 sc1 lds
    buffer_load_dwordx4 v16, s[4:7], s46 offen offset:2048 sc1 lds
    buffer_load_dwordx4 v16, s[4:7], s46 offen offset:3072 sc1 lds
    s_add_u32 s24, s47, 4096
    s_mov_b32 m0, s24
    s_add_u32 s25, s46, 4096
    buffer_load_dwordx4 v16, s[4:7], s25 offen offset:0 sc1 lds
    buffer_load_dwordx4 v16, s[4:7], s25 offen offset:1024 sc1 lds
    buffer_load_dwordx4 v16, s[4:7], s25 offen offset:2048 sc1 lds
    buffer_load_dwordx4 v16, s[4:7], s25 offen offset:3072 sc1 lds
    v_mov_b32 v52, 0
    v_mov_b32 v53, 0
    v_mov_b32 v54, 0
    v_mov_b32 v55, 0
    v_mov_b32 v56, 0
    v_mov_b32 v57, 0
    v_mov_b32 v58, 0
    v_mov_b32 v59, 0
    v_mov_b32 v60, 0
    v_mov_b32 v61, 0
    v_mov_b32 v62, 0
    v_mov_b32 v63, 0
    v_mov_b32 v64, 0
    v_mov_b32 v65, 0
    v_mov_b32 v66, 0
    v_mov_b32 v67, 0
    v_mov_b32 v68, 0
    v_mov_b32 v69, 0
    v_mov_b32 v70, 0
    v_mov_b32 v71, 0
    v_mov_b32 v72, 0
    v_mov_b32 v73, 0
    v_mov_b32 v74, 0
    v_mov_b32 v75, 0
    v_mov_b32 v76, 0
    v_mov_b32 v77, 0
    v_mov_b32 v78, 0
    v_mov_b32 v79, 0
    v_mov_b32 v84, 0
    v_mov_b32 v85, 0
    v_mov_b32 v86, 0
    v_mov_b32 v87, 0
    v_mov_b32 v88, 0
    v_mov_b32 v89, 0
    v_mov_b32 v90, 0
    v_mov_b32 v91, 0
    v_mov_b32 v92, 0
    v_mov_b32 v93, 0
    v_mov_b32 v94, 0
    v_mov_b32 v95, 0
    s_add_u32 s8, s8, 1
    s_add_u32 s44, s44, 7168
    s_add_u32 s45, s45, 10240
    s_add_u32 s46, s46, 32768
    s_xor_b32 s47, s47, 32768
    v_xor_b32 v7, 32768, v7
    s_cmp_lt_u32 s8, 63
    s_cbranch_scc1 sc1_loop
    s_endpgm
sc1_notA:
    buffer_load_dwordx4 v[24:27], v2, s[4:7], s44 offen sc1
    buffer_load_dwordx4 v[28:31], v2, s[4:7], s44 offen offset:1024 sc1
    s_waitcnt vmcnt(2)
    v_max3_u32 v112, v96, v97, v98
    v_max3_u32 v113, v99, v100, v101
    v_max3_u32 v112, v112, v102, v103
    v_max_u32 v112, v112, v113
    v_cmp_eq_u32 vcc, -1, v112
    s_cbranch_vccz sc1_goB
    s_cmp_eq_u32 s17, 0
    s_cbranch_scc1 sc1_goB
    s_sub_u32 s17, s17, 1
    buffer_load_dwordx4 v[96:99], v2, s[4:7], s44 offen sc1
    buffer_load_dwordx4 v[100:103], v2, s[4:7], s44 offen offset:1024 sc1
    s_branch sc1_poll
sc1_goB:
    v_smfmac_f32_16x16x64_bf16 v[52:55], v[96:99], a[0:7], v1
    ds_write_b128 v3, v[96:99]
    v_smfmac_f32_16x16x64_bf16 v[56:59], v[96:99], a[56:63], v1
    ds_write_b128 v3, v[100:103] offset:1024
    v_smfmac_f32_16x16x64_bf16 v[60:63], v[96:99], a[112:119], v1
    v_smfmac_f32_16x16x64_bf16 v[64:67], v[96:99], a[168:175], v1
    v_smfmac_f32_16x16x64_bf16 v[68:71], v[96:99], a[224:231], v1
    v_smfmac_f32_16x16x64_bf16 v[72:75], v[96:99], v[144:151], v1
    v_smfmac_f32_16x16x64_bf16 v[76:79], v[96:99], v[200:207], v1
    v_smfmac_f32_16x16x64_bf16 v[52:55], v[100:103], a[8:15], v1
    v_smfmac_f32_16x16x64_bf16 v[56:59], v[100:103], a[64:71], v1
    s_waitcnt lgkmcnt(0)
    s_barrier
    ds_read_b128 v[32:35], v4
    ds_read_b128 v[36:39], v4 offset:1024
    v_smfmac_f32_16x16x64_bf16 v[60:63], v[100:103], a[120:127], v1
    ds_read_b128 v[40:43], v5
    ds_read_b128 v[44:47], v5 offset:1024
    v_smfmac_f32_16x16x64_bf16 v[64:67], v[100:103], a[176:183], v1
    ds_read_b128 v[48:51], v6
    v_smfmac_f32_16x16x64_bf16 v[68:71], v[100:103], a[232:239], v1
    v_smfmac_f32_16x16x64_bf16 v[72:75], v[100:103], v[152:159], v1
    v_smfmac_f32_16x16x64_bf16 v[76:79], v[100:103], v[208:215], v1
    s_branch sc1_p2
sc1_sm_slow:
    v_max_f32 v26, v24, v25
    s_nop 1
    v_max_f32_dpp v26, v26, v26 row_ror:8 row_mask:0xf bank_mask:0xf
    s_nop 1
    v_max_f32_dpp v26, v26, v26 row_ror:4 row_mask:0xf bank_mask:0xf
    s_nop 1
    v_max_f32_dpp v26, v26, v26 row_ror:2 row_mask:0xf bank_mask:0xf
    s_nop 1
    v_max_f32_dpp v26, v26, v26 row_ror:1 row_mask:0xf bank_mask:0xf
    v_mov_b32 v27, v26
    s_nop 1
    v_permlane16_swap_b32 v26, v27
    v_max_f32 v26, v26, v27
    v_sub_f32 v24, v24, v26
    v_sub_f32 v25, v25, v26
    v_exp_f32 v28, v24
    v_exp_f32 v29, v25
    s_nop 0
    v_add_f32 v26, v28, v29
    s_nop 1
    v_add_f32_dpp v26, v26, v26 row_ror:8 row_mask:0xf bank_mask:0xf
    s_nop 1
    v_add_f32_dpp v26, v26, v26 row_ror:4 row_mask:0xf bank_mask:0xf
    s_nop 1
    v_add_f32_dpp v26, v26, v26 row_ror:2 row_mask:0xf bank_mask:0xf
    s_nop 1
    v_add_f32_dpp v26, v26, v26 row_ror:1 row_mask:0xf bank_mask:0xf
    v_mov_b32 v27, v26
    s_nop 1
    v_permlane16_swap_b32 v26, v27
    v_add_f32 v26, v26, v27
    s_branch sc1_sm_back
va1_start:

    v_lshrrev_b32 v16, 4, v0
    v_and_b32 v17, 15, v0
    v_bfe_u32 v18, v0, 3, 1
    v_mul_u32_u24 v1, 0xaaaa, v18
    v_add_u32 v1, 0x4444, v1
    v_lshlrev_b32 v13, 4, v0
    s_lshl_b32 s24, s9, 1
    s_min_u32 s24, s24, 5
    s_lshl_b32 s25, s24, 10
    v_add_u32 v2, s25, v13
    v_add_u32 v3, 98304, v2
    v_add_u32 v4, 98304, v13
    s_lshl_b32 s25, s9, 13
    v_add_u32 v6, s25, v13
    v_add_u32 v5, 65536, v6
    s_lshl_b32 s24, s11, 4
    s_lshl_b32 s25, s9, 2
    s_add_u32 s24, s24, s25
    s_mul_i32 s24, s24, 28672
    s_add_u32 s24, s24, 10354688

    s_mov_b32 s62, s24
    v_mbcnt_lo_u32_b32 v38, -1, 0
    v_mbcnt_hi_u32_b32 v38, -1, v38
    v_mul_u32_u24 v37, 37, v38
    v_lshrrev_b32 v37, 8, v37
    v_mul_u32_u24 v37, 7, v37
    v_cmp_gt_u32 vcc, 28, v38
    v_add_u32 v38, v38, v37
    s_mul_i32 s24, s9, 56
    s_add_u32 s24, s24, 7
    v_add_u32 v38, s24, v38
    v_lshlrev_b32 v38, 7, v38
    v_add_u32 v38, 57753600, v38
    v_mov_b32 v37, 0x7fff0000
    v_cndmask_b32 v38, v37, v38, vcc
    s_mov_b32 s89, 0
sl7:
    buffer_load_dword v36, v38, s[4:7], 0 offen sc1
    s_waitcnt vmcnt(0)
    v_cmp_eq_u32 s[80:81], s18, v36
    s_bitcmp1_b32 s89, 0
    s_cbranch_scc1 sl7_0
    s_bitcmp1_b32 s80, 0
    s_cbranch_scc0 sl7_0
    s_add_u32 s26, s62, 0
    buffer_load_dwordx4 a[0:3], v13, s[4:7], s26 offen sc1
    buffer_load_dwordx4 a[4:7], v13, s[4:7], s26 offen offset:1024 sc1
    s_add_u32 s26, s62, 14336
    buffer_load_dwordx4 a[56:59], v13, s[4:7], s26 offen sc1
    buffer_load_dwordx4 a[60:63], v13, s[4:7], s26 offen offset:1024 sc1
    s_bitset1_b32 s89, 0
sl7_0:
    s_bitcmp1_b32 s89, 1
    s_cbranch_scc1 sl7_1
    s_bitcmp1_b32 s80, 1
    s_cbranch_scc0 sl7_1
    s_add_u32 s26, s62, 2048
    buffer_load_dwordx4 a[8:11], v13, s[4:7], s26 offen sc1
    buffer_load_dwordx4 a[12:15], v13, s[4:7], s26 offen offset:1024 sc1
    s_add_u32 s26, s62, 16384
    buffer_load_dwordx4 a[64:67], v13, s[4:7], s26 offen sc1
    buffer_load_dwordx4 a[68:71], v13, s[4:7], s26 offen offset:1024 sc1
    s_bitset1_b32 s89, 1
sl7_1:
    s_bitcmp1_b32 s89, 2
    s_cbranch_scc1 sl7_2
    s_bitcmp1_b32 s80, 2
    s_cbranch_scc0 sl7_2
    s_add_u32 s26, s62, 4096
    buffer_load_dwordx4 a[16:19], v13, s[4:7], s26 offen sc1
    buffer_load_dwordx4 a[20:23], v13, s[4:7], s26 offen offset:1024 sc1
    s_add_u32 s26, s62, 18432
    buffer_load_dwordx4 a[72:75], v13, s[4:7], s26 offen sc1
    buffer_load_dwordx4 a[76:79], v13, s[4:7], s26 offen offset:1024 sc1
    s_bitset1_b32 s89, 2
sl7_2:
    s_bitcmp1_b32 s89, 3
    s_cbranch_scc1 sl7_3
    s_bitcmp1_b32 s80, 3
    s_cbranch_scc0 sl7_3
    s_add_u32 s26, s62, 6144
    buffer_load_dwordx4 a[24:27], v13, s[4:7], s26 offen sc1
    buffer_load_dwordx4 a[28:31], v13, s[4:7], s26 offen offset:1024 sc1
    s_add_u32 s26, s62, 20480
    buffer_load_dwordx4 a[80:83], v13, s[4:7], s26 offen sc1
    buffer_load_dwordx4 a[84:87], v13, s[4:7], s26 offen offset:1024 sc1
    s_bitset1_b32 s89, 3
sl7_3:
    s_bitcmp1_b32 s89, 4
    s_cbranch_scc1 sl7_4
    s_bitcmp1_b32 s80, 4
    s_cbranch_scc0 sl7_4
    s_add_u32 s26, s62, 8192
    buffer_load_dwordx4 a[32:35], v13, s[4:7], s26 offen sc1
    buffer_load_dwordx4 a[36:39], v13, s[4:7], s26 offen offset:1024 sc1
    s_add_u32 s26, s62, 22528
    buffer_load_dwordx4 a[88:91], v13, s[4:7], s26 offen sc1
    buffer_load_dwordx4 a[92:95], v13, s[4:7], s26 offen offset:1024 sc1
    s_bitset1_b32 s89, 4
sl7_4:
    s_bitcmp1_b32 s89, 5
    s_cbranch_scc1 sl7_5
    s_bitcmp1_b32 s80, 5
    s_cbranch_scc0 sl7_5
    s_add_u32 s26, s62, 10240
    buffer_load_dwordx4 a[40:43], v13, s[4:7], s26 offen sc1
    buffer_load_dwordx4 a[44:47], v13, s[4:7], s26 offen offset:1024 sc1
    s_add_u32 s26, s62, 24576
    buffer_load_dwordx4 a[96:99], v13, s[4:7], s26 offen sc1
    buffer_load_dwordx4 a[100:103], v13, s[4:7], s26 offen offset:1024 sc1
    s_bitset1_b32 s89, 5
sl7_5:
    s_bitcmp1_b32 s89, 6
    s_cbranch_scc1 sl7_6
    s_bitcmp1_b32 s80, 6
    s_cbranch_scc0 sl7_6
    s_add_u32 s26, s62, 12288
    buffer_load_dwordx4 a[48:51], v13, s[4:7], s26 offen sc1
    buffer_load_dwordx4 a[52:55], v13, s[4:7], s26 offen offset:1024 sc1
    s_add_u32 s26, s62, 26624
    buffer_load_dwordx4 a[104:107], v13, s[4:7], s26 offen sc1
    buffer_load_dwordx4 a[108:111], v13, s[4:7], s26 offen offset:1024 sc1
    s_bitset1_b32 s89, 6
sl7_6:
    s_bitcmp1_b32 s89, 7
    s_cbranch_scc1 sl7_7
    s_bitcmp1_b32 s80, 7
    s_cbranch_scc0 sl7_7
    s_add_u32 s26, s62, 28672
    buffer_load_dwordx4 a[112:115], v13, s[4:7], s26 offen sc1
    buffer_load_dwordx4 a[116:119], v13, s[4:7], s26 offen offset:1024 sc1
    s_add_u32 s26, s62, 43008
    buffer_load_dwordx4 a[168:171], v13, s[4:7], s26 offen sc1
    buffer_load_dwordx4 a[172:175], v13, s[4:7], s26 offen offset:1024 sc1
    s_bitset1_b32 s89, 7
sl7_7:
    s_bitcmp1_b32 s89, 8
    s_cbranch_scc1 sl7_8
    s_bitcmp1_b32 s80, 8
    s_cbranch_scc0 sl7_8
    s_add_u32 s26, s62, 30720
    buffer_load_dwordx4 a[120:123], v13, s[4:7], s26 offen sc1
    buffer_load_dwordx4 a[124:127], v13, s[4:7], s26 offen offset:1024 sc1
    s_add_u32 s26, s62, 45056
    buffer_load_dwordx4 a[176:179], v13, s[4:7], s26 offen sc1
    buffer_load_dwordx4 a[180:183], v13, s[4:7], s26 offen offset:1024 sc1
    s_bitset1_b32 s89, 8
sl7_8:
    s_bitcmp1_b32 s89, 9
    s_cbranch_scc1 sl7_9
    s_bitcmp1_b32 s80, 9
    s_cbranch_scc0 sl7_9
    s_add_u32 s26, s62, 32768
    buffer_load_dwordx4 a[128:131], v13, s[4:7], s26 offen sc1
    buffer_load_dwordx4 a[132:135], v13, s[4:7], s26 offen offset:1024 sc1
    s_add_u32 s26, s62, 47104
    buffer_load_dwordx4 a[184:187], v13, s[4:7], s26 offen sc1
    buffer_load_dwordx4 a[188:191], v13, s[4:7], s26 offen offset:1024 sc1
    s_bitset1_b32 s89, 9
sl7_9:
    s_bitcmp1_b32 s89, 10
    s_cbranch_scc1 sl7_10
    s_bitcmp1_b32 s80, 10
    s_cbranch_scc0 sl7_10
    s_add_u32 s26, s62, 34816
    buffer_load_dwordx4 a[136:139], v13, s[4:7], s26 offen sc1
    buffer_load_dwordx4 a[140:143], v13, s[4:7], s26 offen offset:1024 sc1
    s_add_u32 s26, s62, 49152
    buffer_load_dwordx4 a[192:195], v13, s[4:7], s26 offen sc1
    buffer_load_dwordx4 a[196:199], v13, s[4:7], s26 offen offset:1024 sc1
    s_bitset1_b32 s89, 10
sl7_10:
    s_bitcmp1_b32 s89, 11
    s_cbranch_scc1 sl7_11
    s_bitcmp1_b32 s80, 11
    s_cbranch_scc0 sl7_11
    s_add_u32 s26, s62, 36864
    buffer_load_dwordx4 a[144:147], v13, s[4:7], s26 offen sc1
    buffer_load_dwordx4 a[148:151], v13, s[4:7], s26 offen offset:1024 sc1
    s_add_u32 s26, s62, 51200
    buffer_load_dwordx4 a[200:203], v13, s[4:7], s26 offen sc1
    buffer_load_dwordx4 a[204:207], v13, s[4:7], s26 offen offset:1024 sc1
    s_bitset1_b32 s89, 11
sl7_11:
    s_bitcmp1_b32 s89, 12
    s_cbranch_scc1 sl7_12
    s_bitcmp1_b32 s80, 12
    s_cbranch_scc0 sl7_12
    s_add_u32 s26, s62, 38912
    buffer_load_dwordx4 a[152:155], v13, s[4:7], s26 offen sc1
    buffer_load_dwordx4 a[156:159], v13, s[4:7], s26 offen offset:1024 sc1
    s_add_u32 s26, s62, 53248
    buffer_load_dwordx4 a[208:211], v13, s[4:7], s26 offen sc1
    buffer_load_dwordx4 a[212:215], v13, s[4:7], s26 offen offset:1024 sc1
    s_bitset1_b32 s89, 12
sl7_12:
    s_bitcmp1_b32 s89, 13
    s_cbranch_scc1 sl7_13
    s_bitcmp1_b32 s80, 13
    s_cbranch_scc0 sl7_13
    s_add_u32 s26, s62, 40960
    buffer_load_dwordx4 a[160:163], v13, s[4:7], s26 offen sc1
    buffer_load_dwordx4 a[164:167], v13, s[4:7], s26 offen offset:1024 sc1
    s_add_u32 s26, s62, 55296
    buffer_load_dwordx4 a[216:219], v13, s[4:7], s26 offen sc1
    buffer_load_dwordx4 a[220:223], v13, s[4:7], s26 offen offset:1024 sc1
    s_bitset1_b32 s89, 13
sl7_13:
    s_bitcmp1_b32 s89, 14
    s_cbranch_scc1 sl7_14
    s_bitcmp1_b32 s80, 14
    s_cbranch_scc0 sl7_14
    s_add_u32 s26, s62, 57344
    buffer_load_dwordx4 a[224:227], v13, s[4:7], s26 offen sc1
    buffer_load_dwordx4 a[228:231], v13, s[4:7], s26 offen offset:1024 sc1
    s_add_u32 s26, s62, 71680
    buffer_load_dwordx4 v[120:123], v13, s[4:7], s26 offen sc1
    buffer_load_dwordx4 v[124:127], v13, s[4:7], s26 offen offset:1024 sc1
    s_bitset1_b32 s89, 14
sl7_14:
    s_bitcmp1_b32 s89, 15
    s_cbranch_scc1 sl7_15
    s_bitcmp1_b32 s80, 15
    s_cbranch_scc0 sl7_15
    s_add_u32 s26, s62, 59392
    buffer_load_dwordx4 a[232:235], v13, s[4:7], s26 offen sc1
    buffer_load_dwordx4 a[236:239], v13, s[4:7], s26 offen offset:1024 sc1
    s_add_u32 s26, s62, 73728
    buffer_load_dwordx4 v[128:131], v13, s[4:7], s26 offen sc1
    buffer_load_dwordx4 v[132:135], v13, s[4:7], s26 offen offset:1024 sc1
    s_bitset1_b32 s89, 15
sl7_15:
    s_bitcmp1_b32 s89, 16
    s_cbranch_scc1 sl7_16
    s_bitcmp1_b32 s80, 16
    s_cbranch_scc0 sl7_16
    s_add_u32 s26, s62, 61440
    buffer_load_dwordx4 a[240:243], v13, s[4:7], s26 offen sc1
    buffer_load_dwordx4 a[244:247], v13, s[4:7], s26 offen offset:1024 sc1
    s_add_u32 s26, s62, 75776
    buffer_load_dwordx4 v[136:139], v13, s[4:7], s26 offen sc1
    buffer_load_dwordx4 v[140:143], v13, s[4:7], s26 offen offset:1024 sc1
    s_bitset1_b32 s89, 16
sl7_16:
    s_bitcmp1_b32 s89, 17
    s_cbranch_scc1 sl7_17
    s_bitcmp1_b32 s80, 17
    s_cbranch_scc0 sl7_17
    s_add_u32 s26, s62, 63488
    buffer_load_dwordx4 a[248:251], v13, s[4:7], s26 offen sc1
    buffer_load_dwordx4 a[252:255], v13, s[4:7], s26 offen offset:1024 sc1
    s_add_u32 s26, s62, 77824
    buffer_load_dwordx4 v[144:147], v13, s[4:7], s26 offen sc1
    buffer_load_dwordx4 v[148:151], v13, s[4:7], s26 offen offset:1024 sc1
    s_bitset1_b32 s89, 17
sl7_17:
    s_bitcmp1_b32 s89, 18
    s_cbranch_scc1 sl7_18
    s_bitcmp1_b32 s80, 18
    s_cbranch_scc0 sl7_18
    s_add_u32 s26, s62, 65536
    buffer_load_dwordx4 v[96:99], v13, s[4:7], s26 offen sc1
    buffer_load_dwordx4 v[100:103], v13, s[4:7], s26 offen offset:1024 sc1
    s_add_u32 s26, s62, 79872
    buffer_load_dwordx4 v[152:155], v13, s[4:7], s26 offen sc1
    buffer_load_dwordx4 v[156:159], v13, s[4:7], s26 offen offset:1024 sc1
    s_bitset1_b32 s89, 18
sl7_18:
    s_bitcmp1_b32 s89, 19
    s_cbranch_scc1 sl7_19
    s_bitcmp1_b32 s80, 19
    s_cbranch_scc0 sl7_19
    s_add_u32 s26, s62, 67584
    buffer_load_dwordx4 v[104:107], v13, s[4:7], s26 offen sc1
    buffer_load_dwordx4 v[108:111], v13, s[4:7], s26 offen offset:1024 sc1
    s_add_u32 s26, s62, 81920
    buffer_load_dwordx4 v[160:163], v13, s[4:7], s26 offen sc1
    buffer_load_dwordx4 v[164:167], v13, s[4:7], s26 offen offset:1024 sc1
    s_bitset1_b32 s89, 19
sl7_19:
    s_bitcmp1_b32 s89, 20
    s_cbranch_scc1 sl7_20
    s_bitcmp1_b32 s80, 20
    s_cbranch_scc0 sl7_20
    s_add_u32 s26, s62, 69632
    buffer_load_dwordx4 v[112:115], v13, s[4:7], s26 offen sc1
    buffer_load_dwordx4 v[116:119], v13, s[4:7], s26 offen offset:1024 sc1
    s_add_u32 s26, s62, 83968
    buffer_load_dwordx4 v[168:171], v13, s[4:7], s26 offen sc1
    buffer_load_dwordx4 v[172:175], v13, s[4:7], s26 offen offset:1024 sc1
    s_bitset1_b32 s89, 20
sl7_20:
    s_bitcmp1_b32 s89, 21
    s_cbranch_scc1 sl7_21
    s_bitcmp1_b32 s80, 21
    s_cbranch_scc0 sl7_21
    s_add_u32 s26, s62, 86016
    buffer_load_dwordx4 v[176:179], v13, s[4:7], s26 offen sc1
    buffer_load_dwordx4 v[180:183], v13, s[4:7], s26 offen offset:1024 sc1
    s_add_u32 s26, s62, 100352
    buffer_load_dwordx4 v[232:235], v13, s[4:7], s26 offen sc1
    buffer_load_dwordx4 v[236:239], v13, s[4:7], s26 offen offset:1024 sc1
    s_bitset1_b32 s89, 21
sl7_21:
    s_bitcmp1_b32 s89, 22
    s_cbranch_scc1 sl7_22
    s_bitcmp1_b32 s80, 22
    s_cbranch_scc0 sl7_22
    s_add_u32 s26, s62, 88064
    buffer_load_dwordx4 v[184:187], v13, s[4:7], s26 offen sc1
    buffer_load_dwordx4 v[188:191], v13, s[4:7], s26 offen offset:1024 sc1
    s_add_u32 s26, s62, 102400
    buffer_load_dwordx4 v[240:243], v13, s[4:7], s26 offen sc1
    buffer_load_dwordx4 v[244:247], v13, s[4:7], s26 offen offset:1024 sc1
    s_bitset1_b32 s89, 22
sl7_22:
    s_bitcmp1_b32 s89, 23
    s_cbranch_scc1 sl7_23
    s_bitcmp1_b32 s80, 23
    s_cbranch_scc0 sl7_23
    s_add_u32 s26, s62, 90112
    buffer_load_dwordx4 v[192:195], v13, s[4:7], s26 offen sc1
    buffer_load_dwordx4 v[196:199], v13, s[4:7], s26 offen offset:1024 sc1
    s_add_u32 s26, s62, 104448
    buffer_load_dwordx4 v[248:251], v13, s[4:7], s26 offen sc1
    buffer_load_dwordx4 v[252:255], v13, s[4:7], s26 offen offset:1024 sc1
    s_bitset1_b32 s89, 23
sl7_23:
    s_bitcmp1_b32 s89, 24
    s_cbranch_scc1 sl7_24
    s_bitcmp1_b32 s80, 24
    s_cbranch_scc0 sl7_24
    s_add_u32 s26, s62, 92160
    buffer_load_dwordx4 v[200:203], v13, s[4:7], s26 offen sc1
    buffer_load_dwordx4 v[204:207], v13, s[4:7], s26 offen offset:1024 sc1
    s_add_u32 s26, s62, 106496
    s_lshl_b32 s25, s9, 13
    s_add_u32 s25, s25, 65536
    s_mov_b32 m0, s25
    s_nop 0
    buffer_load_dwordx4 v13, s[4:7], s26 offen sc1 lds
    buffer_load_dwordx4 v13, s[4:7], s26 offen offset:1024 sc1 lds
    s_bitset1_b32 s89, 24
sl7_24:
    s_bitcmp1_b32 s89, 25
    s_cbranch_scc1 sl7_25
    s_bitcmp1_b32 s80, 25
    s_cbranch_scc0 sl7_25
    s_add_u32 s26, s62, 94208
    buffer_load_dwordx4 v[208:211], v13, s[4:7], s26 offen sc1
    buffer_load_dwordx4 v[212:215], v13, s[4:7], s26 offen offset:1024 sc1
    s_add_u32 s26, s62, 108544
    s_lshl_b32 s25, s9, 13
    s_add_u32 s25, s25, 67584
    s_mov_b32 m0, s25
    s_nop 0
    buffer_load_dwordx4 v13, s[4:7], s26 offen sc1 lds
    buffer_load_dwordx4 v13, s[4:7], s26 offen offset:1024 sc1 lds
    s_bitset1_b32 s89, 25
sl7_25:
    s_bitcmp1_b32 s89, 26
    s_cbranch_scc1 sl7_26
    s_bitcmp1_b32 s80, 26
    s_cbranch_scc0 sl7_26
    s_add_u32 s26, s62, 96256
    buffer_load_dwordx4 v[216:219], v13, s[4:7], s26 offen sc1
    buffer_load_dwordx4 v[220:223], v13, s[4:7], s26 offen offset:1024 sc1
    s_add_u32 s26, s62, 110592
    s_lshl_b32 s25, s9, 13
    s_add_u32 s25, s25, 69632
    s_mov_b32 m0, s25
    s_nop 0
    buffer_load_dwordx4 v13, s[4:7], s26 offen sc1 lds
    buffer_load_dwordx4 v13, s[4:7], s26 offen offset:1024 sc1 lds
    s_bitset1_b32 s89, 26
sl7_26:
    s_bitcmp1_b32 s89, 27
    s_cbranch_scc1 sl7_27
    s_bitcmp1_b32 s80, 27
    s_cbranch_scc0 sl7_27
    s_add_u32 s26, s62, 98304
    buffer_load_dwordx4 v[224:227], v13, s[4:7], s26 offen sc1
    buffer_load_dwordx4 v[228:231], v13, s[4:7], s26 offen offset:1024 sc1
    s_add_u32 s26, s62, 112640
    s_lshl_b32 s25, s9, 13
    s_add_u32 s25, s25, 71680
    s_mov_b32 m0, s25
    s_nop 0
    buffer_load_dwordx4 v13, s[4:7], s26 offen sc1 lds
    buffer_load_dwordx4 v13, s[4:7], s26 offen offset:1024 sc1 lds
    s_bitset1_b32 s89, 27
sl7_27:
    s_cmp_eq_u32 s89, 268435455
    s_cbranch_scc1 sl7_ok
    s_cmp_eq_u32 s17, 0
    s_cbranch_scc1 sl7_ok
    s_sub_u32 s17, s17, 1
    s_sleep 8
    s_branch sl7
sl7_ok:
    s_mov_b32 s24, 224
    v_mbcnt_lo_u32_b32 v38, -1, 0
    v_mbcnt_hi_u32_b32 v38, -1, v38
    v_cmp_gt_u32 vcc, 32, v38
    v_add_u32 v38, s24, v38
    v_lshlrev_b32 v38, 7, v38
    v_add_u32 v38, 57753600, v38
    v_mov_b32 v36, 0x7fff0000
    v_cndmask_b32 v38, v36, v38, vcc
wm8:
    buffer_load_dword v36, v38, s[4:7], 0 offen sc1
    s_waitcnt vmcnt(0)
    v_cmp_eq_u32 s[80:81], s18, v36
    s_cmp_eq_u32 s80, -1
    s_cbranch_scc1 wm8_ok
    s_cmp_eq_u32 s17, 0
    s_cbranch_scc1 wm8_ok
    s_sub_u32 s17, s17, 1
    s_sleep 8
    s_branch wm8
wm8_ok:

    v_and_b32 v19, 7, v0
    v_lshrrev_b32 v20, 1, v16
    v_and_b32 v21, 1, v16
    s_mul_i32 s25, s9, 2560
    v_lshlrev_b32 v22, 1, v20
    v_add_u32 v22, v22, v18
    v_mul_u32_u24 v22, 640, v22
    v_lshlrev_b32 v23, 4, v19
    v_add3_u32 v7, v22, v23, s25
    v_mul_u32_u24 v22, 640, v20
    v_lshlrev_b32 v23, 1, v21
    v_add3_u32 v23, v23, v18, 1
    v_lshlrev_b32 v23, 7, v23
    v_add3_u32 v22, v22, v23, s25
    v_lshlrev_b32 v23, 4, v19
    v_add_u32 v8, v22, v23
    v_lshlrev_b32 v22, 2, v21
    v_lshl_add_u32 v22, v20, 1, v22
    v_lshlrev_b32 v22, 5, v22
    v_add_u32 v22, v22, v17
    s_lshl_b32 s25, s9, 8
    v_add_u32 v22, s25, v22
    v_lshlrev_b32 v22, 2, v22
    v_add_u32 v10, 106496, v22
    v_lshrrev_b32 v19, 3, v0
    v_and_b32 v20, 7, v0
    v_lshlrev_b32 v22, 5, v19
    v_and_b32 v23, 3, v20
    v_lshlrev_b32 v23, 1, v23
    v_lshrrev_b32 v21, 2, v20
    v_add_u32 v23, v23, v21
    v_lshlrev_b32 v23, 1, v23
    s_and_b32 s25, s9, 1
    s_lshl_b32 s26, s25, 4
    v_add3_u32 v22, v22, v23, s26
    v_lshlrev_b32 v22, 2, v22
    v_add_u32 v11, 106496, v22
    s_and_b32 s26, s11, 1
    s_lshl_b32 s26, s26, 1
    s_add_u32 s26, s26, s25
    s_lshl_b32 s26, s26, 8
    s_lshr_b32 s27, s11, 1
    s_lshl_b32 s27, s27, 10
    s_add_u32 s26, s26, s27
    v_lshrrev_b32 v22, 2, v20
    v_lshlrev_b32 v22, 3, v22
    v_add_u32 v22, v22, v19
    v_lshlrev_b32 v22, 4, v22
    v_and_b32 v23, 3, v20
    v_lshlrev_b32 v23, 2, v23
    v_add3_u32 v12, v22, v23, s26
    s_mov_b32 s8, 0
    s_mov_b32 s44, 16777216
    s_mov_b32 s48, 16784384
    s_mov_b32 s45, 17711104
    s_lshl_b32 s25, s9, 13
    s_mov_b32 s47, s25
    s_lshl_b32 s24, s11, 15
    s_add_u32 s24, s24, s25
    s_add_u32 s46, s24, 18366464
    s_mov_b32 s51, 57688064
    v_mov_b32 v15, s51
    buffer_load_dword v14, v15, s[4:7], 0 offen sc1

va1_cda:
    s_waitcnt vmcnt(0)
    v_readfirstlane_b32 s24, v14
    s_nop 0
    s_cmp_ge_u32 s24, 16
    s_cbranch_scc1 va1_cda_go
    s_cmp_eq_u32 s17, 0
    s_cbranch_scc1 va1_cda_go
    s_sub_u32 s17, s17, 1
    v_mov_b32 v15, s51
    buffer_load_dword v14, v15, s[4:7], 0 offen sc1
    s_branch va1_cda
va1_cda_go:
    s_mov_b32 m0, s47
    s_nop 0
    buffer_load_dwordx4 v13, s[4:7], s46 offen offset:0 sc1 lds
    buffer_load_dwordx4 v13, s[4:7], s46 offen offset:1024 sc1 lds
    buffer_load_dwordx4 v13, s[4:7], s46 offen offset:2048 sc1 lds
    buffer_load_dwordx4 v13, s[4:7], s46 offen offset:3072 sc1 lds
    s_add_u32 s24, s47, 4096
    s_mov_b32 m0, s24
    s_add_u32 s25, s46, 4096
    buffer_load_dwordx4 v13, s[4:7], s25 offen offset:0 sc1 lds
    buffer_load_dwordx4 v13, s[4:7], s25 offen offset:1024 sc1 lds
    buffer_load_dwordx4 v13, s[4:7], s25 offen offset:2048 sc1 lds
    buffer_load_dwordx4 v13, s[4:7], s25 offen offset:3072 sc1 lds
    s_add_u32 s46, s46, 458752
    s_xor_b32 s47, s47, 32768
    s_add_u32 s51, s51, 128
    v_mov_b32 v15, s51
    buffer_load_dword v14, v15, s[4:7], 0 offen sc1

va1_cdb:
    s_waitcnt vmcnt(0)
    v_readfirstlane_b32 s24, v14
    s_nop 0
    s_cmp_ge_u32 s24, 16
    s_cbranch_scc1 va1_cdb_go
    s_cmp_eq_u32 s17, 0
    s_cbranch_scc1 va1_cdb_go
    s_sub_u32 s17, s17, 1
    v_mov_b32 v15, s51
    buffer_load_dword v14, v15, s[4:7], 0 offen sc1
    s_branch va1_cdb
va1_cdb_go:
    s_add_u32 s51, s51, 128
    s_mov_b32 s53, 16
    s_waitcnt vmcnt(0) lgkmcnt(0)
    s_barrier
va1_loop:
    v_mov_b32 v40, 0
    v_mov_b32 v41, 0
    v_mov_b32 v42, 0
    v_mov_b32 v43, 0
    v_mov_b32 v44, 0
    v_mov_b32 v45, 0
    v_mov_b32 v46, 0
    v_mov_b32 v47, 0
    v_mov_b32 v48, 0
    v_mov_b32 v49, 0
    v_mov_b32 v50, 0
    v_mov_b32 v51, 0
    v_mov_b32 v52, 0
    v_mov_b32 v53, 0
    v_mov_b32 v54, 0
    v_mov_b32 v55, 0
    v_mov_b32 v56, 0
    v_mov_b32 v57, 0
    v_mov_b32 v58, 0
    v_mov_b32 v59, 0
    v_mov_b32 v60, 0
    v_mov_b32 v61, 0
    v_mov_b32 v62, 0
    v_mov_b32 v63, 0
    v_mov_b32 v64, 0
    v_mov_b32 v65, 0
    v_mov_b32 v66, 0
    v_mov_b32 v67, 0
    v_mov_b32 v68, 0
    v_mov_b32 v69, 0
    v_mov_b32 v70, 0
    v_mov_b32 v71, 0
    v_mov_b32 v88, 0
    v_mov_b32 v89, 0
    v_mov_b32 v90, 0
    v_mov_b32 v91, 0
    v_mov_b32 v92, 0
    v_mov_b32 v93, 0
    v_mov_b32 v94, 0
    v_mov_b32 v95, 0
va1_mpoll:
    buffer_load_dwordx4 v[16:19], v2, s[4:7], s44 offen sc1
    buffer_load_dwordx4 v[20:23], v2, s[4:7], s44 offen offset:1024 sc1
    s_waitcnt vmcnt(0)
    ds_write_b128 v3, v[16:19]
    ds_write_b128 v3, v[20:23] offset:1024
    v_max3_u32 v28, v16, v17, v18
    v_max3_u32 v29, v19, v20, v21
    v_max3_u32 v28, v28, v22, v23
    v_max_u32 v28, v28, v29
    v_cmp_eq_u32 vcc, -1, v28
    s_cbranch_vccnz va1_mpoll_retry
va1_mgo:
    s_waitcnt lgkmcnt(0)
    s_barrier

    s_cmp_ge_u32 s53, 16
    s_cbranch_scc0 va1_cdslow
va1_cdok:
    v_mov_b32 v15, s51
    ds_read_b128 v[16:19], v4
    s_waitcnt lgkmcnt(0)
    ds_read_b128 v[20:23], v4 offset:1024
    v_smfmac_f32_16x16x64_bf16 v[40:43], v[16:19], a[0:7], v1
    v_smfmac_f32_16x16x64_bf16 v[44:47], v[16:19], a[56:63], v1
    v_smfmac_f32_16x16x64_bf16 v[48:51], v[16:19], a[112:119], v1
    buffer_load_dword v14, v15, s[4:7], 0 offen sc1
    v_smfmac_f32_16x16x64_bf16 v[52:55], v[16:19], a[168:175], v1
    v_smfmac_f32_16x16x64_bf16 v[56:59], v[16:19], a[224:231], v1
    v_smfmac_f32_16x16x64_bf16 v[60:63], v[16:19], v[120:127], v1
    v_smfmac_f32_16x16x64_bf16 v[64:67], v[16:19], v[176:183], v1
    s_mov_b32 m0, s47
    s_nop 0
    buffer_load_dwordx4 v13, s[4:7], s46 offen offset:0 sc1 lds
    v_smfmac_f32_16x16x64_bf16 v[68:71], v[16:19], v[232:239], v1
    s_waitcnt lgkmcnt(0)
    ds_read_b128 v[16:19], v4 offset:2048
    v_smfmac_f32_16x16x64_bf16 v[40:43], v[20:23], a[8:15], v1
    v_smfmac_f32_16x16x64_bf16 v[44:47], v[20:23], a[64:71], v1
    v_smfmac_f32_16x16x64_bf16 v[48:51], v[20:23], a[120:127], v1
    buffer_load_dwordx4 v13, s[4:7], s46 offen offset:1024 sc1 lds
    v_smfmac_f32_16x16x64_bf16 v[52:55], v[20:23], a[176:183], v1
    v_smfmac_f32_16x16x64_bf16 v[56:59], v[20:23], a[232:239], v1
    v_smfmac_f32_16x16x64_bf16 v[60:63], v[20:23], v[128:135], v1
    v_smfmac_f32_16x16x64_bf16 v[64:67], v[20:23], v[184:191], v1
    buffer_load_dwordx4 v13, s[4:7], s46 offen offset:2048 sc1 lds
    v_smfmac_f32_16x16x64_bf16 v[68:71], v[20:23], v[240:247], v1
    s_waitcnt lgkmcnt(0)
    ds_read_b128 v[20:23], v4 offset:3072
    v_smfmac_f32_16x16x64_bf16 v[40:43], v[16:19], a[16:23], v1
    ds_read_b128 v[32:35], v5 offset:0
    ds_read_b128 v[36:39], v5 offset:1024
    v_smfmac_f32_16x16x64_bf16 v[44:47], v[16:19], a[72:79], v1
    v_smfmac_f32_16x16x64_bf16 v[48:51], v[16:19], a[128:135], v1
    buffer_load_dwordx4 v13, s[4:7], s46 offen offset:3072 sc1 lds
    v_smfmac_f32_16x16x64_bf16 v[52:55], v[16:19], a[184:191], v1
    v_smfmac_f32_16x16x64_bf16 v[56:59], v[16:19], a[240:247], v1
    v_smfmac_f32_16x16x64_bf16 v[60:63], v[16:19], v[136:143], v1
    v_smfmac_f32_16x16x64_bf16 v[64:67], v[16:19], v[192:199], v1
    s_add_u32 s24, s47, 4096
    s_mov_b32 m0, s24
    s_add_u32 s25, s46, 4096
    buffer_load_dwordx4 v13, s[4:7], s25 offen offset:0 sc1 lds
    v_smfmac_f32_16x16x64_bf16 v[68:71], v[16:19], v[248:255], v1
    s_waitcnt lgkmcnt(0)
    ds_read_b128 v[16:19], v4 offset:4096
    v_smfmac_f32_16x16x64_bf16 v[40:43], v[20:23], a[24:31], v1
    ds_read_b128 v[24:27], v5 offset:2048
    ds_read_b128 v[28:31], v5 offset:3072
    v_smfmac_f32_16x16x64_bf16 v[44:47], v[20:23], a[80:87], v1
    v_smfmac_f32_16x16x64_bf16 v[48:51], v[20:23], a[136:143], v1
    buffer_load_dwordx4 v13, s[4:7], s25 offen offset:1024 sc1 lds
    v_smfmac_f32_16x16x64_bf16 v[52:55], v[20:23], a[192:199], v1
    v_smfmac_f32_16x16x64_bf16 v[56:59], v[20:23], a[248:255], v1
    v_smfmac_f32_16x16x64_bf16 v[60:63], v[20:23], v[144:151], v1
    v_smfmac_f32_16x16x64_bf16 v[64:67], v[20:23], v[200:207], v1
    buffer_load_dwordx4 v13, s[4:7], s25 offen offset:2048 sc1 lds
    v_smfmac_f32_16x16x64_bf16 v[68:71], v[20:23], v[32:39], v1
    s_waitcnt lgkmcnt(0)
    ds_read_b128 v[20:23], v4 offset:5120
    v_smfmac_f32_16x16x64_bf16 v[40:43], v[16:19], a[32:39], v1
    ds_read_b128 v[32:35], v5 offset:4096
    ds_read_b128 v[36:39], v5 offset:5120
    v_smfmac_f32_16x16x64_bf16 v[44:47], v[16:19], a[88:95], v1
    v_smfmac_f32_16x16x64_bf16 v[48:51], v[16:19], a[144:151], v1
    buffer_load_dwordx4 v13, s[4:7], s25 offen offset:3072 sc1 lds
    v_smfmac_f32_16x16x64_bf16 v[52:55], v[16:19], a[200:207], v1
    v_smfmac_f32_16x16x64_bf16 v[56:59], v[16:19], v[96:103], v1
    v_smfmac_f32_16x16x64_bf16 v[60:63], v[16:19], v[152:159], v1
    v_smfmac_f32_16x16x64_bf16 v[64:67], v[16:19], v[208:215], v1
    v_smfmac_f32_16x16x64_bf16 v[68:71], v[16:19], v[24:31], v1
    s_waitcnt lgkmcnt(0)
    ds_read_b128 v[16:19], v4 offset:6144
    v_smfmac_f32_16x16x64_bf16 v[40:43], v[20:23], a[40:47], v1
    ds_read_b128 v[24:27], v5 offset:6144
    ds_read_b128 v[28:31], v5 offset:7168
    v_smfmac_f32_16x16x64_bf16 v[44:47], v[20:23], a[96:103], v1
    v_smfmac_f32_16x16x64_bf16 v[48:51], v[20:23], a[152:159], v1
    v_smfmac_f32_16x16x64_bf16 v[52:55], v[20:23], a[208:215], v1
    v_smfmac_f32_16x16x64_bf16 v[56:59], v[20:23], v[104:111], v1
    v_smfmac_f32_16x16x64_bf16 v[60:63], v[20:23], v[160:167], v1
    v_smfmac_f32_16x16x64_bf16 v[64:67], v[20:23], v[216:223], v1
    v_smfmac_f32_16x16x64_bf16 v[68:71], v[20:23], v[32:39], v1
    s_waitcnt lgkmcnt(0)
    v_smfmac_f32_16x16x64_bf16 v[40:43], v[16:19], a[48:55], v1
    v_smfmac_f32_16x16x64_bf16 v[44:47], v[16:19], a[104:111], v1
    v_smfmac_f32_16x16x64_bf16 v[48:51], v[16:19], a[160:167], v1
    v_smfmac_f32_16x16x64_bf16 v[52:55], v[16:19], a[216:223], v1
    v_smfmac_f32_16x16x64_bf16 v[56:59], v[16:19], v[112:119], v1
    v_smfmac_f32_16x16x64_bf16 v[60:63], v[16:19], v[168:175], v1
    v_smfmac_f32_16x16x64_bf16 v[64:67], v[16:19], v[224:231], v1
    v_smfmac_f32_16x16x64_bf16 v[68:71], v[16:19], v[24:31], v1
    v_cvt_pk_bf16_f32 v72, v40, v41
    v_cvt_pk_bf16_f32 v74, v42, v43
    v_cvt_pk_bf16_f32 v80, v44, v45
    v_cvt_pk_bf16_f32 v82, v46, v47
    v_cvt_pk_bf16_f32 v73, v48, v49
    v_cvt_pk_bf16_f32 v75, v50, v51
    v_cvt_pk_bf16_f32 v81, v52, v53
    v_cvt_pk_bf16_f32 v83, v54, v55
    v_cvt_pk_bf16_f32 v76, v56, v57
    v_cvt_pk_bf16_f32 v78, v58, v59
    v_cvt_pk_bf16_f32 v84, v60, v61
    v_cvt_pk_bf16_f32 v86, v62, v63
    v_cvt_pk_bf16_f32 v77, v64, v65
    v_cvt_pk_bf16_f32 v79, v66, v67
    v_cvt_pk_bf16_f32 v85, v68, v69
    v_cvt_pk_bf16_f32 v87, v70, v71
    ds_read_b128 v[40:43], v6 offset:0
    ds_read_b128 v[44:47], v6 offset:2048
    ds_read_b128 v[48:51], v6 offset:4096
    ds_read_b128 v[52:55], v6 offset:6144
    ds_read_b128 v[56:59], v6 offset:1024
    ds_read_b128 v[60:63], v6 offset:3072
    ds_read_b128 v[64:67], v6 offset:5120
    ds_read_b128 v[68:71], v6 offset:7168
    s_waitcnt lgkmcnt(0)
va1_ppoll0:
va1_ppoll:
    buffer_load_dwordx4 v[16:19], v7, s[4:7], s45 offen sc1
    buffer_load_dwordx4 v[20:23], v8, s[4:7], s45 offen sc1
    buffer_load_dwordx4 v[24:27], v8, s[4:7], s45 offen offset:1280 sc1
    s_waitcnt vmcnt(0)
    v_max3_u32 v9, v16, v20, v24
    v_cmp_eq_u32 vcc, -1, v9
    s_cbranch_vccnz va1_ppoll_retry
va1_pgo:
    v_smfmac_f32_16x16x64_bf16 v[88:91], v[16:19], v[72:79], v1
    v_smfmac_f32_16x16x64_bf16 v[92:95], v[16:19], v[80:87], v1
    v_max3_u32 v9, v17, v18, v19
    v_max3_u32 v0, v21, v22, v23
    v_smfmac_f32_16x16x64_bf16 v[88:91], v[20:23], v[40:47], v1
    v_max3_u32 v9, v9, v25, v26
    v_max3_u32 v9, v9, v27, v0
    v_smfmac_f32_16x16x64_bf16 v[92:95], v[20:23], v[56:63], v1
    v_cmp_eq_u32 vcc, -1, v9
    v_smfmac_f32_16x16x64_bf16 v[88:91], v[24:27], v[48:55], v1
    v_readfirstlane_b32 s53, v14
    v_smfmac_f32_16x16x64_bf16 v[92:95], v[24:27], v[64:71], v1
    s_cbranch_vccnz va1_pfail
va1_pok:
    s_nop 2
    v_permlane32_swap_b32 v88, v90
    v_permlane32_swap_b32 v89, v91
    v_pk_add_f32 v[88:89], v[88:89], v[90:91]
    s_nop 0
    v_permlane32_swap_b32 v92, v94
    v_permlane32_swap_b32 v93, v95
    v_pk_add_f32 v[92:93], v[92:93], v[94:95]
    ds_write2_b32 v10, v88, v92 offset0:0 offset1:16
    ds_write2_b32 v10, v89, v93 offset0:32 offset1:48
    s_cmp_ge_u32 s9, 2
    s_waitcnt lgkmcnt(0)
    s_barrier
    s_cbranch_scc1 va1_nofin
    ds_read2st64_b64 v[40:43], v11 offset0:0 offset1:2
    ds_read2st64_b64 v[44:47], v11 offset0:4 offset1:6
    s_waitcnt lgkmcnt(0)
    v_pk_add_f32 v[40:41], v[40:41], v[42:43]
    v_pk_add_f32 v[44:45], v[44:45], v[46:47]
    v_pk_add_f32 v[40:41], v[40:41], v[44:45]
    v_cvt_pk_bf16_f32 v40, v40, v41
    buffer_store_dword v40, v12, s[4:7], s48 offen sc1
va1_nofin:
    s_add_u32 s46, s46, 458752
    s_xor_b32 s47, s47, 32768
    v_xor_b32 v6, 32768, v6
    s_add_u32 s51, s51, 128
    s_add_u32 s8, s8, 1
    s_add_u32 s44, s44, 7168
    s_add_u32 s48, s48, 7168
    s_add_u32 s45, s45, 10240
    s_cmp_lt_u32 s8, 63
    s_cbranch_scc1 va1_loop
    s_endpgm
va1_mpoll_retry:
    s_cmp_eq_u32 s17, 0
    s_cbranch_scc1 va1_mgo
    s_sub_u32 s17, s17, 1
    s_branch va1_mpoll
va1_cdslow:
    s_sub_u32 s24, s51, 128
    v_mov_b32 v15, s24
va1_cdslow_p:
    buffer_load_dword v14, v15, s[4:7], 0 offen sc1
    s_waitcnt vmcnt(0)
    v_readfirstlane_b32 s24, v14
    s_nop 0
    s_cmp_ge_u32 s24, 16
    s_cbranch_scc1 va1_cdok
    s_cmp_eq_u32 s17, 0
    s_cbranch_scc1 va1_cdok
    s_sub_u32 s17, s17, 1
    s_branch va1_cdslow_p
va1_ppoll_retry:
    s_cmp_eq_u32 s17, 0
    s_cbranch_scc1 va1_pgo
    s_sub_u32 s17, s17, 1
    s_branch va1_ppoll
va1_pfail:
    s_cmp_eq_u32 s17, 0
    s_cbranch_scc1 va1_pfail_go
    s_sub_u32 s17, s17, 1
    s_waitcnt vmcnt(0)
    s_nop 7
    v_mov_b32 v88, 0
    v_mov_b32 v89, 0
    v_mov_b32 v90, 0
    v_mov_b32 v91, 0
    v_mov_b32 v92, 0
    v_mov_b32 v93, 0
    v_mov_b32 v94, 0
    v_mov_b32 v95, 0
    s_branch va1_ppoll0
va1_pfail_go:
    s_nop 7
    s_branch va1_pok
hp_start:
    s_mov_b32 s24, 224
    v_mbcnt_lo_u32_b32 v22, -1, 0
    v_mbcnt_hi_u32_b32 v22, -1, v22
    v_cmp_gt_u32 vcc, 32, v22
    v_add_u32 v22, s24, v22
    v_lshlrev_b32 v22, 7, v22
    v_add_u32 v22, 57753600, v22
    v_mov_b32 v20, 0x7fff0000
    v_cndmask_b32 v22, v20, v22, vcc
wm9:
    buffer_load_dword v20, v22, s[4:7], 0 offen sc1
    s_waitcnt vmcnt(0)
    v_cmp_eq_u32 s[80:81], s18, v20
    s_cmp_eq_u32 s80, -1
    s_cbranch_scc1 wm9_ok
    s_cmp_eq_u32 s17, 0
    s_cbranch_scc1 wm9_ok
    s_sub_u32 s17, s17, 1
    s_sleep 8
    s_branch wm9
wm9_ok:
    v_lshlrev_b32 v3, 4, v0
    v_lshlrev_b32 v4, 7, v0
    s_mov_b32 s8, 0
    s_mov_b32 s44, 16777216
    s_cmp_lg_u32 s11, 0
    s_cbranch_scc1 hp_h1
    s_lshl_b32 s24, s9, 1
    s_min_u32 s24, s24, 5
    s_lshl_b32 s25, s24, 10
    v_add_u32 v2, s25, v3
    s_mov_b32 s45, 17244160
hp_poll:
    buffer_load_dwordx4 v[8:11], v2, s[4:7], s44 offen sc1
    buffer_load_dwordx4 v[12:15], v2, s[4:7], s44 offen offset:1024 sc1
    s_waitcnt vmcnt(0)
    v_max3_u32 v16, v8, v9, v10
    v_max3_u32 v17, v11, v12, v13
    v_max3_u32 v16, v16, v14, v15
    v_max_u32 v16, v16, v17
    v_cmp_eq_u32 vcc, -1, v16
    s_cbranch_vccnz hp_retry
hp_go:
    buffer_store_dwordx4 v[8:11], v2, s[4:7], s45 offen sc1
    buffer_store_dwordx4 v[12:15], v2, s[4:7], s45 offen offset:1024 sc1
    s_add_u32 s8, s8, 1
    s_add_u32 s44, s44, 7168
    s_add_u32 s45, s45, 7168
    s_cmp_lt_u32 s8, 64
    s_cbranch_scc1 hp_poll
    s_waitcnt vmcnt(0)
    s_endpgm
hp_retry:
    s_cmp_eq_u32 s17, 0
    s_cbranch_scc1 hp_go
    s_sub_u32 s17, s17, 1
    s_sleep 1
    s_branch hp_poll
hp_h1:
    s_cmp_eq_u32 s9, 3
    s_cbranch_scc1 hp_xs
    s_mov_b32 s46, 17731584
    s_mov_b32 s47, 10240
    s_mov_b32 s25, 64
    s_cmp_eq_u32 s9, 1
    s_cselect_b32 s24, 8192, 0
    s_cselect_b32 s25, 16, s25
    s_add_u32 s46, s46, s24
    s_cmp_eq_u32 s9, 2
    s_cselect_b32 s46, 16798720, s46
    s_cselect_b32 s47, 7168, s47
    s_cselect_b32 s25, 56, s25
    v_mov_b32 v16, 0x7fff0000
    v_cmp_gt_u32 vcc, s25, v0
    s_nop 1
    v_cndmask_b32 v19, v16, v4, vcc
    v_mov_b32 v2, 7152
hp_poll1:
    buffer_load_dword v16, v2, s[4:7], s44 offen sc1
    s_waitcnt vmcnt(0)
    v_cmp_eq_u32 vcc, -1, v16
    s_cbranch_vccnz hp_retry1
hp_go1:
    buffer_load_dword v18, v19, s[4:7], s46 offen sc1
    s_add_u32 s46, s46, s47
    s_add_u32 s8, s8, 1
    s_add_u32 s44, s44, 7168
    s_cmp_lt_u32 s8, 61
    s_cbranch_scc1 hp_poll1
hp_end:
    s_endpgm
hp_xs:
    s_mov_b32 s46, 1900544
    v_mov_b32 v2, 7152
hp_poll2:
    buffer_load_dword v16, v2, s[4:7], s44 offen sc1
    s_waitcnt vmcnt(0)
    v_cmp_eq_u32 vcc, -1, v16
    s_cbranch_vccnz hp_retry2
hp_go2:
    buffer_load_dword v18, v4, s[4:7], s46 offen
    s_add_u32 s24, s46, 8192
    buffer_load_dword v18, v4, s[4:7], s24 offen
    s_add_u32 s24, s24, 8192
    buffer_load_dword v18, v4, s[4:7], s24 offen
    s_add_u32 s24, s24, 8192
    buffer_load_dword v18, v4, s[4:7], s24 offen
    s_add_u32 s46, s46, 32768
    s_add_u32 s8, s8, 1
    s_add_u32 s44, s44, 7168
    s_cmp_lt_u32 s8, 61
    s_cbranch_scc1 hp_poll2
    s_endpgm
hp_retry2:
    s_cmp_eq_u32 s17, 0
    s_cbranch_scc1 hp_go2
    s_sub_u32 s17, s17, 1
    s_sleep 2
    s_branch hp_poll2
hp_retry1:
    s_cmp_eq_u32 s17, 0
    s_cbranch_scc1 hp_go1
    s_sub_u32 s17, s17, 1
    s_sleep 2
    s_branch hp_poll1
dp_start:
    s_and_b32 s44, s11, 7
    s_lshr_b32 s24, s11, 5
    s_lshl_b32 s24, s24, 3
    s_add_u32 s44, s44, s24
    s_bfe_u32 s45, s11, 0x20003
    v_lshlrev_b32 v1, 4, v0
    v_mov_b32 v2, 1
    s_mul_i32 s54, s9, 7168
    v_lshrrev_b32 v8, 4, v0
    v_and_b32 v9, 15, v0
    v_bfe_u32 v10, v9, 3, 1
    v_lshlrev_b32 v10, 4, v10
    v_bfe_u32 v11, v9, 1, 1
    v_lshlrev_b32 v11, 3, v11
    v_bfe_u32 v12, v9, 2, 1
    v_lshlrev_b32 v12, 2, v12
    v_and_b32 v13, 1, v9
    v_add3_u32 v10, v10, v11, v12
    v_add_u32 v10, v10, v13
    v_lshlrev_b32 v10, 4, v10
    v_lshlrev_b32 v11, 9, v8
    v_add_u32 v4, v10, v11
    v_bfe_u32 v10, v0, 3, 1
    v_mul_u32_u24 v5, 0xaaaa, v10
    v_add_u32 v5, 0x4444, v5
    v_lshrrev_b32 v10, 5, v0
    v_lshlrev_b32 v10, 8, v10
    v_lshlrev_b32 v11, 4, v9
    v_and_b32 v12, 1, v8
    v_lshlrev_b32 v12, 3, v12
    v_add3_u32 v6, v10, v11, v12
    v_mov_b32 v10, 0x7fff0000
    v_cmp_gt_u32 vcc, 32, v0
    s_nop 1
    v_cndmask_b32 v7, v10, v6, vcc

    s_mul_i32 s24, s9, 7
    s_add_u32 s24, s24, 0
    s_lshr_b32 s25, s24, 1
    s_and_b32 s24, s24, 1
    s_lshl_b32 s25, s25, 4
    s_add_u32 s25, s25, s44
    s_lshl_b32 s25, s25, 1
    s_add_u32 s25, s25, s24
    s_mul_i32 s60, s25, 1024
    s_mul_i32 s25, s25, 14336
    s_add_u32 s70, s25, 10354688
    s_mul_i32 s24, s9, 7
    s_add_u32 s24, s24, 1
    s_lshr_b32 s25, s24, 1
    s_and_b32 s24, s24, 1
    s_lshl_b32 s25, s25, 4
    s_add_u32 s25, s25, s44
    s_lshl_b32 s25, s25, 1
    s_add_u32 s25, s25, s24
    s_mul_i32 s61, s25, 1024
    s_mul_i32 s25, s25, 14336
    s_add_u32 s71, s25, 10354688
    s_mul_i32 s24, s9, 7
    s_add_u32 s24, s24, 2
    s_lshr_b32 s25, s24, 1
    s_and_b32 s24, s24, 1
    s_lshl_b32 s25, s25, 4
    s_add_u32 s25, s25, s44
    s_lshl_b32 s25, s25, 1
    s_add_u32 s25, s25, s24
    s_mul_i32 s62, s25, 1024
    s_mul_i32 s25, s25, 14336
    s_add_u32 s72, s25, 10354688
    s_mul_i32 s24, s9, 7
    s_add_u32 s24, s24, 3
    s_lshr_b32 s25, s24, 1
    s_and_b32 s24, s24, 1
    s_lshl_b32 s25, s25, 4
    s_add_u32 s25, s25, s44
    s_lshl_b32 s25, s25, 1
    s_add_u32 s25, s25, s24
    s_mul_i32 s63, s25, 1024
    s_mul_i32 s25, s25, 14336
    s_add_u32 s73, s25, 10354688
    s_mul_i32 s24, s9, 7
    s_add_u32 s24, s24, 4
    s_lshr_b32 s25, s24, 1
    s_and_b32 s24, s24, 1
    s_lshl_b32 s25, s25, 4
    s_add_u32 s25, s25, s44
    s_lshl_b32 s25, s25, 1
    s_add_u32 s25, s25, s24
    s_mul_i32 s64, s25, 1024
    s_mul_i32 s25, s25, 14336
    s_add_u32 s74, s25, 10354688
    s_mul_i32 s24, s9, 7
    s_add_u32 s24, s24, 5
    s_lshr_b32 s25, s24, 1
    s_and_b32 s24, s24, 1
    s_lshl_b32 s25, s25, 4
    s_add_u32 s25, s25, s44
    s_lshl_b32 s25, s25, 1
    s_add_u32 s25, s25, s24
    s_mul_i32 s65, s25, 1024
    s_mul_i32 s25, s25, 14336
    s_add_u32 s75, s25, 10354688
    s_mul_i32 s24, s9, 7
    s_add_u32 s24, s24, 6
    s_lshr_b32 s25, s24, 1
    s_and_b32 s24, s24, 1
    s_lshl_b32 s25, s25, 4
    s_add_u32 s25, s25, s44
    s_lshl_b32 s25, s25, 1
    s_add_u32 s25, s25, s24
    s_mul_i32 s66, s25, 1024
    s_mul_i32 s25, s25, 14336
    s_add_u32 s76, s25, 10354688
    s_mul_i32 s24, s44, 14
    s_add_u32 s24, s24, 7
    v_mbcnt_lo_u32_b32 v82, -1, 0
    v_mbcnt_hi_u32_b32 v82, -1, v82
    v_cmp_gt_u32 vcc, 7, v82
    v_add_u32 v82, s24, v82
    v_lshlrev_b32 v82, 7, v82
    v_add_u32 v82, 57753600, v82
    v_mov_b32 v80, 0x7fff0000
    v_cndmask_b32 v82, v80, v82, vcc
    s_mov_b32 s89, 0
sl10:
    buffer_load_dword v80, v82, s[4:7], 0 offen sc1
    s_waitcnt vmcnt(0)
    v_cmp_eq_u32 s[80:81], s18, v80
    s_bitcmp1_b32 s89, 0
    s_cbranch_scc1 sl10_0
    s_bitcmp1_b32 s80, 0
    s_cbranch_scc0 sl10_0
    s_add_u32 s25, s70, 0
    buffer_load_dwordx4 a[0:3], v1, s[4:7], s25 offen sc1
    buffer_load_dwordx4 a[4:7], v1, s[4:7], s25 offen offset:1024 sc1
    s_add_u32 s25, s71, 0
    buffer_load_dwordx4 a[56:59], v1, s[4:7], s25 offen sc1
    buffer_load_dwordx4 a[60:63], v1, s[4:7], s25 offen offset:1024 sc1
    s_add_u32 s25, s72, 0
    buffer_load_dwordx4 a[112:115], v1, s[4:7], s25 offen sc1
    buffer_load_dwordx4 a[116:119], v1, s[4:7], s25 offen offset:1024 sc1
    s_add_u32 s25, s73, 0
    buffer_load_dwordx4 a[168:171], v1, s[4:7], s25 offen sc1
    buffer_load_dwordx4 a[172:175], v1, s[4:7], s25 offen offset:1024 sc1
    s_add_u32 s25, s74, 0
    buffer_load_dwordx4 a[224:227], v1, s[4:7], s25 offen sc1
    buffer_load_dwordx4 a[228:231], v1, s[4:7], s25 offen offset:1024 sc1
    s_add_u32 s25, s75, 0
    buffer_load_dwordx4 v[144:147], v1, s[4:7], s25 offen sc1
    buffer_load_dwordx4 v[148:151], v1, s[4:7], s25 offen offset:1024 sc1
    s_add_u32 s25, s76, 0
    buffer_load_dwordx4 v[200:203], v1, s[4:7], s25 offen sc1
    buffer_load_dwordx4 v[204:207], v1, s[4:7], s25 offen offset:1024 sc1
    s_bitset1_b32 s89, 0
sl10_0:
    s_bitcmp1_b32 s89, 1
    s_cbranch_scc1 sl10_1
    s_bitcmp1_b32 s80, 1
    s_cbranch_scc0 sl10_1
    s_add_u32 s25, s70, 2048
    buffer_load_dwordx4 a[8:11], v1, s[4:7], s25 offen sc1
    buffer_load_dwordx4 a[12:15], v1, s[4:7], s25 offen offset:1024 sc1
    s_add_u32 s25, s71, 2048
    buffer_load_dwordx4 a[64:67], v1, s[4:7], s25 offen sc1
    buffer_load_dwordx4 a[68:71], v1, s[4:7], s25 offen offset:1024 sc1
    s_add_u32 s25, s72, 2048
    buffer_load_dwordx4 a[120:123], v1, s[4:7], s25 offen sc1
    buffer_load_dwordx4 a[124:127], v1, s[4:7], s25 offen offset:1024 sc1
    s_add_u32 s25, s73, 2048
    buffer_load_dwordx4 a[176:179], v1, s[4:7], s25 offen sc1
    buffer_load_dwordx4 a[180:183], v1, s[4:7], s25 offen offset:1024 sc1
    s_add_u32 s25, s74, 2048
    buffer_load_dwordx4 a[232:235], v1, s[4:7], s25 offen sc1
    buffer_load_dwordx4 a[236:239], v1, s[4:7], s25 offen offset:1024 sc1
    s_add_u32 s25, s75, 2048
    buffer_load_dwordx4 v[152:155], v1, s[4:7], s25 offen sc1
    buffer_load_dwordx4 v[156:159], v1, s[4:7], s25 offen offset:1024 sc1
    s_add_u32 s25, s76, 2048
    buffer_load_dwordx4 v[208:211], v1, s[4:7], s25 offen sc1
    buffer_load_dwordx4 v[212:215], v1, s[4:7], s25 offen offset:1024 sc1
    s_bitset1_b32 s89, 1
sl10_1:
    s_bitcmp1_b32 s89, 2
    s_cbranch_scc1 sl10_2
    s_bitcmp1_b32 s80, 2
    s_cbranch_scc0 sl10_2
    s_add_u32 s25, s70, 4096
    buffer_load_dwordx4 a[16:19], v1, s[4:7], s25 offen sc1
    buffer_load_dwordx4 a[20:23], v1, s[4:7], s25 offen offset:1024 sc1
    s_add_u32 s25, s71, 4096
    buffer_load_dwordx4 a[72:75], v1, s[4:7], s25 offen sc1
    buffer_load_dwordx4 a[76:79], v1, s[4:7], s25 offen offset:1024 sc1
    s_add_u32 s25, s72, 4096
    buffer_load_dwordx4 a[128:131], v1, s[4:7], s25 offen sc1
    buffer_load_dwordx4 a[132:135], v1, s[4:7], s25 offen offset:1024 sc1
    s_add_u32 s25, s73, 4096
    buffer_load_dwordx4 a[184:187], v1, s[4:7], s25 offen sc1
    buffer_load_dwordx4 a[188:191], v1, s[4:7], s25 offen offset:1024 sc1
    s_add_u32 s25, s74, 4096
    buffer_load_dwordx4 a[240:243], v1, s[4:7], s25 offen sc1
    buffer_load_dwordx4 a[244:247], v1, s[4:7], s25 offen offset:1024 sc1
    s_add_u32 s25, s75, 4096
    buffer_load_dwordx4 v[160:163], v1, s[4:7], s25 offen sc1
    buffer_load_dwordx4 v[164:167], v1, s[4:7], s25 offen offset:1024 sc1
    s_add_u32 s25, s76, 4096
    buffer_load_dwordx4 v[216:219], v1, s[4:7], s25 offen sc1
    buffer_load_dwordx4 v[220:223], v1, s[4:7], s25 offen offset:1024 sc1
    s_bitset1_b32 s89, 2
sl10_2:
    s_bitcmp1_b32 s89, 3
    s_cbranch_scc1 sl10_3
    s_bitcmp1_b32 s80, 3
    s_cbranch_scc0 sl10_3
    s_add_u32 s25, s70, 6144
    buffer_load_dwordx4 a[24:27], v1, s[4:7], s25 offen sc1
    buffer_load_dwordx4 a[28:31], v1, s[4:7], s25 offen offset:1024 sc1
    s_add_u32 s25, s71, 6144
    buffer_load_dwordx4 a[80:83], v1, s[4:7], s25 offen sc1
    buffer_load_dwordx4 a[84:87], v1, s[4:7], s25 offen offset:1024 sc1
    s_add_u32 s25, s72, 6144
    buffer_load_dwordx4 a[136:139], v1, s[4:7], s25 offen sc1
    buffer_load_dwordx4 a[140:143], v1, s[4:7], s25 offen offset:1024 sc1
    s_add_u32 s25, s73, 6144
    buffer_load_dwordx4 a[192:195], v1, s[4:7], s25 offen sc1
    buffer_load_dwordx4 a[196:199], v1, s[4:7], s25 offen offset:1024 sc1
    s_add_u32 s25, s74, 6144
    buffer_load_dwordx4 a[248:251], v1, s[4:7], s25 offen sc1
    buffer_load_dwordx4 a[252:255], v1, s[4:7], s25 offen offset:1024 sc1
    s_add_u32 s25, s75, 6144
    buffer_load_dwordx4 v[168:171], v1, s[4:7], s25 offen sc1
    buffer_load_dwordx4 v[172:175], v1, s[4:7], s25 offen offset:1024 sc1
    s_add_u32 s25, s76, 6144
    buffer_load_dwordx4 v[224:227], v1, s[4:7], s25 offen sc1
    buffer_load_dwordx4 v[228:231], v1, s[4:7], s25 offen offset:1024 sc1
    s_bitset1_b32 s89, 3
sl10_3:
    s_bitcmp1_b32 s89, 4
    s_cbranch_scc1 sl10_4
    s_bitcmp1_b32 s80, 4
    s_cbranch_scc0 sl10_4
    s_add_u32 s25, s70, 8192
    buffer_load_dwordx4 a[32:35], v1, s[4:7], s25 offen sc1
    buffer_load_dwordx4 a[36:39], v1, s[4:7], s25 offen offset:1024 sc1
    s_add_u32 s25, s71, 8192
    buffer_load_dwordx4 a[88:91], v1, s[4:7], s25 offen sc1
    buffer_load_dwordx4 a[92:95], v1, s[4:7], s25 offen offset:1024 sc1
    s_add_u32 s25, s72, 8192
    buffer_load_dwordx4 a[144:147], v1, s[4:7], s25 offen sc1
    buffer_load_dwordx4 a[148:151], v1, s[4:7], s25 offen offset:1024 sc1
    s_add_u32 s25, s73, 8192
    buffer_load_dwordx4 a[200:203], v1, s[4:7], s25 offen sc1
    buffer_load_dwordx4 a[204:207], v1, s[4:7], s25 offen offset:1024 sc1
    s_add_u32 s25, s74, 8192
    buffer_load_dwordx4 v[120:123], v1, s[4:7], s25 offen sc1
    buffer_load_dwordx4 v[124:127], v1, s[4:7], s25 offen offset:1024 sc1
    s_add_u32 s25, s75, 8192
    buffer_load_dwordx4 v[176:179], v1, s[4:7], s25 offen sc1
    buffer_load_dwordx4 v[180:183], v1, s[4:7], s25 offen offset:1024 sc1
    s_add_u32 s25, s76, 8192
    buffer_load_dwordx4 v[232:235], v1, s[4:7], s25 offen sc1
    buffer_load_dwordx4 v[236:239], v1, s[4:7], s25 offen offset:1024 sc1
    s_bitset1_b32 s89, 4
sl10_4:
    s_bitcmp1_b32 s89, 5
    s_cbranch_scc1 sl10_5
    s_bitcmp1_b32 s80, 5
    s_cbranch_scc0 sl10_5
    s_add_u32 s25, s70, 10240
    buffer_load_dwordx4 a[40:43], v1, s[4:7], s25 offen sc1
    buffer_load_dwordx4 a[44:47], v1, s[4:7], s25 offen offset:1024 sc1
    s_add_u32 s25, s71, 10240
    buffer_load_dwordx4 a[96:99], v1, s[4:7], s25 offen sc1
    buffer_load_dwordx4 a[100:103], v1, s[4:7], s25 offen offset:1024 sc1
    s_add_u32 s25, s72, 10240
    buffer_load_dwordx4 a[152:155], v1, s[4:7], s25 offen sc1
    buffer_load_dwordx4 a[156:159], v1, s[4:7], s25 offen offset:1024 sc1
    s_add_u32 s25, s73, 10240
    buffer_load_dwordx4 a[208:211], v1, s[4:7], s25 offen sc1
    buffer_load_dwordx4 a[212:215], v1, s[4:7], s25 offen offset:1024 sc1
    s_add_u32 s25, s74, 10240
    buffer_load_dwordx4 v[128:131], v1, s[4:7], s25 offen sc1
    buffer_load_dwordx4 v[132:135], v1, s[4:7], s25 offen offset:1024 sc1
    s_add_u32 s25, s75, 10240
    buffer_load_dwordx4 v[184:187], v1, s[4:7], s25 offen sc1
    buffer_load_dwordx4 v[188:191], v1, s[4:7], s25 offen offset:1024 sc1
    s_add_u32 s25, s76, 10240
    buffer_load_dwordx4 v[240:243], v1, s[4:7], s25 offen sc1
    buffer_load_dwordx4 v[244:247], v1, s[4:7], s25 offen offset:1024 sc1
    s_bitset1_b32 s89, 5
sl10_5:
    s_bitcmp1_b32 s89, 6
    s_cbranch_scc1 sl10_6
    s_bitcmp1_b32 s80, 6
    s_cbranch_scc0 sl10_6
    s_add_u32 s25, s70, 12288
    buffer_load_dwordx4 a[48:51], v1, s[4:7], s25 offen sc1
    buffer_load_dwordx4 a[52:55], v1, s[4:7], s25 offen offset:1024 sc1
    s_add_u32 s25, s71, 12288
    buffer_load_dwordx4 a[104:107], v1, s[4:7], s25 offen sc1
    buffer_load_dwordx4 a[108:111], v1, s[4:7], s25 offen offset:1024 sc1
    s_add_u32 s25, s72, 12288
    buffer_load_dwordx4 a[160:163], v1, s[4:7], s25 offen sc1
    buffer_load_dwordx4 a[164:167], v1, s[4:7], s25 offen offset:1024 sc1
    s_add_u32 s25, s73, 12288
    buffer_load_dwordx4 a[216:219], v1, s[4:7], s25 offen sc1
    buffer_load_dwordx4 a[220:223], v1, s[4:7], s25 offen offset:1024 sc1
    s_add_u32 s25, s74, 12288
    buffer_load_dwordx4 v[136:139], v1, s[4:7], s25 offen sc1
    buffer_load_dwordx4 v[140:143], v1, s[4:7], s25 offen offset:1024 sc1
    s_add_u32 s25, s75, 12288
    buffer_load_dwordx4 v[192:195], v1, s[4:7], s25 offen sc1
    buffer_load_dwordx4 v[196:199], v1, s[4:7], s25 offen offset:1024 sc1
    s_add_u32 s25, s76, 12288
    buffer_load_dwordx4 v[248:251], v1, s[4:7], s25 offen sc1
    buffer_load_dwordx4 v[252:255], v1, s[4:7], s25 offen offset:1024 sc1
    s_bitset1_b32 s89, 6
sl10_6:
    s_cmp_eq_u32 s89, 127
    s_cbranch_scc1 sl10_ok
    s_cmp_eq_u32 s17, 0
    s_cbranch_scc1 sl10_ok
    s_sub_u32 s17, s17, 1
    s_sleep 8
    s_branch sl10
sl10_ok:
    s_mov_b32 s24, 224
    v_mbcnt_lo_u32_b32 v82, -1, 0
    v_mbcnt_hi_u32_b32 v82, -1, v82
    v_cmp_gt_u32 vcc, 32, v82
    v_add_u32 v82, s24, v82
    v_lshlrev_b32 v82, 7, v82
    v_add_u32 v82, 57753600, v82
    v_mov_b32 v80, 0x7fff0000
    v_cndmask_b32 v82, v80, v82, vcc
wm11:
    buffer_load_dword v80, v82, s[4:7], 0 offen sc1
    s_waitcnt vmcnt(0)
    v_cmp_eq_u32 s[80:81], s18, v80
    s_cmp_eq_u32 s80, -1
    s_cbranch_scc1 wm11_ok
    s_cmp_eq_u32 s17, 0
    s_cbranch_scc1 wm11_ok
    s_sub_u32 s17, s17, 1
    s_sleep 8
    s_branch wm11
wm11_ok:
    s_mov_b32 s46, s45
    s_mul_i32 s47, s46, 28672
    s_add_u32 s47, s47, 0
    s_mov_b32 s48, 0
    s_add_u32 s24, s48, s54
    s_mov_b32 m0, s24
    s_add_u32 s25, s47, s54
    buffer_load_dwordx4 v1, s[4:7], s25 offen offset:0 sc1 lds
    buffer_load_dwordx4 v1, s[4:7], s25 offen offset:1024 sc1 lds
    buffer_load_dwordx4 v1, s[4:7], s25 offen offset:2048 sc1 lds
    buffer_load_dwordx4 v1, s[4:7], s25 offen offset:3072 sc1 lds
    s_add_u32 s24, s24, 4096
    s_mov_b32 m0, s24
    s_add_u32 s25, s25, 4096
    buffer_load_dwordx4 v1, s[4:7], s25 offen offset:0 sc1 lds
    buffer_load_dwordx4 v1, s[4:7], s25 offen offset:1024 sc1 lds
    buffer_load_dwordx4 v1, s[4:7], s25 offen offset:2048 sc1 lds
    s_mov_b32 s49, 0
dp_loop:
    s_waitcnt vmcnt(0)
    s_barrier
    s_cmp_eq_u32 s49, 0
    s_cbranch_scc1 dp_first
    s_cmp_lg_u32 s9, 0
    s_cbranch_scc1 dp_nosiga
    s_lshl_b32 s24, s53, 7
    s_add_u32 s24, s24, 57688064
    v_mov_b32 v3, s24
    s_mov_b64 exec, 1
    buffer_atomic_add v2, v3, s[4:7], 0 offen
    s_mov_b64 exec, -1
dp_nosiga:
dp_first:
    s_cmp_eq_u32 s49, 15
    s_cbranch_scc1 dp_nodma
    s_add_u32 s47, s47, 114688
    s_xor_b32 s48, s48, 32768
    s_add_u32 s24, s48, s54
    s_mov_b32 m0, s24
    s_add_u32 s25, s47, s54
    buffer_load_dwordx4 v1, s[4:7], s25 offen offset:0 sc1 lds
    buffer_load_dwordx4 v1, s[4:7], s25 offen offset:1024 sc1 lds
    buffer_load_dwordx4 v1, s[4:7], s25 offen offset:2048 sc1 lds
    buffer_load_dwordx4 v1, s[4:7], s25 offen offset:3072 sc1 lds
    s_add_u32 s24, s24, 4096
    s_mov_b32 m0, s24
    s_add_u32 s25, s25, 4096
    buffer_load_dwordx4 v1, s[4:7], s25 offen offset:0 sc1 lds
    buffer_load_dwordx4 v1, s[4:7], s25 offen offset:1024 sc1 lds
    buffer_load_dwordx4 v1, s[4:7], s25 offen offset:2048 sc1 lds
dp_nodma:
    ds_read_b128 v[64:67], v4 offset:0
    ds_read_b128 v[68:71], v4 offset:32
    s_waitcnt lgkmcnt(0)
    ds_read_b128 v[72:75], v4 offset:2048
    ds_read_b128 v[76:79], v4 offset:2080
    v_mfma_f32_16x16x32_bf16 v[8:11], v[64:67], a[0:3], 0
    v_mfma_f32_16x16x32_bf16 v[12:15], v[68:71], a[0:3], 0
    v_mfma_f32_16x16x32_bf16 v[16:19], v[64:67], a[56:59], 0
    v_mfma_f32_16x16x32_bf16 v[20:23], v[68:71], a[56:59], 0
    v_mfma_f32_16x16x32_bf16 v[24:27], v[64:67], a[112:115], 0
    v_mfma_f32_16x16x32_bf16 v[28:31], v[68:71], a[112:115], 0
    v_mfma_f32_16x16x32_bf16 v[32:35], v[64:67], a[168:171], 0
    v_mfma_f32_16x16x32_bf16 v[36:39], v[68:71], a[168:171], 0
    v_mfma_f32_16x16x32_bf16 v[40:43], v[64:67], a[224:227], 0
    v_mfma_f32_16x16x32_bf16 v[44:47], v[68:71], a[224:227], 0
    v_mfma_f32_16x16x32_bf16 v[48:51], v[64:67], v[144:147], 0
    v_mfma_f32_16x16x32_bf16 v[52:55], v[68:71], v[144:147], 0
    v_mfma_f32_16x16x32_bf16 v[56:59], v[64:67], v[200:203], 0
    v_mfma_f32_16x16x32_bf16 v[60:63], v[68:71], v[200:203], 0
    s_waitcnt lgkmcnt(0)
    ds_read_b128 v[64:67], v4 offset:4096
    ds_read_b128 v[68:71], v4 offset:4128
    v_mfma_f32_16x16x32_bf16 v[8:11], v[72:75], a[4:7], v[8:11]
    v_mfma_f32_16x16x32_bf16 v[12:15], v[76:79], a[4:7], v[12:15]
    v_mfma_f32_16x16x32_bf16 v[16:19], v[72:75], a[60:63], v[16:19]
    v_mfma_f32_16x16x32_bf16 v[20:23], v[76:79], a[60:63], v[20:23]
    v_mfma_f32_16x16x32_bf16 v[24:27], v[72:75], a[116:119], v[24:27]
    v_mfma_f32_16x16x32_bf16 v[28:31], v[76:79], a[116:119], v[28:31]
    v_mfma_f32_16x16x32_bf16 v[32:35], v[72:75], a[172:175], v[32:35]
    v_mfma_f32_16x16x32_bf16 v[36:39], v[76:79], a[172:175], v[36:39]
    v_mfma_f32_16x16x32_bf16 v[40:43], v[72:75], a[228:231], v[40:43]
    v_mfma_f32_16x16x32_bf16 v[44:47], v[76:79], a[228:231], v[44:47]
    v_mfma_f32_16x16x32_bf16 v[48:51], v[72:75], v[148:151], v[48:51]
    v_mfma_f32_16x16x32_bf16 v[52:55], v[76:79], v[148:151], v[52:55]
    v_mfma_f32_16x16x32_bf16 v[56:59], v[72:75], v[204:207], v[56:59]
    v_mfma_f32_16x16x32_bf16 v[60:63], v[76:79], v[204:207], v[60:63]
    s_waitcnt lgkmcnt(0)
    ds_read_b128 v[72:75], v4 offset:6144
    ds_read_b128 v[76:79], v4 offset:6176
    v_mfma_f32_16x16x32_bf16 v[8:11], v[64:67], a[8:11], v[8:11]
    v_mfma_f32_16x16x32_bf16 v[12:15], v[68:71], a[8:11], v[12:15]
    v_mfma_f32_16x16x32_bf16 v[16:19], v[64:67], a[64:67], v[16:19]
    v_mfma_f32_16x16x32_bf16 v[20:23], v[68:71], a[64:67], v[20:23]
    v_mfma_f32_16x16x32_bf16 v[24:27], v[64:67], a[120:123], v[24:27]
    v_mfma_f32_16x16x32_bf16 v[28:31], v[68:71], a[120:123], v[28:31]
    v_mfma_f32_16x16x32_bf16 v[32:35], v[64:67], a[176:179], v[32:35]
    v_mfma_f32_16x16x32_bf16 v[36:39], v[68:71], a[176:179], v[36:39]
    v_mfma_f32_16x16x32_bf16 v[40:43], v[64:67], a[232:235], v[40:43]
    v_mfma_f32_16x16x32_bf16 v[44:47], v[68:71], a[232:235], v[44:47]
    v_mfma_f32_16x16x32_bf16 v[48:51], v[64:67], v[152:155], v[48:51]
    v_mfma_f32_16x16x32_bf16 v[52:55], v[68:71], v[152:155], v[52:55]
    v_mfma_f32_16x16x32_bf16 v[56:59], v[64:67], v[208:211], v[56:59]
    v_mfma_f32_16x16x32_bf16 v[60:63], v[68:71], v[208:211], v[60:63]
    s_waitcnt lgkmcnt(0)
    ds_read_b128 v[64:67], v4 offset:8192
    ds_read_b128 v[68:71], v4 offset:8224
    v_mfma_f32_16x16x32_bf16 v[8:11], v[72:75], a[12:15], v[8:11]
    v_mfma_f32_16x16x32_bf16 v[12:15], v[76:79], a[12:15], v[12:15]
    v_mfma_f32_16x16x32_bf16 v[16:19], v[72:75], a[68:71], v[16:19]
    v_mfma_f32_16x16x32_bf16 v[20:23], v[76:79], a[68:71], v[20:23]
    v_mfma_f32_16x16x32_bf16 v[24:27], v[72:75], a[124:127], v[24:27]
    v_mfma_f32_16x16x32_bf16 v[28:31], v[76:79], a[124:127], v[28:31]
    v_mfma_f32_16x16x32_bf16 v[32:35], v[72:75], a[180:183], v[32:35]
    v_mfma_f32_16x16x32_bf16 v[36:39], v[76:79], a[180:183], v[36:39]
    v_mfma_f32_16x16x32_bf16 v[40:43], v[72:75], a[236:239], v[40:43]
    v_mfma_f32_16x16x32_bf16 v[44:47], v[76:79], a[236:239], v[44:47]
    v_mfma_f32_16x16x32_bf16 v[48:51], v[72:75], v[156:159], v[48:51]
    v_mfma_f32_16x16x32_bf16 v[52:55], v[76:79], v[156:159], v[52:55]
    v_mfma_f32_16x16x32_bf16 v[56:59], v[72:75], v[212:215], v[56:59]
    v_mfma_f32_16x16x32_bf16 v[60:63], v[76:79], v[212:215], v[60:63]
    s_waitcnt lgkmcnt(0)
    ds_read_b128 v[72:75], v4 offset:10240
    ds_read_b128 v[76:79], v4 offset:10272
    v_mfma_f32_16x16x32_bf16 v[8:11], v[64:67], a[16:19], v[8:11]
    v_mfma_f32_16x16x32_bf16 v[12:15], v[68:71], a[16:19], v[12:15]
    v_mfma_f32_16x16x32_bf16 v[16:19], v[64:67], a[72:75], v[16:19]
    v_mfma_f32_16x16x32_bf16 v[20:23], v[68:71], a[72:75], v[20:23]
    v_mfma_f32_16x16x32_bf16 v[24:27], v[64:67], a[128:131], v[24:27]
    v_mfma_f32_16x16x32_bf16 v[28:31], v[68:71], a[128:131], v[28:31]
    v_mfma_f32_16x16x32_bf16 v[32:35], v[64:67], a[184:187], v[32:35]
    v_mfma_f32_16x16x32_bf16 v[36:39], v[68:71], a[184:187], v[36:39]
    v_mfma_f32_16x16x32_bf16 v[40:43], v[64:67], a[240:243], v[40:43]
    v_mfma_f32_16x16x32_bf16 v[44:47], v[68:71], a[240:243], v[44:47]
    v_mfma_f32_16x16x32_bf16 v[48:51], v[64:67], v[160:163], v[48:51]
    v_mfma_f32_16x16x32_bf16 v[52:55], v[68:71], v[160:163], v[52:55]
    v_mfma_f32_16x16x32_bf16 v[56:59], v[64:67], v[216:219], v[56:59]
    v_mfma_f32_16x16x32_bf16 v[60:63], v[68:71], v[216:219], v[60:63]
    s_waitcnt lgkmcnt(0)
    ds_read_b128 v[64:67], v4 offset:12288
    ds_read_b128 v[68:71], v4 offset:12320
    v_mfma_f32_16x16x32_bf16 v[8:11], v[72:75], a[20:23], v[8:11]
    v_mfma_f32_16x16x32_bf16 v[12:15], v[76:79], a[20:23], v[12:15]
    v_mfma_f32_16x16x32_bf16 v[16:19], v[72:75], a[76:79], v[16:19]
    v_mfma_f32_16x16x32_bf16 v[20:23], v[76:79], a[76:79], v[20:23]
    v_mfma_f32_16x16x32_bf16 v[24:27], v[72:75], a[132:135], v[24:27]
    v_mfma_f32_16x16x32_bf16 v[28:31], v[76:79], a[132:135], v[28:31]
    v_mfma_f32_16x16x32_bf16 v[32:35], v[72:75], a[188:191], v[32:35]
    v_mfma_f32_16x16x32_bf16 v[36:39], v[76:79], a[188:191], v[36:39]
    v_mfma_f32_16x16x32_bf16 v[40:43], v[72:75], a[244:247], v[40:43]
    v_mfma_f32_16x16x32_bf16 v[44:47], v[76:79], a[244:247], v[44:47]
    v_mfma_f32_16x16x32_bf16 v[48:51], v[72:75], v[164:167], v[48:51]
    v_mfma_f32_16x16x32_bf16 v[52:55], v[76:79], v[164:167], v[52:55]
    v_mfma_f32_16x16x32_bf16 v[56:59], v[72:75], v[220:223], v[56:59]
    v_mfma_f32_16x16x32_bf16 v[60:63], v[76:79], v[220:223], v[60:63]
    s_waitcnt lgkmcnt(0)
    ds_read_b128 v[72:75], v4 offset:14336
    ds_read_b128 v[76:79], v4 offset:14368
    v_mfma_f32_16x16x32_bf16 v[8:11], v[64:67], a[24:27], v[8:11]
    v_mfma_f32_16x16x32_bf16 v[12:15], v[68:71], a[24:27], v[12:15]
    v_mfma_f32_16x16x32_bf16 v[16:19], v[64:67], a[80:83], v[16:19]
    v_mfma_f32_16x16x32_bf16 v[20:23], v[68:71], a[80:83], v[20:23]
    v_mfma_f32_16x16x32_bf16 v[24:27], v[64:67], a[136:139], v[24:27]
    v_mfma_f32_16x16x32_bf16 v[28:31], v[68:71], a[136:139], v[28:31]
    v_mfma_f32_16x16x32_bf16 v[32:35], v[64:67], a[192:195], v[32:35]
    v_mfma_f32_16x16x32_bf16 v[36:39], v[68:71], a[192:195], v[36:39]
    v_mfma_f32_16x16x32_bf16 v[40:43], v[64:67], a[248:251], v[40:43]
    v_mfma_f32_16x16x32_bf16 v[44:47], v[68:71], a[248:251], v[44:47]
    v_mfma_f32_16x16x32_bf16 v[48:51], v[64:67], v[168:171], v[48:51]
    v_mfma_f32_16x16x32_bf16 v[52:55], v[68:71], v[168:171], v[52:55]
    v_mfma_f32_16x16x32_bf16 v[56:59], v[64:67], v[224:227], v[56:59]
    v_mfma_f32_16x16x32_bf16 v[60:63], v[68:71], v[224:227], v[60:63]
    s_waitcnt lgkmcnt(0)
    ds_read_b128 v[64:67], v4 offset:16384
    ds_read_b128 v[68:71], v4 offset:16416
    v_mfma_f32_16x16x32_bf16 v[8:11], v[72:75], a[28:31], v[8:11]
    v_mfma_f32_16x16x32_bf16 v[12:15], v[76:79], a[28:31], v[12:15]
    v_mfma_f32_16x16x32_bf16 v[16:19], v[72:75], a[84:87], v[16:19]
    v_mfma_f32_16x16x32_bf16 v[20:23], v[76:79], a[84:87], v[20:23]
    v_mfma_f32_16x16x32_bf16 v[24:27], v[72:75], a[140:143], v[24:27]
    v_mfma_f32_16x16x32_bf16 v[28:31], v[76:79], a[140:143], v[28:31]
    v_mfma_f32_16x16x32_bf16 v[32:35], v[72:75], a[196:199], v[32:35]
    v_mfma_f32_16x16x32_bf16 v[36:39], v[76:79], a[196:199], v[36:39]
    v_mfma_f32_16x16x32_bf16 v[40:43], v[72:75], a[252:255], v[40:43]
    v_mfma_f32_16x16x32_bf16 v[44:47], v[76:79], a[252:255], v[44:47]
    v_mfma_f32_16x16x32_bf16 v[48:51], v[72:75], v[172:175], v[48:51]
    v_mfma_f32_16x16x32_bf16 v[52:55], v[76:79], v[172:175], v[52:55]
    v_mfma_f32_16x16x32_bf16 v[56:59], v[72:75], v[228:231], v[56:59]
    v_mfma_f32_16x16x32_bf16 v[60:63], v[76:79], v[228:231], v[60:63]
    s_waitcnt lgkmcnt(0)
    ds_read_b128 v[72:75], v4 offset:18432
    ds_read_b128 v[76:79], v4 offset:18464
    v_mfma_f32_16x16x32_bf16 v[8:11], v[64:67], a[32:35], v[8:11]
    v_mfma_f32_16x16x32_bf16 v[12:15], v[68:71], a[32:35], v[12:15]
    v_mfma_f32_16x16x32_bf16 v[16:19], v[64:67], a[88:91], v[16:19]
    v_mfma_f32_16x16x32_bf16 v[20:23], v[68:71], a[88:91], v[20:23]
    v_mfma_f32_16x16x32_bf16 v[24:27], v[64:67], a[144:147], v[24:27]
    v_mfma_f32_16x16x32_bf16 v[28:31], v[68:71], a[144:147], v[28:31]
    v_mfma_f32_16x16x32_bf16 v[32:35], v[64:67], a[200:203], v[32:35]
    v_mfma_f32_16x16x32_bf16 v[36:39], v[68:71], a[200:203], v[36:39]
    v_mfma_f32_16x16x32_bf16 v[40:43], v[64:67], v[120:123], v[40:43]
    v_mfma_f32_16x16x32_bf16 v[44:47], v[68:71], v[120:123], v[44:47]
    v_mfma_f32_16x16x32_bf16 v[48:51], v[64:67], v[176:179], v[48:51]
    v_mfma_f32_16x16x32_bf16 v[52:55], v[68:71], v[176:179], v[52:55]
    v_mfma_f32_16x16x32_bf16 v[56:59], v[64:67], v[232:235], v[56:59]
    v_mfma_f32_16x16x32_bf16 v[60:63], v[68:71], v[232:235], v[60:63]
    s_waitcnt lgkmcnt(0)
    ds_read_b128 v[64:67], v4 offset:20480
    ds_read_b128 v[68:71], v4 offset:20512
    v_mfma_f32_16x16x32_bf16 v[8:11], v[72:75], a[36:39], v[8:11]
    v_mfma_f32_16x16x32_bf16 v[12:15], v[76:79], a[36:39], v[12:15]
    v_mfma_f32_16x16x32_bf16 v[16:19], v[72:75], a[92:95], v[16:19]
    v_mfma_f32_16x16x32_bf16 v[20:23], v[76:79], a[92:95], v[20:23]
    v_mfma_f32_16x16x32_bf16 v[24:27], v[72:75], a[148:151], v[24:27]
    v_mfma_f32_16x16x32_bf16 v[28:31], v[76:79], a[148:151], v[28:31]
    v_mfma_f32_16x16x32_bf16 v[32:35], v[72:75], a[204:207], v[32:35]
    v_mfma_f32_16x16x32_bf16 v[36:39], v[76:79], a[204:207], v[36:39]
    v_mfma_f32_16x16x32_bf16 v[40:43], v[72:75], v[124:127], v[40:43]
    v_mfma_f32_16x16x32_bf16 v[44:47], v[76:79], v[124:127], v[44:47]
    v_mfma_f32_16x16x32_bf16 v[48:51], v[72:75], v[180:183], v[48:51]
    v_mfma_f32_16x16x32_bf16 v[52:55], v[76:79], v[180:183], v[52:55]
    v_mfma_f32_16x16x32_bf16 v[56:59], v[72:75], v[236:239], v[56:59]
    v_mfma_f32_16x16x32_bf16 v[60:63], v[76:79], v[236:239], v[60:63]
    s_waitcnt lgkmcnt(0)
    ds_read_b128 v[72:75], v4 offset:22528
    ds_read_b128 v[76:79], v4 offset:22560
    v_mfma_f32_16x16x32_bf16 v[8:11], v[64:67], a[40:43], v[8:11]
    v_mfma_f32_16x16x32_bf16 v[12:15], v[68:71], a[40:43], v[12:15]
    v_mfma_f32_16x16x32_bf16 v[16:19], v[64:67], a[96:99], v[16:19]
    v_mfma_f32_16x16x32_bf16 v[20:23], v[68:71], a[96:99], v[20:23]
    v_mfma_f32_16x16x32_bf16 v[24:27], v[64:67], a[152:155], v[24:27]
    v_mfma_f32_16x16x32_bf16 v[28:31], v[68:71], a[152:155], v[28:31]
    v_mfma_f32_16x16x32_bf16 v[32:35], v[64:67], a[208:211], v[32:35]
    v_mfma_f32_16x16x32_bf16 v[36:39], v[68:71], a[208:211], v[36:39]
    v_mfma_f32_16x16x32_bf16 v[40:43], v[64:67], v[128:131], v[40:43]
    v_mfma_f32_16x16x32_bf16 v[44:47], v[68:71], v[128:131], v[44:47]
    v_mfma_f32_16x16x32_bf16 v[48:51], v[64:67], v[184:187], v[48:51]
    v_mfma_f32_16x16x32_bf16 v[52:55], v[68:71], v[184:187], v[52:55]
    v_mfma_f32_16x16x32_bf16 v[56:59], v[64:67], v[240:243], v[56:59]
    v_mfma_f32_16x16x32_bf16 v[60:63], v[68:71], v[240:243], v[60:63]
    s_waitcnt lgkmcnt(0)
    ds_read_b128 v[64:67], v4 offset:24576
    ds_read_b128 v[68:71], v4 offset:24608
    v_mfma_f32_16x16x32_bf16 v[8:11], v[72:75], a[44:47], v[8:11]
    v_mfma_f32_16x16x32_bf16 v[12:15], v[76:79], a[44:47], v[12:15]
    v_mfma_f32_16x16x32_bf16 v[16:19], v[72:75], a[100:103], v[16:19]
    v_mfma_f32_16x16x32_bf16 v[20:23], v[76:79], a[100:103], v[20:23]
    v_mfma_f32_16x16x32_bf16 v[24:27], v[72:75], a[156:159], v[24:27]
    v_mfma_f32_16x16x32_bf16 v[28:31], v[76:79], a[156:159], v[28:31]
    v_mfma_f32_16x16x32_bf16 v[32:35], v[72:75], a[212:215], v[32:35]
    v_mfma_f32_16x16x32_bf16 v[36:39], v[76:79], a[212:215], v[36:39]
    v_mfma_f32_16x16x32_bf16 v[40:43], v[72:75], v[132:135], v[40:43]
    v_mfma_f32_16x16x32_bf16 v[44:47], v[76:79], v[132:135], v[44:47]
    v_mfma_f32_16x16x32_bf16 v[48:51], v[72:75], v[188:191], v[48:51]
    v_mfma_f32_16x16x32_bf16 v[52:55], v[76:79], v[188:191], v[52:55]
    v_mfma_f32_16x16x32_bf16 v[56:59], v[72:75], v[244:247], v[56:59]
    v_mfma_f32_16x16x32_bf16 v[60:63], v[76:79], v[244:247], v[60:63]
    s_waitcnt lgkmcnt(0)
    ds_read_b128 v[72:75], v4 offset:26624
    ds_read_b128 v[76:79], v4 offset:26656
    v_mfma_f32_16x16x32_bf16 v[8:11], v[64:67], a[48:51], v[8:11]
    v_mfma_f32_16x16x32_bf16 v[12:15], v[68:71], a[48:51], v[12:15]
    v_mfma_f32_16x16x32_bf16 v[16:19], v[64:67], a[104:107], v[16:19]
    v_mfma_f32_16x16x32_bf16 v[20:23], v[68:71], a[104:107], v[20:23]
    v_mfma_f32_16x16x32_bf16 v[24:27], v[64:67], a[160:163], v[24:27]
    v_mfma_f32_16x16x32_bf16 v[28:31], v[68:71], a[160:163], v[28:31]
    v_mfma_f32_16x16x32_bf16 v[32:35], v[64:67], a[216:219], v[32:35]
    v_mfma_f32_16x16x32_bf16 v[36:39], v[68:71], a[216:219], v[36:39]
    v_mfma_f32_16x16x32_bf16 v[40:43], v[64:67], v[136:139], v[40:43]
    v_mfma_f32_16x16x32_bf16 v[44:47], v[68:71], v[136:139], v[44:47]
    v_mfma_f32_16x16x32_bf16 v[48:51], v[64:67], v[192:195], v[48:51]
    v_mfma_f32_16x16x32_bf16 v[52:55], v[68:71], v[192:195], v[52:55]
    v_mfma_f32_16x16x32_bf16 v[56:59], v[64:67], v[248:251], v[56:59]
    v_mfma_f32_16x16x32_bf16 v[60:63], v[68:71], v[248:251], v[60:63]
    s_waitcnt lgkmcnt(0)
    v_mfma_f32_16x16x32_bf16 v[8:11], v[72:75], a[52:55], v[8:11]
    v_mfma_f32_16x16x32_bf16 v[12:15], v[76:79], a[52:55], v[12:15]
    v_mfma_f32_16x16x32_bf16 v[16:19], v[72:75], a[108:111], v[16:19]
    v_mfma_f32_16x16x32_bf16 v[20:23], v[76:79], a[108:111], v[20:23]
    v_mfma_f32_16x16x32_bf16 v[24:27], v[72:75], a[164:167], v[24:27]
    v_mfma_f32_16x16x32_bf16 v[28:31], v[76:79], a[164:167], v[28:31]
    v_mfma_f32_16x16x32_bf16 v[32:35], v[72:75], a[220:223], v[32:35]
    v_mfma_f32_16x16x32_bf16 v[36:39], v[76:79], a[220:223], v[36:39]
    v_mfma_f32_16x16x32_bf16 v[40:43], v[72:75], v[140:143], v[40:43]
    v_mfma_f32_16x16x32_bf16 v[44:47], v[76:79], v[140:143], v[44:47]
    v_mfma_f32_16x16x32_bf16 v[48:51], v[72:75], v[196:199], v[48:51]
    v_mfma_f32_16x16x32_bf16 v[52:55], v[76:79], v[196:199], v[52:55]
    v_mfma_f32_16x16x32_bf16 v[56:59], v[72:75], v[252:255], v[56:59]
    v_mfma_f32_16x16x32_bf16 v[60:63], v[76:79], v[252:255], v[60:63]
    s_mul_i32 s26, s46, 458752
    s_add_u32 s26, s26, 18366464
    v_cvt_pk_bf16_f32 v80, v8, v9
    v_cvt_pk_bf16_f32 v81, v10, v11
    v_cvt_pk_bf16_f32 v82, v12, v13
    v_cvt_pk_bf16_f32 v83, v14, v15
    s_add_u32 s27, s26, s60
    buffer_store_dwordx4 v[80:83], v1, s[4:7], s27 offen sc1
    v_cvt_pk_bf16_f32 v84, v16, v17
    v_cvt_pk_bf16_f32 v85, v18, v19
    v_cvt_pk_bf16_f32 v86, v20, v21
    v_cvt_pk_bf16_f32 v87, v22, v23
    s_add_u32 s27, s26, s61
    buffer_store_dwordx4 v[84:87], v1, s[4:7], s27 offen sc1
    v_cvt_pk_bf16_f32 v80, v24, v25
    v_cvt_pk_bf16_f32 v81, v26, v27
    v_cvt_pk_bf16_f32 v82, v28, v29
    v_cvt_pk_bf16_f32 v83, v30, v31
    s_add_u32 s27, s26, s62
    buffer_store_dwordx4 v[80:83], v1, s[4:7], s27 offen sc1
    v_cvt_pk_bf16_f32 v84, v32, v33
    v_cvt_pk_bf16_f32 v85, v34, v35
    v_cvt_pk_bf16_f32 v86, v36, v37
    v_cvt_pk_bf16_f32 v87, v38, v39
    s_add_u32 s27, s26, s63
    buffer_store_dwordx4 v[84:87], v1, s[4:7], s27 offen sc1
    v_cvt_pk_bf16_f32 v80, v40, v41
    v_cvt_pk_bf16_f32 v81, v42, v43
    v_cvt_pk_bf16_f32 v82, v44, v45
    v_cvt_pk_bf16_f32 v83, v46, v47
    s_add_u32 s27, s26, s64
    buffer_store_dwordx4 v[80:83], v1, s[4:7], s27 offen sc1
    v_cvt_pk_bf16_f32 v84, v48, v49
    v_cvt_pk_bf16_f32 v85, v50, v51
    v_cvt_pk_bf16_f32 v86, v52, v53
    v_cvt_pk_bf16_f32 v87, v54, v55
    s_add_u32 s27, s26, s65
    buffer_store_dwordx4 v[84:87], v1, s[4:7], s27 offen sc1
    v_cvt_pk_bf16_f32 v80, v56, v57
    v_cvt_pk_bf16_f32 v81, v58, v59
    v_cvt_pk_bf16_f32 v82, v60, v61
    v_cvt_pk_bf16_f32 v83, v62, v63
    s_add_u32 s27, s26, s66
    buffer_store_dwordx4 v[80:83], v1, s[4:7], s27 offen sc1
    s_mov_b32 s53, s46
    s_add_u32 s46, s46, 4
    v_xor_b32 v4, 32768, v4
    s_add_u32 s49, s49, 1
    s_cmp_lt_u32 s49, 16
    s_cbranch_scc1 dp_loop
    s_waitcnt vmcnt(0)
    s_barrier
    s_cmp_lg_u32 s9, 0
    s_cbranch_scc1 dp_nosigb
    s_lshl_b32 s24, s53, 7
    s_add_u32 s24, s24, 57688064
    v_mov_b32 v3, s24
    s_mov_b64 exec, 1
    buffer_atomic_add v2, v3, s[4:7], 0 offen
    s_mov_b64 exec, -1
dp_nosigb:
    s_mov_b32 s46, s45
    s_mov_b32 s49, 0
dp_uloop:
    s_mul_i32 s26, s46, 7168
    s_add_u32 s26, s26, 17244160
dp_upoll:
    buffer_load_dwordx4 v[88:91], v1, s[4:7], s26 offen offset:0 sc1
    buffer_load_dwordx4 v[92:95], v1, s[4:7], s26 offen offset:1024 sc1
    buffer_load_dwordx4 v[96:99], v1, s[4:7], s26 offen offset:2048 sc1
    buffer_load_dwordx4 v[100:103], v1, s[4:7], s26 offen offset:3072 sc1
    s_add_u32 s27, s26, 4096
    buffer_load_dwordx4 v[104:107], v1, s[4:7], s27 offen offset:0 sc1
    buffer_load_dwordx4 v[108:111], v1, s[4:7], s27 offen offset:1024 sc1
    buffer_load_dwordx4 v[112:115], v1, s[4:7], s27 offen offset:2048 sc1
    s_waitcnt vmcnt(0)
    v_max3_u32 v80, v88, v89, v90
    v_max3_u32 v80, v80, v91, v92
    v_max3_u32 v80, v80, v93, v94
    v_max3_u32 v80, v80, v95, v96
    v_max3_u32 v80, v80, v97, v98
    v_max3_u32 v80, v80, v99, v100
    v_max3_u32 v80, v80, v101, v102
    v_max3_u32 v80, v80, v103, v104
    v_max3_u32 v80, v80, v105, v106
    v_max3_u32 v80, v80, v107, v108
    v_max3_u32 v80, v80, v109, v110
    v_max3_u32 v80, v80, v111, v112
    v_max3_u32 v80, v80, v113, v114
    v_max_u32 v80, v80, v115
    v_cmp_eq_u32 vcc, -1, v80
    s_cbranch_vccnz dp_uretry
dp_ugo:
    v_mov_b32 v8, 0
    v_mov_b32 v9, 0
    v_mov_b32 v10, 0
    v_mov_b32 v11, 0
    v_mov_b32 v12, 0
    v_mov_b32 v13, 0
    v_mov_b32 v14, 0
    v_mov_b32 v15, 0
    v_mov_b32 v16, 0
    v_mov_b32 v17, 0
    v_mov_b32 v18, 0
    v_mov_b32 v19, 0
    v_mov_b32 v20, 0
    v_mov_b32 v21, 0
    v_mov_b32 v22, 0
    v_mov_b32 v23, 0
    v_mov_b32 v24, 0
    v_mov_b32 v25, 0
    v_mov_b32 v26, 0
    v_mov_b32 v27, 0
    v_mov_b32 v28, 0
    v_mov_b32 v29, 0
    v_mov_b32 v30, 0
    v_mov_b32 v31, 0
    v_mov_b32 v32, 0
    v_mov_b32 v33, 0
    v_mov_b32 v34, 0
    v_mov_b32 v35, 0
    v_mov_b32 v36, 0
    v_mov_b32 v37, 0
    v_mov_b32 v38, 0
    v_mov_b32 v39, 0
    v_smfmac_f32_16x16x64_bf16 v[8:11], v[88:91], a[0:7], v5
    v_smfmac_f32_16x16x64_bf16 v[12:15], v[88:91], a[56:63], v5
    v_smfmac_f32_16x16x64_bf16 v[16:19], v[88:91], a[112:119], v5
    v_smfmac_f32_16x16x64_bf16 v[20:23], v[88:91], a[168:175], v5
    v_smfmac_f32_16x16x64_bf16 v[24:27], v[88:91], a[224:231], v5
    v_smfmac_f32_16x16x64_bf16 v[28:31], v[88:91], v[144:151], v5
    v_smfmac_f32_16x16x64_bf16 v[32:35], v[88:91], v[200:207], v5
    v_smfmac_f32_16x16x64_bf16 v[8:11], v[92:95], a[8:15], v5
    v_smfmac_f32_16x16x64_bf16 v[12:15], v[92:95], a[64:71], v5
    v_smfmac_f32_16x16x64_bf16 v[16:19], v[92:95], a[120:127], v5
    v_smfmac_f32_16x16x64_bf16 v[20:23], v[92:95], a[176:183], v5
    v_smfmac_f32_16x16x64_bf16 v[24:27], v[92:95], a[232:239], v5
    v_smfmac_f32_16x16x64_bf16 v[28:31], v[92:95], v[152:159], v5
    v_smfmac_f32_16x16x64_bf16 v[32:35], v[92:95], v[208:215], v5
    v_smfmac_f32_16x16x64_bf16 v[8:11], v[96:99], a[16:23], v5
    v_smfmac_f32_16x16x64_bf16 v[12:15], v[96:99], a[72:79], v5
    v_smfmac_f32_16x16x64_bf16 v[16:19], v[96:99], a[128:135], v5
    v_smfmac_f32_16x16x64_bf16 v[20:23], v[96:99], a[184:191], v5
    v_smfmac_f32_16x16x64_bf16 v[24:27], v[96:99], a[240:247], v5
    v_smfmac_f32_16x16x64_bf16 v[28:31], v[96:99], v[160:167], v5
    v_smfmac_f32_16x16x64_bf16 v[32:35], v[96:99], v[216:223], v5
    v_smfmac_f32_16x16x64_bf16 v[8:11], v[100:103], a[24:31], v5
    v_smfmac_f32_16x16x64_bf16 v[12:15], v[100:103], a[80:87], v5
    v_smfmac_f32_16x16x64_bf16 v[16:19], v[100:103], a[136:143], v5
    v_smfmac_f32_16x16x64_bf16 v[20:23], v[100:103], a[192:199], v5
    v_smfmac_f32_16x16x64_bf16 v[24:27], v[100:103], a[248:255], v5
    v_smfmac_f32_16x16x64_bf16 v[28:31], v[100:103], v[168:175], v5
    v_smfmac_f32_16x16x64_bf16 v[32:35], v[100:103], v[224:231], v5
    v_smfmac_f32_16x16x64_bf16 v[8:11], v[104:107], a[32:39], v5
    v_smfmac_f32_16x16x64_bf16 v[12:15], v[104:107], a[88:95], v5
    v_smfmac_f32_16x16x64_bf16 v[16:19], v[104:107], a[144:151], v5
    v_smfmac_f32_16x16x64_bf16 v[20:23], v[104:107], a[200:207], v5
    v_smfmac_f32_16x16x64_bf16 v[24:27], v[104:107], v[120:127], v5
    v_smfmac_f32_16x16x64_bf16 v[28:31], v[104:107], v[176:183], v5
    v_smfmac_f32_16x16x64_bf16 v[32:35], v[104:107], v[232:239], v5
    v_smfmac_f32_16x16x64_bf16 v[8:11], v[108:111], a[40:47], v5
    v_smfmac_f32_16x16x64_bf16 v[12:15], v[108:111], a[96:103], v5
    v_smfmac_f32_16x16x64_bf16 v[16:19], v[108:111], a[152:159], v5
    v_smfmac_f32_16x16x64_bf16 v[20:23], v[108:111], a[208:215], v5
    v_smfmac_f32_16x16x64_bf16 v[24:27], v[108:111], v[128:135], v5
    v_smfmac_f32_16x16x64_bf16 v[28:31], v[108:111], v[184:191], v5
    v_smfmac_f32_16x16x64_bf16 v[32:35], v[108:111], v[240:247], v5
    v_smfmac_f32_16x16x64_bf16 v[8:11], v[112:115], a[48:55], v5
    v_smfmac_f32_16x16x64_bf16 v[12:15], v[112:115], a[104:111], v5
    v_smfmac_f32_16x16x64_bf16 v[16:19], v[112:115], a[160:167], v5
    v_smfmac_f32_16x16x64_bf16 v[20:23], v[112:115], a[216:223], v5
    v_smfmac_f32_16x16x64_bf16 v[24:27], v[112:115], v[136:143], v5
    v_smfmac_f32_16x16x64_bf16 v[28:31], v[112:115], v[192:199], v5
    v_smfmac_f32_16x16x64_bf16 v[32:35], v[112:115], v[248:255], v5
    s_lshl_b32 s26, s46, 4
    s_add_u32 s26, s26, s44
    s_mul_i32 s26, s26, 7168
    s_mul_i32 s27, s9, 1792
    s_add_u32 s26, s26, s27
    s_add_u32 s26, s26, 47726592
    s_nop 7
    v_permlane32_swap_b32 v8, v12
    v_permlane32_swap_b32 v9, v13
    v_permlane32_swap_b32 v10, v14
    v_permlane32_swap_b32 v11, v15
    v_add_f32 v8, v8, v12
    v_add_f32 v9, v9, v13
    v_add_f32 v10, v10, v14
    v_add_f32 v11, v11, v15
    v_cvt_pk_bf16_f32 v8, v8, v9
    v_cvt_pk_bf16_f32 v9, v10, v11
    buffer_store_dwordx2 v[8:9], v6, s[4:7], s26 offen offset:0 sc1
    v_permlane32_swap_b32 v16, v20
    v_permlane32_swap_b32 v17, v21
    v_permlane32_swap_b32 v18, v22
    v_permlane32_swap_b32 v19, v23
    v_add_f32 v16, v16, v20
    v_add_f32 v17, v17, v21
    v_add_f32 v18, v18, v22
    v_add_f32 v19, v19, v23
    v_cvt_pk_bf16_f32 v16, v16, v17
    v_cvt_pk_bf16_f32 v17, v18, v19
    buffer_store_dwordx2 v[16:17], v6, s[4:7], s26 offen offset:512 sc1
    v_permlane32_swap_b32 v24, v28
    v_permlane32_swap_b32 v25, v29
    v_permlane32_swap_b32 v26, v30
    v_permlane32_swap_b32 v27, v31
    v_add_f32 v24, v24, v28
    v_add_f32 v25, v25, v29
    v_add_f32 v26, v26, v30
    v_add_f32 v27, v27, v31
    v_cvt_pk_bf16_f32 v24, v24, v25
    v_cvt_pk_bf16_f32 v25, v26, v27
    buffer_store_dwordx2 v[24:25], v6, s[4:7], s26 offen offset:1024 sc1
    v_mov_b32 v36, v32
    v_mov_b32 v37, v33
    v_mov_b32 v38, v34
    v_mov_b32 v39, v35
    v_permlane32_swap_b32 v32, v36
    v_permlane32_swap_b32 v33, v37
    v_permlane32_swap_b32 v34, v38
    v_permlane32_swap_b32 v35, v39
    v_add_f32 v32, v32, v36
    v_add_f32 v33, v33, v37
    v_add_f32 v34, v34, v38
    v_add_f32 v35, v35, v39
    v_cvt_pk_bf16_f32 v32, v32, v33
    v_cvt_pk_bf16_f32 v33, v34, v35
    buffer_store_dwordx2 v[32:33], v7, s[4:7], s26 offen offset:1536 sc1
    s_waitcnt vmcnt(0)
    s_barrier
    s_cmp_lg_u32 s9, 0
    s_cbranch_scc1 dp_nosigc
    s_lshl_b32 s24, s46, 7
    s_add_u32 s24, s24, 57704448
    v_mov_b32 v3, s24
    s_mov_b64 exec, 1
    buffer_atomic_add v2, v3, s[4:7], 0 offen
    s_mov_b64 exec, -1
dp_nosigc:
    s_add_u32 s46, s46, 4
    s_add_u32 s49, s49, 1
    s_cmp_lt_u32 s49, 16
    s_cbranch_scc1 dp_uloop
    s_endpgm
dp_uretry:
    s_cmp_eq_u32 s17, 0
    s_cbranch_scc1 dp_ugo
    s_sub_u32 s17, s17, 1
    s_sleep 4
    s_branch dp_upoll
ts_start:
    s_and_b32 s44, s11, 7
    s_lshr_b32 s24, s11, 5
    s_lshl_b32 s24, s24, 3
    s_add_u32 s44, s44, s24
    s_bfe_u32 s45, s11, 0x20003
    v_lshlrev_b32 v1, 4, v0
    v_mov_b32 v2, 1
    s_mul_i32 s54, s9, 7168
    v_lshrrev_b32 v8, 4, v0
    v_and_b32 v9, 15, v0
    v_lshlrev_b32 v10, 9, v8
    v_lshlrev_b32 v11, 4, v9
    v_add_u32 v4, v10, v11
    v_bfe_u32 v10, v9, 3, 1
    v_lshlrev_b32 v10, 4, v10
    v_bfe_u32 v11, v9, 1, 1
    v_lshlrev_b32 v11, 3, v11
    v_bfe_u32 v12, v9, 2, 1
    v_lshlrev_b32 v12, 2, v12
    v_and_b32 v13, 1, v9
    v_add3_u32 v10, v10, v11, v12
    v_add_u32 v10, v10, v13
    v_lshlrev_b32 v10, 4, v10
    s_mul_i32 s24, s9, 7168
    v_add_u32 v10, s24, v10
    v_lshlrev_b32 v11, 10, v8
    v_add_u32 v5, v10, v11
    v_lshlrev_b32 v11, 9, v8
    v_add3_u32 v6, v10, v11, 0
    v_add_u32 v6, 4096, v6
    v_lshrrev_b32 v11, 1, v8
    v_lshlrev_b32 v11, 9, v11
    v_and_b32 v12, 1, v8
    v_lshlrev_b32 v12, 3, v12
    v_add3_u32 v7, v10, v11, v12
    v_add_u32 v7, 6144, v7
    v_and_b32 v10, 7, v9
    v_lshlrev_b32 v10, 4, v10
    s_mul_i32 s24, s9, 1792
    s_add_u32 s24, s24, 65536
    v_add_u32 v10, s24, v10
    v_lshlrev_b32 v11, 8, v8
    v_add_u32 v80, v10, v11
    v_lshrrev_b32 v11, 1, v8
    v_lshlrev_b32 v11, 8, v11
    v_add3_u32 v81, v10, v11, v12
    v_add_u32 v81, 1024, v81
    v_lshlrev_b32 v11, 2, v8
    v_add_u32 v82, v10, v11
    v_add_u32 v82, 1536, v82
    s_lshl_b32 s24, s9, 1
    s_min_u32 s24, s24, 5
    s_lshl_b32 s24, s24, 10
    v_add_u32 v83, s24, v1
    v_add_u32 v84, 65536, v83
    s_mul_i32 s24, s9, 6144
    s_add_u32 s24, s24, 73728
    v_add_u32 v85, s24, v1
    s_and_b32 s24, s9, 1
    s_mul_i32 s25, s24, 3072
    s_add_u32 s25, s25, 73728
    v_add_u32 v86, s25, v1
    s_lshl_b32 s25, s24, 4
    v_add_u32 v10, s25, v9
    v_lshrrev_b32 v11, 1, v8
    v_lshlrev_b32 v11, 4, v11
    v_sub_u32 v10, v10, v11
    v_and_b32 v11, 1, v8
    v_lshlrev_b32 v11, 2, v11
    v_sub_u32 v87, v10, v11
    v_add_u32 v10, s25, v9
    v_lshlrev_b32 v10, 4, v10
    v_lshlrev_b32 v11, 3, v8
    v_add_u32 v10, v10, v11
    v_mov_b32 v11, 0x7fff0000
    v_cmp_gt_u32 vcc, 2, v8
    s_nop 1
    v_cndmask_b32 v88, v11, v10, vcc
    s_lshl_b32 s24, s44, 2
    s_add_u32 s24, s24, s9
    s_mul_i32 s24, s24, 100352
    s_add_u32 s24, s24, 3932160
    s_mov_b32 s70, s24
    s_mov_b32 s24, 224
    v_mbcnt_lo_u32_b32 v92, -1, 0
    v_mbcnt_hi_u32_b32 v92, -1, v92
    v_cmp_gt_u32 vcc, 32, v92
    v_add_u32 v92, s24, v92
    v_lshlrev_b32 v92, 7, v92
    v_add_u32 v92, 57753600, v92
    v_mov_b32 v90, 0x7fff0000
    v_cndmask_b32 v92, v90, v92, vcc
wm12:
    buffer_load_dword v90, v92, s[4:7], 0 offen sc1
    s_waitcnt vmcnt(0)
    v_cmp_eq_u32 s[80:81], s18, v90
    s_cmp_eq_u32 s80, -1
    s_cbranch_scc1 wm12_ok
    s_cmp_eq_u32 s17, 0
    s_cbranch_scc1 wm12_ok
    s_sub_u32 s17, s17, 1
    s_sleep 8
    s_branch wm12
wm12_ok:
    v_mov_b32 v93, 17251328
ts_dly:
    buffer_load_dword v94, v93, s[4:7], 0 offen sc1
    s_waitcnt vmcnt(0)
    v_cmp_eq_u32 vcc, -1, v94
    s_cbranch_vccz ts_dly_ok
    s_cmp_eq_u32 s17, 0
    s_cbranch_scc1 ts_dly_ok
    s_sub_u32 s17, s17, 1
    s_sleep 40
    s_branch ts_dly
ts_dly_ok:
    s_mul_i32 s24, s44, 14
    s_add_u32 s24, s24, 0
    v_mbcnt_lo_u32_b32 v92, -1, 0
    v_mbcnt_hi_u32_b32 v92, -1, v92
    v_cmp_gt_u32 vcc, 7, v92
    v_add_u32 v92, s24, v92
    v_lshlrev_b32 v92, 7, v92
    v_add_u32 v92, 57753600, v92
    v_mov_b32 v90, 0x7fff0000
    v_cndmask_b32 v92, v90, v92, vcc
    s_mov_b32 s89, 0
sl13:
    buffer_load_dword v90, v92, s[4:7], 0 offen sc1
    s_waitcnt vmcnt(0)
    v_cmp_eq_u32 s[80:81], s18, v90
    s_bitcmp1_b32 s89, 0
    s_cbranch_scc1 sl13_0
    s_bitcmp1_b32 s80, 0
    s_cbranch_scc0 sl13_0
    s_add_u32 s25, s70, 0
    buffer_load_dwordx4 a[0:3], v1, s[4:7], s25 offen sc1
    buffer_load_dwordx4 a[4:7], v1, s[4:7], s25 offen offset:1024 sc1
    s_add_u32 s25, s25, 14336
    buffer_load_dwordx4 a[56:59], v1, s[4:7], s25 offen sc1
    buffer_load_dwordx4 a[60:63], v1, s[4:7], s25 offen offset:1024 sc1
    s_add_u32 s25, s25, 14336
    buffer_load_dwordx4 a[112:115], v1, s[4:7], s25 offen sc1
    buffer_load_dwordx4 a[116:119], v1, s[4:7], s25 offen offset:1024 sc1
    s_add_u32 s25, s25, 14336
    buffer_load_dwordx4 a[168:171], v1, s[4:7], s25 offen sc1
    buffer_load_dwordx4 a[172:175], v1, s[4:7], s25 offen offset:1024 sc1
    s_add_u32 s25, s25, 14336
    buffer_load_dwordx4 a[224:227], v1, s[4:7], s25 offen sc1
    buffer_load_dwordx4 a[228:231], v1, s[4:7], s25 offen offset:1024 sc1
    s_add_u32 s25, s25, 14336
    buffer_load_dwordx4 v[144:147], v1, s[4:7], s25 offen sc1
    buffer_load_dwordx4 v[148:151], v1, s[4:7], s25 offen offset:1024 sc1
    s_add_u32 s25, s25, 14336
    buffer_load_dwordx4 v[200:203], v1, s[4:7], s25 offen sc1
    buffer_load_dwordx4 v[204:207], v1, s[4:7], s25 offen offset:1024 sc1
    s_bitset1_b32 s89, 0
sl13_0:
    s_bitcmp1_b32 s89, 1
    s_cbranch_scc1 sl13_1
    s_bitcmp1_b32 s80, 1
    s_cbranch_scc0 sl13_1
    s_add_u32 s25, s70, 2048
    buffer_load_dwordx4 a[8:11], v1, s[4:7], s25 offen sc1
    buffer_load_dwordx4 a[12:15], v1, s[4:7], s25 offen offset:1024 sc1
    s_add_u32 s25, s25, 14336
    buffer_load_dwordx4 a[64:67], v1, s[4:7], s25 offen sc1
    buffer_load_dwordx4 a[68:71], v1, s[4:7], s25 offen offset:1024 sc1
    s_add_u32 s25, s25, 14336
    buffer_load_dwordx4 a[120:123], v1, s[4:7], s25 offen sc1
    buffer_load_dwordx4 a[124:127], v1, s[4:7], s25 offen offset:1024 sc1
    s_add_u32 s25, s25, 14336
    buffer_load_dwordx4 a[176:179], v1, s[4:7], s25 offen sc1
    buffer_load_dwordx4 a[180:183], v1, s[4:7], s25 offen offset:1024 sc1
    s_add_u32 s25, s25, 14336
    buffer_load_dwordx4 a[232:235], v1, s[4:7], s25 offen sc1
    buffer_load_dwordx4 a[236:239], v1, s[4:7], s25 offen offset:1024 sc1
    s_add_u32 s25, s25, 14336
    buffer_load_dwordx4 v[152:155], v1, s[4:7], s25 offen sc1
    buffer_load_dwordx4 v[156:159], v1, s[4:7], s25 offen offset:1024 sc1
    s_add_u32 s25, s25, 14336
    buffer_load_dwordx4 v[208:211], v1, s[4:7], s25 offen sc1
    buffer_load_dwordx4 v[212:215], v1, s[4:7], s25 offen offset:1024 sc1
    s_bitset1_b32 s89, 1
sl13_1:
    s_bitcmp1_b32 s89, 2
    s_cbranch_scc1 sl13_2
    s_bitcmp1_b32 s80, 2
    s_cbranch_scc0 sl13_2
    s_add_u32 s25, s70, 4096
    buffer_load_dwordx4 a[16:19], v1, s[4:7], s25 offen sc1
    buffer_load_dwordx4 a[20:23], v1, s[4:7], s25 offen offset:1024 sc1
    s_add_u32 s25, s25, 14336
    buffer_load_dwordx4 a[72:75], v1, s[4:7], s25 offen sc1
    buffer_load_dwordx4 a[76:79], v1, s[4:7], s25 offen offset:1024 sc1
    s_add_u32 s25, s25, 14336
    buffer_load_dwordx4 a[128:131], v1, s[4:7], s25 offen sc1
    buffer_load_dwordx4 a[132:135], v1, s[4:7], s25 offen offset:1024 sc1
    s_add_u32 s25, s25, 14336
    buffer_load_dwordx4 a[184:187], v1, s[4:7], s25 offen sc1
    buffer_load_dwordx4 a[188:191], v1, s[4:7], s25 offen offset:1024 sc1
    s_add_u32 s25, s25, 14336
    buffer_load_dwordx4 a[240:243], v1, s[4:7], s25 offen sc1
    buffer_load_dwordx4 a[244:247], v1, s[4:7], s25 offen offset:1024 sc1
    s_add_u32 s25, s25, 14336
    buffer_load_dwordx4 v[160:163], v1, s[4:7], s25 offen sc1
    buffer_load_dwordx4 v[164:167], v1, s[4:7], s25 offen offset:1024 sc1
    s_add_u32 s25, s25, 14336
    buffer_load_dwordx4 v[216:219], v1, s[4:7], s25 offen sc1
    buffer_load_dwordx4 v[220:223], v1, s[4:7], s25 offen offset:1024 sc1
    s_bitset1_b32 s89, 2
sl13_2:
    s_bitcmp1_b32 s89, 3
    s_cbranch_scc1 sl13_3
    s_bitcmp1_b32 s80, 3
    s_cbranch_scc0 sl13_3
    s_add_u32 s25, s70, 6144
    buffer_load_dwordx4 a[24:27], v1, s[4:7], s25 offen sc1
    buffer_load_dwordx4 a[28:31], v1, s[4:7], s25 offen offset:1024 sc1
    s_add_u32 s25, s25, 14336
    buffer_load_dwordx4 a[80:83], v1, s[4:7], s25 offen sc1
    buffer_load_dwordx4 a[84:87], v1, s[4:7], s25 offen offset:1024 sc1
    s_add_u32 s25, s25, 14336
    buffer_load_dwordx4 a[136:139], v1, s[4:7], s25 offen sc1
    buffer_load_dwordx4 a[140:143], v1, s[4:7], s25 offen offset:1024 sc1
    s_add_u32 s25, s25, 14336
    buffer_load_dwordx4 a[192:195], v1, s[4:7], s25 offen sc1
    buffer_load_dwordx4 a[196:199], v1, s[4:7], s25 offen offset:1024 sc1
    s_add_u32 s25, s25, 14336
    buffer_load_dwordx4 a[248:251], v1, s[4:7], s25 offen sc1
    buffer_load_dwordx4 a[252:255], v1, s[4:7], s25 offen offset:1024 sc1
    s_add_u32 s25, s25, 14336
    buffer_load_dwordx4 v[168:171], v1, s[4:7], s25 offen sc1
    buffer_load_dwordx4 v[172:175], v1, s[4:7], s25 offen offset:1024 sc1
    s_add_u32 s25, s25, 14336
    buffer_load_dwordx4 v[224:227], v1, s[4:7], s25 offen sc1
    buffer_load_dwordx4 v[228:231], v1, s[4:7], s25 offen offset:1024 sc1
    s_bitset1_b32 s89, 3
sl13_3:
    s_bitcmp1_b32 s89, 4
    s_cbranch_scc1 sl13_4
    s_bitcmp1_b32 s80, 4
    s_cbranch_scc0 sl13_4
    s_add_u32 s25, s70, 8192
    buffer_load_dwordx4 a[32:35], v1, s[4:7], s25 offen sc1
    buffer_load_dwordx4 a[36:39], v1, s[4:7], s25 offen offset:1024 sc1
    s_add_u32 s25, s25, 14336
    buffer_load_dwordx4 a[88:91], v1, s[4:7], s25 offen sc1
    buffer_load_dwordx4 a[92:95], v1, s[4:7], s25 offen offset:1024 sc1
    s_add_u32 s25, s25, 14336
    buffer_load_dwordx4 a[144:147], v1, s[4:7], s25 offen sc1
    buffer_load_dwordx4 a[148:151], v1, s[4:7], s25 offen offset:1024 sc1
    s_add_u32 s25, s25, 14336
    buffer_load_dwordx4 a[200:203], v1, s[4:7], s25 offen sc1
    buffer_load_dwordx4 a[204:207], v1, s[4:7], s25 offen offset:1024 sc1
    s_add_u32 s25, s25, 14336
    buffer_load_dwordx4 v[120:123], v1, s[4:7], s25 offen sc1
    buffer_load_dwordx4 v[124:127], v1, s[4:7], s25 offen offset:1024 sc1
    s_add_u32 s25, s25, 14336
    buffer_load_dwordx4 v[176:179], v1, s[4:7], s25 offen sc1
    buffer_load_dwordx4 v[180:183], v1, s[4:7], s25 offen offset:1024 sc1
    s_add_u32 s25, s25, 14336
    buffer_load_dwordx4 v[232:235], v1, s[4:7], s25 offen sc1
    buffer_load_dwordx4 v[236:239], v1, s[4:7], s25 offen offset:1024 sc1
    s_bitset1_b32 s89, 4
sl13_4:
    s_bitcmp1_b32 s89, 5
    s_cbranch_scc1 sl13_5
    s_bitcmp1_b32 s80, 5
    s_cbranch_scc0 sl13_5
    s_add_u32 s25, s70, 10240
    buffer_load_dwordx4 a[40:43], v1, s[4:7], s25 offen sc1
    buffer_load_dwordx4 a[44:47], v1, s[4:7], s25 offen offset:1024 sc1
    s_add_u32 s25, s25, 14336
    buffer_load_dwordx4 a[96:99], v1, s[4:7], s25 offen sc1
    buffer_load_dwordx4 a[100:103], v1, s[4:7], s25 offen offset:1024 sc1
    s_add_u32 s25, s25, 14336
    buffer_load_dwordx4 a[152:155], v1, s[4:7], s25 offen sc1
    buffer_load_dwordx4 a[156:159], v1, s[4:7], s25 offen offset:1024 sc1
    s_add_u32 s25, s25, 14336
    buffer_load_dwordx4 a[208:211], v1, s[4:7], s25 offen sc1
    buffer_load_dwordx4 a[212:215], v1, s[4:7], s25 offen offset:1024 sc1
    s_add_u32 s25, s25, 14336
    buffer_load_dwordx4 v[128:131], v1, s[4:7], s25 offen sc1
    buffer_load_dwordx4 v[132:135], v1, s[4:7], s25 offen offset:1024 sc1
    s_add_u32 s25, s25, 14336
    buffer_load_dwordx4 v[184:187], v1, s[4:7], s25 offen sc1
    buffer_load_dwordx4 v[188:191], v1, s[4:7], s25 offen offset:1024 sc1
    s_add_u32 s25, s25, 14336
    buffer_load_dwordx4 v[240:243], v1, s[4:7], s25 offen sc1
    buffer_load_dwordx4 v[244:247], v1, s[4:7], s25 offen offset:1024 sc1
    s_bitset1_b32 s89, 5
sl13_5:
    s_bitcmp1_b32 s89, 6
    s_cbranch_scc1 sl13_6
    s_bitcmp1_b32 s80, 6
    s_cbranch_scc0 sl13_6
    s_add_u32 s25, s70, 12288
    buffer_load_dwordx4 a[48:51], v1, s[4:7], s25 offen sc1
    buffer_load_dwordx4 a[52:55], v1, s[4:7], s25 offen offset:1024 sc1
    s_add_u32 s25, s25, 14336
    buffer_load_dwordx4 a[104:107], v1, s[4:7], s25 offen sc1
    buffer_load_dwordx4 a[108:111], v1, s[4:7], s25 offen offset:1024 sc1
    s_add_u32 s25, s25, 14336
    buffer_load_dwordx4 a[160:163], v1, s[4:7], s25 offen sc1
    buffer_load_dwordx4 a[164:167], v1, s[4:7], s25 offen offset:1024 sc1
    s_add_u32 s25, s25, 14336
    buffer_load_dwordx4 a[216:219], v1, s[4:7], s25 offen sc1
    buffer_load_dwordx4 a[220:223], v1, s[4:7], s25 offen offset:1024 sc1
    s_add_u32 s25, s25, 14336
    buffer_load_dwordx4 v[136:139], v1, s[4:7], s25 offen sc1
    buffer_load_dwordx4 v[140:143], v1, s[4:7], s25 offen offset:1024 sc1
    s_add_u32 s25, s25, 14336
    buffer_load_dwordx4 v[192:195], v1, s[4:7], s25 offen sc1
    buffer_load_dwordx4 v[196:199], v1, s[4:7], s25 offen offset:1024 sc1
    s_add_u32 s25, s25, 14336
    buffer_load_dwordx4 v[248:251], v1, s[4:7], s25 offen sc1
    buffer_load_dwordx4 v[252:255], v1, s[4:7], s25 offen offset:1024 sc1
    s_bitset1_b32 s89, 6
sl13_6:
    s_cmp_eq_u32 s89, 127
    s_cbranch_scc1 sl13_ok
    s_cmp_eq_u32 s17, 0
    s_cbranch_scc1 sl13_ok
    s_sub_u32 s17, s17, 1
    s_sleep 8
    s_branch sl13
sl13_ok:
    v_mov_b32 v90, 0
    v_mov_b32 v91, 0
    v_lshlrev_b32 v92, 3, v0
    v_add_u32 v92, 72704, v92
    ds_write_b64 v92, v[90:91]
    s_mov_b32 s46, s45
    s_mul_i32 s47, s46, 28672
    s_add_u32 s47, s47, 0
    s_mov_b32 s48, 0
    s_add_u32 s24, s48, s54
    s_mov_b32 m0, s24
    s_add_u32 s25, s47, s54
    buffer_load_dwordx4 v1, s[4:7], s25 offen offset:0 sc1 lds
    buffer_load_dwordx4 v1, s[4:7], s25 offen offset:1024 sc1 lds
    buffer_load_dwordx4 v1, s[4:7], s25 offen offset:2048 sc1 lds
    buffer_load_dwordx4 v1, s[4:7], s25 offen offset:3072 sc1 lds
    s_add_u32 s24, s24, 4096
    s_mov_b32 m0, s24
    s_add_u32 s25, s25, 4096
    buffer_load_dwordx4 v1, s[4:7], s25 offen offset:0 sc1 lds
    buffer_load_dwordx4 v1, s[4:7], s25 offen offset:1024 sc1 lds
    buffer_load_dwordx4 v1, s[4:7], s25 offen offset:2048 sc1 lds
    s_mov_b32 s49, 0
    s_mov_b32 s50, 0x3DB8AA3B
ts_loop:
    s_waitcnt vmcnt(0) lgkmcnt(0)
    s_barrier
    s_cmp_eq_u32 s49, 0
    s_cbranch_scc1 ts_first
    s_cmp_lg_u32 s9, 0
    s_cbranch_scc1 ts_nosiga
    s_lshl_b32 s24, s53, 7
    s_add_u32 s24, s24, 57696256
    v_mov_b32 v3, s24
    s_mov_b64 exec, 1
    buffer_atomic_add v2, v3, s[4:7], 0 offen
    s_mov_b64 exec, -1
ts_nosiga:
ts_first:
    s_cmp_eq_u32 s49, 15
    s_cbranch_scc1 ts_nodma
    s_add_u32 s47, s47, 114688
    s_xor_b32 s48, s48, 32768
    s_add_u32 s24, s48, s54
    s_mov_b32 m0, s24
    s_add_u32 s25, s47, s54
    buffer_load_dwordx4 v1, s[4:7], s25 offen offset:0 sc1 lds
    buffer_load_dwordx4 v1, s[4:7], s25 offen offset:1024 sc1 lds
    buffer_load_dwordx4 v1, s[4:7], s25 offen offset:2048 sc1 lds
    buffer_load_dwordx4 v1, s[4:7], s25 offen offset:3072 sc1 lds
    s_add_u32 s24, s24, 4096
    s_mov_b32 m0, s24
    s_add_u32 s25, s25, 4096
    buffer_load_dwordx4 v1, s[4:7], s25 offen offset:0 sc1 lds
    buffer_load_dwordx4 v1, s[4:7], s25 offen offset:1024 sc1 lds
    buffer_load_dwordx4 v1, s[4:7], s25 offen offset:2048 sc1 lds
ts_nodma:
    ds_read_b128 v[64:67], v4 offset:0
    ds_read_b128 v[68:71], v4 offset:256
    s_waitcnt lgkmcnt(0)
    ds_read_b128 v[72:75], v4 offset:2048
    ds_read_b128 v[76:79], v4 offset:2304
    v_mfma_f32_16x16x32_bf16 v[8:11], a[0:3], v[64:67], 0
    v_mfma_f32_16x16x32_bf16 v[12:15], a[0:3], v[68:71], 0
    v_mfma_f32_16x16x32_bf16 v[16:19], a[56:59], v[64:67], 0
    v_mfma_f32_16x16x32_bf16 v[20:23], a[56:59], v[68:71], 0
    v_mfma_f32_16x16x32_bf16 v[24:27], a[112:115], v[64:67], 0
    v_mfma_f32_16x16x32_bf16 v[28:31], a[112:115], v[68:71], 0
    v_mfma_f32_16x16x32_bf16 v[32:35], a[168:171], v[64:67], 0
    v_mfma_f32_16x16x32_bf16 v[36:39], a[168:171], v[68:71], 0
    v_mfma_f32_16x16x32_bf16 v[40:43], a[224:227], v[64:67], 0
    v_mfma_f32_16x16x32_bf16 v[44:47], a[224:227], v[68:71], 0
    v_mfma_f32_16x16x32_bf16 v[48:51], v[144:147], v[64:67], 0
    v_mfma_f32_16x16x32_bf16 v[52:55], v[144:147], v[68:71], 0
    v_mfma_f32_16x16x32_bf16 v[56:59], v[200:203], v[64:67], 0
    v_mfma_f32_16x16x32_bf16 v[60:63], v[200:203], v[68:71], 0
    s_waitcnt lgkmcnt(0)
    ds_read_b128 v[64:67], v4 offset:4096
    ds_read_b128 v[68:71], v4 offset:4352
    v_mfma_f32_16x16x32_bf16 v[8:11], a[4:7], v[72:75], v[8:11]
    v_mfma_f32_16x16x32_bf16 v[12:15], a[4:7], v[76:79], v[12:15]
    v_mfma_f32_16x16x32_bf16 v[16:19], a[60:63], v[72:75], v[16:19]
    v_mfma_f32_16x16x32_bf16 v[20:23], a[60:63], v[76:79], v[20:23]
    v_mfma_f32_16x16x32_bf16 v[24:27], a[116:119], v[72:75], v[24:27]
    v_mfma_f32_16x16x32_bf16 v[28:31], a[116:119], v[76:79], v[28:31]
    v_mfma_f32_16x16x32_bf16 v[32:35], a[172:175], v[72:75], v[32:35]
    v_mfma_f32_16x16x32_bf16 v[36:39], a[172:175], v[76:79], v[36:39]
    v_mfma_f32_16x16x32_bf16 v[40:43], a[228:231], v[72:75], v[40:43]
    v_mfma_f32_16x16x32_bf16 v[44:47], a[228:231], v[76:79], v[44:47]
    v_mfma_f32_16x16x32_bf16 v[48:51], v[148:151], v[72:75], v[48:51]
    v_mfma_f32_16x16x32_bf16 v[52:55], v[148:151], v[76:79], v[52:55]
    v_mfma_f32_16x16x32_bf16 v[56:59], v[204:207], v[72:75], v[56:59]
    v_mfma_f32_16x16x32_bf16 v[60:63], v[204:207], v[76:79], v[60:63]
    s_waitcnt lgkmcnt(0)
    ds_read_b128 v[72:75], v4 offset:6144
    ds_read_b128 v[76:79], v4 offset:6400
    v_mfma_f32_16x16x32_bf16 v[8:11], a[8:11], v[64:67], v[8:11]
    v_mfma_f32_16x16x32_bf16 v[12:15], a[8:11], v[68:71], v[12:15]
    v_mfma_f32_16x16x32_bf16 v[16:19], a[64:67], v[64:67], v[16:19]
    v_mfma_f32_16x16x32_bf16 v[20:23], a[64:67], v[68:71], v[20:23]
    v_mfma_f32_16x16x32_bf16 v[24:27], a[120:123], v[64:67], v[24:27]
    v_mfma_f32_16x16x32_bf16 v[28:31], a[120:123], v[68:71], v[28:31]
    v_mfma_f32_16x16x32_bf16 v[32:35], a[176:179], v[64:67], v[32:35]
    v_mfma_f32_16x16x32_bf16 v[36:39], a[176:179], v[68:71], v[36:39]
    v_mfma_f32_16x16x32_bf16 v[40:43], a[232:235], v[64:67], v[40:43]
    v_mfma_f32_16x16x32_bf16 v[44:47], a[232:235], v[68:71], v[44:47]
    v_mfma_f32_16x16x32_bf16 v[48:51], v[152:155], v[64:67], v[48:51]
    v_mfma_f32_16x16x32_bf16 v[52:55], v[152:155], v[68:71], v[52:55]
    v_mfma_f32_16x16x32_bf16 v[56:59], v[208:211], v[64:67], v[56:59]
    v_mfma_f32_16x16x32_bf16 v[60:63], v[208:211], v[68:71], v[60:63]
    s_waitcnt lgkmcnt(0)
    ds_read_b128 v[64:67], v4 offset:8192
    ds_read_b128 v[68:71], v4 offset:8448
    v_mfma_f32_16x16x32_bf16 v[8:11], a[12:15], v[72:75], v[8:11]
    v_mfma_f32_16x16x32_bf16 v[12:15], a[12:15], v[76:79], v[12:15]
    v_mfma_f32_16x16x32_bf16 v[16:19], a[68:71], v[72:75], v[16:19]
    v_mfma_f32_16x16x32_bf16 v[20:23], a[68:71], v[76:79], v[20:23]
    v_mfma_f32_16x16x32_bf16 v[24:27], a[124:127], v[72:75], v[24:27]
    v_mfma_f32_16x16x32_bf16 v[28:31], a[124:127], v[76:79], v[28:31]
    v_mfma_f32_16x16x32_bf16 v[32:35], a[180:183], v[72:75], v[32:35]
    v_mfma_f32_16x16x32_bf16 v[36:39], a[180:183], v[76:79], v[36:39]
    v_mfma_f32_16x16x32_bf16 v[40:43], a[236:239], v[72:75], v[40:43]
    v_mfma_f32_16x16x32_bf16 v[44:47], a[236:239], v[76:79], v[44:47]
    v_mfma_f32_16x16x32_bf16 v[48:51], v[156:159], v[72:75], v[48:51]
    v_mfma_f32_16x16x32_bf16 v[52:55], v[156:159], v[76:79], v[52:55]
    v_mfma_f32_16x16x32_bf16 v[56:59], v[212:215], v[72:75], v[56:59]
    v_mfma_f32_16x16x32_bf16 v[60:63], v[212:215], v[76:79], v[60:63]
    s_waitcnt lgkmcnt(0)
    ds_read_b128 v[72:75], v4 offset:10240
    ds_read_b128 v[76:79], v4 offset:10496
    v_mfma_f32_16x16x32_bf16 v[8:11], a[16:19], v[64:67], v[8:11]
    v_mfma_f32_16x16x32_bf16 v[12:15], a[16:19], v[68:71], v[12:15]
    v_mfma_f32_16x16x32_bf16 v[16:19], a[72:75], v[64:67], v[16:19]
    v_mfma_f32_16x16x32_bf16 v[20:23], a[72:75], v[68:71], v[20:23]
    v_mfma_f32_16x16x32_bf16 v[24:27], a[128:131], v[64:67], v[24:27]
    v_mfma_f32_16x16x32_bf16 v[28:31], a[128:131], v[68:71], v[28:31]
    v_mfma_f32_16x16x32_bf16 v[32:35], a[184:187], v[64:67], v[32:35]
    v_mfma_f32_16x16x32_bf16 v[36:39], a[184:187], v[68:71], v[36:39]
    v_mfma_f32_16x16x32_bf16 v[40:43], a[240:243], v[64:67], v[40:43]
    v_mfma_f32_16x16x32_bf16 v[44:47], a[240:243], v[68:71], v[44:47]
    v_mfma_f32_16x16x32_bf16 v[48:51], v[160:163], v[64:67], v[48:51]
    v_mfma_f32_16x16x32_bf16 v[52:55], v[160:163], v[68:71], v[52:55]
    v_mfma_f32_16x16x32_bf16 v[56:59], v[216:219], v[64:67], v[56:59]
    v_mfma_f32_16x16x32_bf16 v[60:63], v[216:219], v[68:71], v[60:63]
    s_waitcnt lgkmcnt(0)
    ds_read_b128 v[64:67], v4 offset:12288
    ds_read_b128 v[68:71], v4 offset:12544
    v_mfma_f32_16x16x32_bf16 v[8:11], a[20:23], v[72:75], v[8:11]
    v_mfma_f32_16x16x32_bf16 v[12:15], a[20:23], v[76:79], v[12:15]
    v_mfma_f32_16x16x32_bf16 v[16:19], a[76:79], v[72:75], v[16:19]
    v_mfma_f32_16x16x32_bf16 v[20:23], a[76:79], v[76:79], v[20:23]
    v_mfma_f32_16x16x32_bf16 v[24:27], a[132:135], v[72:75], v[24:27]
    v_mfma_f32_16x16x32_bf16 v[28:31], a[132:135], v[76:79], v[28:31]
    v_mfma_f32_16x16x32_bf16 v[32:35], a[188:191], v[72:75], v[32:35]
    v_mfma_f32_16x16x32_bf16 v[36:39], a[188:191], v[76:79], v[36:39]
    v_mfma_f32_16x16x32_bf16 v[40:43], a[244:247], v[72:75], v[40:43]
    v_mfma_f32_16x16x32_bf16 v[44:47], a[244:247], v[76:79], v[44:47]
    v_mfma_f32_16x16x32_bf16 v[48:51], v[164:167], v[72:75], v[48:51]
    v_mfma_f32_16x16x32_bf16 v[52:55], v[164:167], v[76:79], v[52:55]
    v_mfma_f32_16x16x32_bf16 v[56:59], v[220:223], v[72:75], v[56:59]
    v_mfma_f32_16x16x32_bf16 v[60:63], v[220:223], v[76:79], v[60:63]
    s_waitcnt lgkmcnt(0)
    ds_read_b128 v[72:75], v4 offset:14336
    ds_read_b128 v[76:79], v4 offset:14592
    v_mfma_f32_16x16x32_bf16 v[8:11], a[24:27], v[64:67], v[8:11]
    v_mfma_f32_16x16x32_bf16 v[12:15], a[24:27], v[68:71], v[12:15]
    v_mfma_f32_16x16x32_bf16 v[16:19], a[80:83], v[64:67], v[16:19]
    v_mfma_f32_16x16x32_bf16 v[20:23], a[80:83], v[68:71], v[20:23]
    v_mfma_f32_16x16x32_bf16 v[24:27], a[136:139], v[64:67], v[24:27]
    v_mfma_f32_16x16x32_bf16 v[28:31], a[136:139], v[68:71], v[28:31]
    v_mfma_f32_16x16x32_bf16 v[32:35], a[192:195], v[64:67], v[32:35]
    v_mfma_f32_16x16x32_bf16 v[36:39], a[192:195], v[68:71], v[36:39]
    v_mfma_f32_16x16x32_bf16 v[40:43], a[248:251], v[64:67], v[40:43]
    v_mfma_f32_16x16x32_bf16 v[44:47], a[248:251], v[68:71], v[44:47]
    v_mfma_f32_16x16x32_bf16 v[48:51], v[168:171], v[64:67], v[48:51]
    v_mfma_f32_16x16x32_bf16 v[52:55], v[168:171], v[68:71], v[52:55]
    v_mfma_f32_16x16x32_bf16 v[56:59], v[224:227], v[64:67], v[56:59]
    v_mfma_f32_16x16x32_bf16 v[60:63], v[224:227], v[68:71], v[60:63]
    s_waitcnt lgkmcnt(0)
    ds_read_b128 v[64:67], v4 offset:16384
    ds_read_b128 v[68:71], v4 offset:16640
    v_mfma_f32_16x16x32_bf16 v[8:11], a[28:31], v[72:75], v[8:11]
    v_mfma_f32_16x16x32_bf16 v[12:15], a[28:31], v[76:79], v[12:15]
    v_mfma_f32_16x16x32_bf16 v[16:19], a[84:87], v[72:75], v[16:19]
    v_mfma_f32_16x16x32_bf16 v[20:23], a[84:87], v[76:79], v[20:23]
    v_mfma_f32_16x16x32_bf16 v[24:27], a[140:143], v[72:75], v[24:27]
    v_mfma_f32_16x16x32_bf16 v[28:31], a[140:143], v[76:79], v[28:31]
    v_mfma_f32_16x16x32_bf16 v[32:35], a[196:199], v[72:75], v[32:35]
    v_mfma_f32_16x16x32_bf16 v[36:39], a[196:199], v[76:79], v[36:39]
    v_mfma_f32_16x16x32_bf16 v[40:43], a[252:255], v[72:75], v[40:43]
    v_mfma_f32_16x16x32_bf16 v[44:47], a[252:255], v[76:79], v[44:47]
    v_mfma_f32_16x16x32_bf16 v[48:51], v[172:175], v[72:75], v[48:51]
    v_mfma_f32_16x16x32_bf16 v[52:55], v[172:175], v[76:79], v[52:55]
    v_mfma_f32_16x16x32_bf16 v[56:59], v[228:231], v[72:75], v[56:59]
    v_mfma_f32_16x16x32_bf16 v[60:63], v[228:231], v[76:79], v[60:63]
    s_waitcnt lgkmcnt(0)
    ds_read_b128 v[72:75], v4 offset:18432
    ds_read_b128 v[76:79], v4 offset:18688
    v_mfma_f32_16x16x32_bf16 v[8:11], a[32:35], v[64:67], v[8:11]
    v_mfma_f32_16x16x32_bf16 v[12:15], a[32:35], v[68:71], v[12:15]
    v_mfma_f32_16x16x32_bf16 v[16:19], a[88:91], v[64:67], v[16:19]
    v_mfma_f32_16x16x32_bf16 v[20:23], a[88:91], v[68:71], v[20:23]
    v_mfma_f32_16x16x32_bf16 v[24:27], a[144:147], v[64:67], v[24:27]
    v_mfma_f32_16x16x32_bf16 v[28:31], a[144:147], v[68:71], v[28:31]
    v_mfma_f32_16x16x32_bf16 v[32:35], a[200:203], v[64:67], v[32:35]
    v_mfma_f32_16x16x32_bf16 v[36:39], a[200:203], v[68:71], v[36:39]
    v_mfma_f32_16x16x32_bf16 v[40:43], v[120:123], v[64:67], v[40:43]
    v_mfma_f32_16x16x32_bf16 v[44:47], v[120:123], v[68:71], v[44:47]
    v_mfma_f32_16x16x32_bf16 v[48:51], v[176:179], v[64:67], v[48:51]
    v_mfma_f32_16x16x32_bf16 v[52:55], v[176:179], v[68:71], v[52:55]
    v_mfma_f32_16x16x32_bf16 v[56:59], v[232:235], v[64:67], v[56:59]
    v_mfma_f32_16x16x32_bf16 v[60:63], v[232:235], v[68:71], v[60:63]
    s_waitcnt lgkmcnt(0)
    ds_read_b128 v[64:67], v4 offset:20480
    ds_read_b128 v[68:71], v4 offset:20736
    v_mfma_f32_16x16x32_bf16 v[8:11], a[36:39], v[72:75], v[8:11]
    v_mfma_f32_16x16x32_bf16 v[12:15], a[36:39], v[76:79], v[12:15]
    v_mfma_f32_16x16x32_bf16 v[16:19], a[92:95], v[72:75], v[16:19]
    v_mfma_f32_16x16x32_bf16 v[20:23], a[92:95], v[76:79], v[20:23]
    v_mfma_f32_16x16x32_bf16 v[24:27], a[148:151], v[72:75], v[24:27]
    v_mfma_f32_16x16x32_bf16 v[28:31], a[148:151], v[76:79], v[28:31]
    v_mfma_f32_16x16x32_bf16 v[32:35], a[204:207], v[72:75], v[32:35]
    v_mfma_f32_16x16x32_bf16 v[36:39], a[204:207], v[76:79], v[36:39]
    v_mfma_f32_16x16x32_bf16 v[40:43], v[124:127], v[72:75], v[40:43]
    v_mfma_f32_16x16x32_bf16 v[44:47], v[124:127], v[76:79], v[44:47]
    v_mfma_f32_16x16x32_bf16 v[48:51], v[180:183], v[72:75], v[48:51]
    v_mfma_f32_16x16x32_bf16 v[52:55], v[180:183], v[76:79], v[52:55]
    v_mfma_f32_16x16x32_bf16 v[56:59], v[236:239], v[72:75], v[56:59]
    v_mfma_f32_16x16x32_bf16 v[60:63], v[236:239], v[76:79], v[60:63]
    s_waitcnt lgkmcnt(0)
    ds_read_b128 v[72:75], v4 offset:22528
    ds_read_b128 v[76:79], v4 offset:22784
    v_mfma_f32_16x16x32_bf16 v[8:11], a[40:43], v[64:67], v[8:11]
    v_mfma_f32_16x16x32_bf16 v[12:15], a[40:43], v[68:71], v[12:15]
    v_mfma_f32_16x16x32_bf16 v[16:19], a[96:99], v[64:67], v[16:19]
    v_mfma_f32_16x16x32_bf16 v[20:23], a[96:99], v[68:71], v[20:23]
    v_mfma_f32_16x16x32_bf16 v[24:27], a[152:155], v[64:67], v[24:27]
    v_mfma_f32_16x16x32_bf16 v[28:31], a[152:155], v[68:71], v[28:31]
    v_mfma_f32_16x16x32_bf16 v[32:35], a[208:211], v[64:67], v[32:35]
    v_mfma_f32_16x16x32_bf16 v[36:39], a[208:211], v[68:71], v[36:39]
    v_mfma_f32_16x16x32_bf16 v[40:43], v[128:131], v[64:67], v[40:43]
    v_mfma_f32_16x16x32_bf16 v[44:47], v[128:131], v[68:71], v[44:47]
    v_mfma_f32_16x16x32_bf16 v[48:51], v[184:187], v[64:67], v[48:51]
    v_mfma_f32_16x16x32_bf16 v[52:55], v[184:187], v[68:71], v[52:55]
    v_mfma_f32_16x16x32_bf16 v[56:59], v[240:243], v[64:67], v[56:59]
    v_mfma_f32_16x16x32_bf16 v[60:63], v[240:243], v[68:71], v[60:63]
    s_waitcnt lgkmcnt(0)
    ds_read_b128 v[64:67], v4 offset:24576
    ds_read_b128 v[68:71], v4 offset:24832
    v_mfma_f32_16x16x32_bf16 v[8:11], a[44:47], v[72:75], v[8:11]
    v_mfma_f32_16x16x32_bf16 v[12:15], a[44:47], v[76:79], v[12:15]
    v_mfma_f32_16x16x32_bf16 v[16:19], a[100:103], v[72:75], v[16:19]
    v_mfma_f32_16x16x32_bf16 v[20:23], a[100:103], v[76:79], v[20:23]
    v_mfma_f32_16x16x32_bf16 v[24:27], a[156:159], v[72:75], v[24:27]
    v_mfma_f32_16x16x32_bf16 v[28:31], a[156:159], v[76:79], v[28:31]
    v_mfma_f32_16x16x32_bf16 v[32:35], a[212:215], v[72:75], v[32:35]
    v_mfma_f32_16x16x32_bf16 v[36:39], a[212:215], v[76:79], v[36:39]
    v_mfma_f32_16x16x32_bf16 v[40:43], v[132:135], v[72:75], v[40:43]
    v_mfma_f32_16x16x32_bf16 v[44:47], v[132:135], v[76:79], v[44:47]
    v_mfma_f32_16x16x32_bf16 v[48:51], v[188:191], v[72:75], v[48:51]
    v_mfma_f32_16x16x32_bf16 v[52:55], v[188:191], v[76:79], v[52:55]
    v_mfma_f32_16x16x32_bf16 v[56:59], v[244:247], v[72:75], v[56:59]
    v_mfma_f32_16x16x32_bf16 v[60:63], v[244:247], v[76:79], v[60:63]
    s_waitcnt lgkmcnt(0)
    ds_read_b128 v[72:75], v4 offset:26624
    ds_read_b128 v[76:79], v4 offset:26880
    v_mfma_f32_16x16x32_bf16 v[8:11], a[48:51], v[64:67], v[8:11]
    v_mfma_f32_16x16x32_bf16 v[12:15], a[48:51], v[68:71], v[12:15]
    v_mfma_f32_16x16x32_bf16 v[16:19], a[104:107], v[64:67], v[16:19]
    v_mfma_f32_16x16x32_bf16 v[20:23], a[104:107], v[68:71], v[20:23]
    v_mfma_f32_16x16x32_bf16 v[24:27], a[160:163], v[64:67], v[24:27]
    v_mfma_f32_16x16x32_bf16 v[28:31], a[160:163], v[68:71], v[28:31]
    v_mfma_f32_16x16x32_bf16 v[32:35], a[216:219], v[64:67], v[32:35]
    v_mfma_f32_16x16x32_bf16 v[36:39], a[216:219], v[68:71], v[36:39]
    v_mfma_f32_16x16x32_bf16 v[40:43], v[136:139], v[64:67], v[40:43]
    v_mfma_f32_16x16x32_bf16 v[44:47], v[136:139], v[68:71], v[44:47]
    v_mfma_f32_16x16x32_bf16 v[48:51], v[192:195], v[64:67], v[48:51]
    v_mfma_f32_16x16x32_bf16 v[52:55], v[192:195], v[68:71], v[52:55]
    v_mfma_f32_16x16x32_bf16 v[56:59], v[248:251], v[64:67], v[56:59]
    v_mfma_f32_16x16x32_bf16 v[60:63], v[248:251], v[68:71], v[60:63]
    s_waitcnt lgkmcnt(0)
    v_mfma_f32_16x16x32_bf16 v[8:11], a[52:55], v[72:75], v[8:11]
    v_mfma_f32_16x16x32_bf16 v[12:15], a[52:55], v[76:79], v[12:15]
    v_mfma_f32_16x16x32_bf16 v[16:19], a[108:111], v[72:75], v[16:19]
    v_mfma_f32_16x16x32_bf16 v[20:23], a[108:111], v[76:79], v[20:23]
    v_mfma_f32_16x16x32_bf16 v[24:27], a[164:167], v[72:75], v[24:27]
    v_mfma_f32_16x16x32_bf16 v[28:31], a[164:167], v[76:79], v[28:31]
    v_mfma_f32_16x16x32_bf16 v[32:35], a[220:223], v[72:75], v[32:35]
    v_mfma_f32_16x16x32_bf16 v[36:39], a[220:223], v[76:79], v[36:39]
    v_mfma_f32_16x16x32_bf16 v[40:43], v[140:143], v[72:75], v[40:43]
    v_mfma_f32_16x16x32_bf16 v[44:47], v[140:143], v[76:79], v[44:47]
    v_mfma_f32_16x16x32_bf16 v[48:51], v[196:199], v[72:75], v[48:51]
    v_mfma_f32_16x16x32_bf16 v[52:55], v[196:199], v[76:79], v[52:55]
    v_mfma_f32_16x16x32_bf16 v[56:59], v[252:255], v[72:75], v[56:59]
    v_mfma_f32_16x16x32_bf16 v[60:63], v[252:255], v[76:79], v[60:63]
    s_nop 7
    v_cvt_pk_bf16_f32 v8, v8, v9
    v_cvt_pk_bf16_f32 v9, v16, v17
    v_cvt_pk_bf16_f32 v10, v10, v11
    v_cvt_pk_bf16_f32 v11, v18, v19
    v_cvt_pk_bf16_f32 v24, v24, v25
    v_cvt_pk_bf16_f32 v25, v32, v33
    v_cvt_pk_bf16_f32 v26, v26, v27
    v_cvt_pk_bf16_f32 v27, v34, v35
    v_cvt_pk_bf16_f32 v40, v40, v41
    v_cvt_pk_bf16_f32 v41, v48, v49
    v_cvt_pk_bf16_f32 v42, v42, v43
    v_cvt_pk_bf16_f32 v43, v50, v51
    v_cvt_pk_bf16_f32 v56, v56, v57
    v_cvt_pk_bf16_f32 v57, v58, v59
    v_cvt_pk_bf16_f32 v12, v12, v13
    v_cvt_pk_bf16_f32 v13, v20, v21
    v_cvt_pk_bf16_f32 v14, v14, v15
    v_cvt_pk_bf16_f32 v15, v22, v23
    v_cvt_pk_bf16_f32 v28, v28, v29
    v_cvt_pk_bf16_f32 v29, v36, v37
    v_cvt_pk_bf16_f32 v30, v30, v31
    v_cvt_pk_bf16_f32 v31, v38, v39
    v_cvt_pk_bf16_f32 v44, v44, v45
    v_cvt_pk_bf16_f32 v45, v52, v53
    v_cvt_pk_bf16_f32 v46, v46, v47
    v_cvt_pk_bf16_f32 v47, v54, v55
    v_cvt_pk_bf16_f32 v60, v60, v61
    v_cvt_pk_bf16_f32 v61, v62, v63
    s_mul_i32 s26, s46, 7168
    s_add_u32 s26, s26, 17244160
ts_poll:
    buffer_load_dwordx4 v[90:93], v83, s[4:7], s26 offen sc1
    buffer_load_dwordx4 v[94:97], v83, s[4:7], s26 offen offset:1024 sc1
    s_waitcnt vmcnt(0)
    ds_write_b128 v84, v[90:93]
    ds_write_b128 v84, v[94:97] offset:1024
    v_max3_u32 v98, v90, v91, v92
    v_max3_u32 v99, v93, v94, v95
    v_max3_u32 v98, v98, v96, v97
    v_max_u32 v98, v98, v99
    v_cmp_eq_u32 vcc, -1, v98
    s_cbranch_vccnz ts_retry
ts_go:
    s_waitcnt lgkmcnt(0)
    s_barrier
    ds_read_b128 v[64:67], v5 offset:0
    ds_read_b128 v[68:71], v5 offset:512
    ds_read_b128 v[72:75], v6 offset:0
    ds_read_b64 v[76:77], v7 offset:0
    s_waitcnt lgkmcnt(0)
    v_mfma_f32_16x16x32_bf16 v[16:19], v[64:67], v[8:11], 0
    v_mfma_f32_16x16x32_bf16 v[20:23], v[64:67], v[12:15], 0
    v_mfma_f32_16x16x32_bf16 v[16:19], v[68:71], v[24:27], v[16:19]
    v_mfma_f32_16x16x32_bf16 v[20:23], v[68:71], v[28:31], v[20:23]
    v_mfma_f32_16x16x32_bf16 v[16:19], v[72:75], v[40:43], v[16:19]
    v_mfma_f32_16x16x32_bf16 v[20:23], v[72:75], v[44:47], v[20:23]
    v_mfma_f32_16x16x16_bf16 v[16:19], v[76:77], v[56:57], v[16:19]
    v_mfma_f32_16x16x16_bf16 v[20:23], v[76:77], v[60:61], v[20:23]
    ds_read_b128 v[64:67], v5 offset:32
    ds_read_b128 v[68:71], v5 offset:544
    ds_read_b128 v[72:75], v6 offset:32
    ds_read_b64 v[76:77], v7 offset:32
    s_waitcnt lgkmcnt(0)
    v_mfma_f32_16x16x32_bf16 v[32:35], v[64:67], v[8:11], 0
    v_mfma_f32_16x16x32_bf16 v[36:39], v[64:67], v[12:15], 0
    v_mfma_f32_16x16x32_bf16 v[32:35], v[68:71], v[24:27], v[32:35]
    v_mfma_f32_16x16x32_bf16 v[36:39], v[68:71], v[28:31], v[36:39]
    v_mfma_f32_16x16x32_bf16 v[32:35], v[72:75], v[40:43], v[32:35]
    v_mfma_f32_16x16x32_bf16 v[36:39], v[72:75], v[44:47], v[36:39]
    v_mfma_f32_16x16x16_bf16 v[32:35], v[76:77], v[56:57], v[32:35]
    v_mfma_f32_16x16x16_bf16 v[36:39], v[76:77], v[60:61], v[36:39]
    ds_read2_b32 v[64:65], v80 offset0:0 offset1:32
    ds_read2_b32 v[66:67], v80 offset0:1 offset1:33
    ds_read2_b32 v[68:69], v80 offset0:2 offset1:34
    ds_read2_b32 v[70:71], v80 offset0:3 offset1:35
    ds_read2_b32 v[72:73], v81 offset0:0 offset1:32
    ds_read2_b32 v[74:75], v81 offset0:1 offset1:33
    ds_read2_b32 v[76:77], v82 offset0:0 offset1:32
    s_waitcnt lgkmcnt(0)
    v_mfma_f32_16x16x32_bf16 v[48:51], v[64:67], v[8:11], 0
    v_mfma_f32_16x16x32_bf16 v[52:55], v[64:67], v[12:15], 0
    v_mfma_f32_16x16x32_bf16 v[48:51], v[68:71], v[24:27], v[48:51]
    v_mfma_f32_16x16x32_bf16 v[52:55], v[68:71], v[28:31], v[52:55]
    v_mfma_f32_16x16x32_bf16 v[48:51], v[72:75], v[40:43], v[48:51]
    v_mfma_f32_16x16x32_bf16 v[52:55], v[72:75], v[44:47], v[52:55]
    v_mfma_f32_16x16x16_bf16 v[48:51], v[76:77], v[56:57], v[48:51]
    v_mfma_f32_16x16x16_bf16 v[52:55], v[76:77], v[60:61], v[52:55]
    s_nop 7
    ds_write_b128 v85, v[16:19] offset:0
    ds_write_b128 v85, v[32:35] offset:1024
    ds_write_b128 v85, v[48:51] offset:2048
    ds_write_b128 v85, v[20:23] offset:3072
    ds_write_b128 v85, v[36:39] offset:4096
    ds_write_b128 v85, v[52:55] offset:5120
    s_waitcnt lgkmcnt(0)
    s_barrier
    s_cmp_ge_u32 s9, 2
    s_cbranch_scc1 ts_nosm
    ds_read_b128 v[8:11], v86 offset:0
    ds_read_b128 v[12:15], v86 offset:1024
    ds_read_b128 v[16:19], v86 offset:2048
    ds_read_b128 v[20:23], v86 offset:6144
    ds_read_b128 v[24:27], v86 offset:7168
    ds_read_b128 v[28:31], v86 offset:8192
    ds_read_b128 v[32:35], v86 offset:12288
    ds_read_b128 v[36:39], v86 offset:13312
    ds_read_b128 v[40:43], v86 offset:14336
    ds_read_b128 v[44:47], v86 offset:18432
    ds_read_b128 v[48:51], v86 offset:19456
    ds_read_b128 v[52:55], v86 offset:20480
    s_waitcnt lgkmcnt(0)
    v_pk_add_f32 v[8:9], v[8:9], v[20:21]
    v_pk_add_f32 v[32:33], v[32:33], v[44:45]
    v_pk_add_f32 v[10:11], v[10:11], v[22:23]
    v_pk_add_f32 v[34:35], v[34:35], v[46:47]
    v_pk_add_f32 v[12:13], v[12:13], v[24:25]
    v_pk_add_f32 v[36:37], v[36:37], v[48:49]
    v_pk_add_f32 v[14:15], v[14:15], v[26:27]
    v_pk_add_f32 v[38:39], v[38:39], v[50:51]
    v_pk_add_f32 v[16:17], v[16:17], v[28:29]
    v_pk_add_f32 v[40:41], v[40:41], v[52:53]
    v_pk_add_f32 v[18:19], v[18:19], v[30:31]
    v_pk_add_f32 v[42:43], v[42:43], v[54:55]
    v_pk_add_f32 v[8:9], v[8:9], v[32:33]
    v_pk_add_f32 v[10:11], v[10:11], v[34:35]
    v_pk_add_f32 v[12:13], v[12:13], v[36:37]
    v_pk_add_f32 v[14:15], v[14:15], v[38:39]
    v_pk_add_f32 v[16:17], v[16:17], v[40:41]
    v_pk_add_f32 v[18:19], v[18:19], v[42:43]
    v_mov_b32 v20, 0xff800000
    v_cmp_le_i32 vcc, 0, v87
    s_nop 1
    v_cndmask_b32 v8, v20, v8, vcc
    v_cmp_le_i32 vcc, 1, v87
    s_nop 1
    v_cndmask_b32 v9, v20, v9, vcc
    v_cmp_le_i32 vcc, 8, v87
    s_nop 1
    v_cndmask_b32 v10, v20, v10, vcc
    v_cmp_le_i32 vcc, 9, v87
    s_nop 1
    v_cndmask_b32 v11, v20, v11, vcc
    v_cmp_le_i32 vcc, 2, v87
    s_nop 1
    v_cndmask_b32 v12, v20, v12, vcc
    v_cmp_le_i32 vcc, 3, v87
    s_nop 1
    v_cndmask_b32 v13, v20, v13, vcc
    v_cmp_le_i32 vcc, 10, v87
    s_nop 1
    v_cndmask_b32 v14, v20, v14, vcc
    v_cmp_le_i32 vcc, 11, v87
    s_nop 1
    v_cndmask_b32 v15, v20, v15, vcc
    v_cmp_gt_u32 vcc, 32, v0
    s_nop 1
    v_cndmask_b32 v16, v20, v16, vcc
    v_cndmask_b32 v17, v20, v17, vcc
    v_cndmask_b32 v18, v20, v18, vcc
    v_cndmask_b32 v19, v20, v19, vcc
    v_max3_f32 v21, v8, v9, v10
    v_max3_f32 v22, v11, v12, v13
    v_max3_f32 v21, v21, v14, v15
    v_max3_f32 v22, v22, v16, v17
    v_max3_f32 v21, v21, v18, v19
    v_max_f32 v21, v21, v22
    v_mov_b32 v22, v21
    s_nop 1
    v_permlane16_swap_b32 v21, v22
    v_max_f32 v21, v21, v22
    v_mov_b32 v22, v21
    s_nop 1
    v_permlane32_swap_b32 v21, v22
    v_max_f32 v21, v21, v22
    v_mul_f32 v21, s50, v21
    v_fma_f32 v8, v8, s50, -v21
    v_fma_f32 v9, v9, s50, -v21
    v_fma_f32 v10, v10, s50, -v21
    v_fma_f32 v11, v11, s50, -v21
    v_fma_f32 v12, v12, s50, -v21
    v_fma_f32 v13, v13, s50, -v21
    v_fma_f32 v14, v14, s50, -v21
    v_fma_f32 v15, v15, s50, -v21
    v_fma_f32 v16, v16, s50, -v21
    v_fma_f32 v17, v17, s50, -v21
    v_fma_f32 v18, v18, s50, -v21
    v_fma_f32 v19, v19, s50, -v21
    v_exp_f32 v8, v8
    v_exp_f32 v9, v9
    v_exp_f32 v10, v10
    v_exp_f32 v11, v11
    v_exp_f32 v12, v12
    v_exp_f32 v13, v13
    v_exp_f32 v14, v14
    v_exp_f32 v15, v15
    v_exp_f32 v16, v16
    v_exp_f32 v17, v17
    v_exp_f32 v18, v18
    v_exp_f32 v19, v19
    s_nop 0
    v_add_f32 v21, v8, v9
    v_add_f32 v21, v21, v10
    v_add_f32 v21, v21, v11
    v_add_f32 v21, v21, v12
    v_add_f32 v21, v21, v13
    v_add_f32 v21, v21, v14
    v_add_f32 v21, v21, v15
    v_add_f32 v21, v21, v16
    v_add_f32 v21, v21, v17
    v_add_f32 v21, v21, v18
    v_add_f32 v21, v21, v19
    v_mov_b32 v22, v21
    s_nop 1
    v_permlane16_swap_b32 v21, v22
    v_add_f32 v21, v21, v22
    v_mov_b32 v22, v21
    s_nop 1
    v_permlane32_swap_b32 v21, v22
    v_add_f32 v21, v21, v22
    v_rcp_f32 v21, v21
    s_nop 0
    v_mul_f32 v8, v8, v21
    v_mul_f32 v9, v9, v21
    v_mul_f32 v10, v10, v21
    v_mul_f32 v11, v11, v21
    v_mul_f32 v12, v12, v21
    v_mul_f32 v13, v13, v21
    v_mul_f32 v14, v14, v21
    v_mul_f32 v15, v15, v21
    v_mul_f32 v16, v16, v21
    v_mul_f32 v17, v17, v21
    v_mul_f32 v18, v18, v21
    v_mul_f32 v19, v19, v21
    v_cvt_pk_bf16_f32 v24, v8, v9
    v_cvt_pk_bf16_f32 v25, v10, v11
    v_cvt_pk_bf16_f32 v26, v12, v13
    v_cvt_pk_bf16_f32 v27, v14, v15
    v_cvt_pk_bf16_f32 v28, v16, v17
    v_cvt_pk_bf16_f32 v29, v18, v19
    s_lshl_b32 s24, s46, 4
    s_add_u32 s24, s24, s44
    s_lshl_b32 s25, s24, 11
    s_lshl_b32 s26, s9, 10
    s_add_u32 s25, s25, s26
    s_add_u32 s25, s25, 55066624
    buffer_store_dwordx4 v[24:27], v1, s[4:7], s25 offen sc1
    s_lshl_b32 s25, s24, 9
    s_add_u32 s25, s25, 57163776
    buffer_store_dwordx2 v[28:29], v88, s[4:7], s25 offen sc1
ts_nosm:
    s_mov_b32 s53, s46
    s_add_u32 s46, s46, 4
    v_xor_b32 v4, 32768, v4
    v_xor_b32 v5, 32768, v5
    v_xor_b32 v6, 32768, v6
    v_xor_b32 v7, 32768, v7
    s_add_u32 s49, s49, 1
    s_cmp_lt_u32 s49, 16
    s_cbranch_scc1 ts_loop
    s_waitcnt vmcnt(0)
    s_barrier
    s_cmp_lg_u32 s9, 0
    s_cbranch_scc1 ts_nosigb
    s_lshl_b32 s24, s53, 7
    s_add_u32 s24, s24, 57696256
    v_mov_b32 v3, s24
    s_mov_b64 exec, 1
    buffer_atomic_add v2, v3, s[4:7], 0 offen
    s_mov_b64 exec, -1
ts_nosigb:
    s_endpgm
ts_retry:
    s_cmp_eq_u32 s17, 0
    s_cbranch_scc1 ts_go
    s_sub_u32 s17, s17, 1
    s_sleep 4
    s_branch ts_poll
to_start:
    s_cmp_ge_u32 s11, 84
    s_cbranch_scc1 to_end
    s_mul_i32 s45, s11, 4682
    s_lshr_b32 s45, s45, 16
    s_mul_i32 s24, s45, 14
    s_sub_u32 s44, s11, s24
    s_and_b32 s50, s9, 1
    s_lshr_b32 s51, s9, 1
    v_lshlrev_b32 v1, 4, v0
    v_lshrrev_b32 v8, 4, v0
    v_and_b32 v9, 15, v0
    v_mul_u32_u24 v10, 7168, v8
    v_lshlrev_b32 v11, 4, v9
    s_lshl_b32 s24, s44, 1
    s_add_u32 s24, s24, s50
    s_lshl_b32 s24, s24, 8
    v_add3_u32 v4, v10, v11, s24
    v_lshlrev_b32 v10, 9, v8
    s_lshl_b32 s24, s51, 8
    v_add3_u32 v5, v10, v11, s24
    s_lshl_b32 s24, s51, 4
    v_add_u32 v10, s24, v9
    v_mul_u32_u24 v10, 896, v10
    v_lshl_add_u32 v10, v8, 3, v10
    s_lshl_b32 s24, s44, 6
    s_lshl_b32 s25, s50, 5
    s_add_u32 s24, s24, s25
    v_add_u32 v6, s24, v10
    s_mov_b32 s46, s45
    s_mov_b32 s24, 224
    v_mbcnt_lo_u32_b32 v174, -1, 0
    v_mbcnt_hi_u32_b32 v174, -1, v174
    v_cmp_gt_u32 vcc, 32, v174
    v_add_u32 v174, s24, v174
    v_lshlrev_b32 v174, 7, v174
    v_add_u32 v174, 57753600, v174
    v_mov_b32 v172, 0x7fff0000
    v_cndmask_b32 v174, v172, v174, vcc
wm14:
    buffer_load_dword v172, v174, s[4:7], 0 offen sc1
    s_waitcnt vmcnt(0)
    v_cmp_eq_u32 s[80:81], s18, v172
    s_cmp_eq_u32 s80, -1
    s_cbranch_scc1 wm14_ok
    s_cmp_eq_u32 s17, 0
    s_cbranch_scc1 wm14_ok
    s_sub_u32 s17, s17, 1
    s_sleep 8
    s_branch wm14
wm14_ok:
to_loop:
    s_lshl_b32 s24, s46, 7
    s_add_u32 s24, s24, 57688064
    v_mov_b32 v173, s24
to_wcd:
    buffer_load_dword v172, v173, s[4:7], 0 offen sc1
    s_waitcnt vmcnt(0)
    v_readfirstlane_b32 s25, v172
    s_nop 0
    s_cmp_ge_u32 s25, 16
    s_cbranch_scc1 to_wcd_go
    s_cmp_eq_u32 s17, 0
    s_cbranch_scc1 to_wcd_go
    s_sub_u32 s17, s17, 1
    s_sleep 2
    s_branch to_wcd
to_wcd_go:
    s_mul_i32 s26, s46, 458752
    s_lshl_b32 s27, s44, 15
    s_add_u32 s26, s26, s27
    s_lshl_b32 s27, s50, 10
    s_add_u32 s26, s26, s27
    s_add_u32 s26, s26, 18366464
    buffer_load_dwordx4 v[8:11], v1, s[4:7], s26 offen offset:0 sc1
    buffer_load_dwordx4 v[12:15], v1, s[4:7], s26 offen offset:2048 sc1
    s_add_u32 s26, s26, 4096
    buffer_load_dwordx4 v[16:19], v1, s[4:7], s26 offen offset:0 sc1
    buffer_load_dwordx4 v[20:23], v1, s[4:7], s26 offen offset:2048 sc1
    s_add_u32 s26, s26, 4096
    buffer_load_dwordx4 v[24:27], v1, s[4:7], s26 offen offset:0 sc1
    buffer_load_dwordx4 v[28:31], v1, s[4:7], s26 offen offset:2048 sc1
    s_add_u32 s26, s26, 4096
    buffer_load_dwordx4 v[32:35], v1, s[4:7], s26 offen offset:0 sc1
    buffer_load_dwordx4 v[36:39], v1, s[4:7], s26 offen offset:2048 sc1
    s_add_u32 s26, s26, 4096
    buffer_load_dwordx4 v[40:43], v1, s[4:7], s26 offen offset:0 sc1
    buffer_load_dwordx4 v[44:47], v1, s[4:7], s26 offen offset:2048 sc1
    s_add_u32 s26, s26, 4096
    buffer_load_dwordx4 v[48:51], v1, s[4:7], s26 offen offset:0 sc1
    buffer_load_dwordx4 v[52:55], v1, s[4:7], s26 offen offset:2048 sc1
    s_add_u32 s26, s26, 4096
    buffer_load_dwordx4 v[56:59], v1, s[4:7], s26 offen offset:0 sc1
    buffer_load_dwordx4 v[60:63], v1, s[4:7], s26 offen offset:2048 sc1
    s_add_u32 s26, s26, 4096
    buffer_load_dwordx4 v[64:67], v1, s[4:7], s26 offen offset:0 sc1
    buffer_load_dwordx4 v[68:71], v1, s[4:7], s26 offen offset:2048 sc1
    s_lshl_b32 s24, s46, 7
    s_add_u32 s24, s24, 57696256
    v_mov_b32 v173, s24
to_wcp:
    buffer_load_dword v172, v173, s[4:7], 0 offen sc1
    s_waitcnt vmcnt(0)
    v_readfirstlane_b32 s25, v172
    s_nop 0
    s_cmp_ge_u32 s25, 16
    s_cbranch_scc1 to_wcp_go
    s_cmp_eq_u32 s17, 0
    s_cbranch_scc1 to_wcp_go
    s_sub_u32 s17, s17, 1
    s_sleep 2
    s_branch to_wcp
to_wcp_go:
    s_lshl_b32 s26, s46, 15
    s_lshl_b32 s27, s51, 10
    s_add_u32 s26, s26, s27
    s_add_u32 s26, s26, 55066624
    buffer_load_dwordx4 v[88:91], v1, s[4:7], s26 offen offset:0 sc1
    buffer_load_dwordx4 v[92:95], v1, s[4:7], s26 offen offset:2048 sc1
    s_add_u32 s26, s26, 4096
    buffer_load_dwordx4 v[96:99], v1, s[4:7], s26 offen offset:0 sc1
    buffer_load_dwordx4 v[100:103], v1, s[4:7], s26 offen offset:2048 sc1
    s_add_u32 s26, s26, 4096
    buffer_load_dwordx4 v[104:107], v1, s[4:7], s26 offen offset:0 sc1
    buffer_load_dwordx4 v[108:111], v1, s[4:7], s26 offen offset:2048 sc1
    s_add_u32 s26, s26, 4096
    buffer_load_dwordx4 v[112:115], v1, s[4:7], s26 offen offset:0 sc1
    buffer_load_dwordx4 v[116:119], v1, s[4:7], s26 offen offset:2048 sc1
    s_add_u32 s26, s26, 4096
    buffer_load_dwordx4 v[120:123], v1, s[4:7], s26 offen offset:0 sc1
    buffer_load_dwordx4 v[124:127], v1, s[4:7], s26 offen offset:2048 sc1
    s_add_u32 s26, s26, 4096
    buffer_load_dwordx4 v[128:131], v1, s[4:7], s26 offen offset:0 sc1
    buffer_load_dwordx4 v[132:135], v1, s[4:7], s26 offen offset:2048 sc1
    s_add_u32 s26, s26, 4096
    buffer_load_dwordx4 v[136:139], v1, s[4:7], s26 offen offset:0 sc1
    buffer_load_dwordx4 v[140:143], v1, s[4:7], s26 offen offset:2048 sc1
    s_add_u32 s26, s26, 4096
    buffer_load_dwordx4 v[144:147], v1, s[4:7], s26 offen offset:0 sc1
    buffer_load_dwordx4 v[148:151], v1, s[4:7], s26 offen offset:2048 sc1
    s_lshl_b32 s26, s46, 13
    s_add_u32 s26, s26, 57163776
    buffer_load_dwordx4 v[152:155], v5, s[4:7], s26 offen offset:0 sc1
    buffer_load_dwordx4 v[156:159], v5, s[4:7], s26 offen offset:2048 sc1
    s_add_u32 s26, s26, 4096
    buffer_load_dwordx4 v[160:163], v5, s[4:7], s26 offen offset:0 sc1
    buffer_load_dwordx4 v[164:167], v5, s[4:7], s26 offen offset:2048 sc1
    s_lshl_b32 s24, s46, 7
    s_add_u32 s24, s24, 57704448
    v_mov_b32 v173, s24
to_wcu:
    buffer_load_dword v172, v173, s[4:7], 0 offen sc1
    s_waitcnt vmcnt(0)
    v_readfirstlane_b32 s25, v172
    s_nop 0
    s_cmp_ge_u32 s25, 16
    s_cbranch_scc1 to_wcu_go
    s_cmp_eq_u32 s17, 0
    s_cbranch_scc1 to_wcu_go
    s_sub_u32 s17, s17, 1
    s_sleep 2
    s_branch to_wcu
to_wcu_go:
    s_mul_i32 s26, s46, 114688
    s_add_u32 s26, s26, 47726592
    buffer_load_dwordx4 v[72:75], v4, s[4:7], s26 offen sc1
    s_add_u32 s26, s26, 28672
    buffer_load_dwordx4 v[76:79], v4, s[4:7], s26 offen sc1
    s_add_u32 s26, s26, 28672
    buffer_load_dwordx4 v[80:83], v4, s[4:7], s26 offen sc1
    s_add_u32 s26, s26, 28672
    buffer_load_dwordx4 v[84:87], v4, s[4:7], s26 offen sc1
    s_waitcnt vmcnt(4)
    v_mfma_f32_16x16x32_bf16 v[168:171], v[8:11], v[88:91], 0
    v_mfma_f32_16x16x32_bf16 v[168:171], v[12:15], v[92:95], v[168:171]
    v_mfma_f32_16x16x32_bf16 v[168:171], v[16:19], v[96:99], v[168:171]
    v_mfma_f32_16x16x32_bf16 v[168:171], v[20:23], v[100:103], v[168:171]
    v_mfma_f32_16x16x32_bf16 v[168:171], v[24:27], v[104:107], v[168:171]
    v_mfma_f32_16x16x32_bf16 v[168:171], v[28:31], v[108:111], v[168:171]
    v_mfma_f32_16x16x32_bf16 v[168:171], v[32:35], v[112:115], v[168:171]
    v_mfma_f32_16x16x32_bf16 v[168:171], v[36:39], v[116:119], v[168:171]
    v_mfma_f32_16x16x32_bf16 v[168:171], v[40:43], v[120:123], v[168:171]
    v_mfma_f32_16x16x32_bf16 v[168:171], v[44:47], v[124:127], v[168:171]
    v_mfma_f32_16x16x32_bf16 v[168:171], v[48:51], v[128:131], v[168:171]
    v_mfma_f32_16x16x32_bf16 v[168:171], v[52:55], v[132:135], v[168:171]
    v_mfma_f32_16x16x32_bf16 v[168:171], v[56:59], v[136:139], v[168:171]
    v_mfma_f32_16x16x32_bf16 v[168:171], v[60:63], v[140:143], v[168:171]
    v_mfma_f32_16x16x32_bf16 v[168:171], v[64:67], v[144:147], v[168:171]
    v_mfma_f32_16x16x32_bf16 v[168:171], v[68:71], v[148:151], v[168:171]
    s_waitcnt vmcnt(0)
    v_mfma_f32_16x16x32_bf16 v[168:171], v[72:75], v[152:155], v[168:171]
    v_mfma_f32_16x16x32_bf16 v[168:171], v[76:79], v[156:159], v[168:171]
    v_mfma_f32_16x16x32_bf16 v[168:171], v[80:83], v[160:163], v[168:171]
    v_mfma_f32_16x16x32_bf16 v[168:171], v[84:87], v[164:167], v[168:171]
    s_mul_i32 s26, s46, 28672
    s_nop 6
    v_cvt_pk_bf16_f32 v172, v168, v169
    v_cvt_pk_bf16_f32 v173, v170, v171
    buffer_store_dwordx2 v[172:173], v6, s[20:23], s26 offen
    s_add_u32 s46, s46, 6
    s_cmp_lt_u32 s46, 64
    s_cbranch_scc1 to_loop
to_end:
    s_endpgm
.section .rodata,"a"
.p2align 6
.amdhsa_kernel standalone__memory_aug_recurrent_mem_tr__prompt_kernel
  .amdhsa_next_free_vgpr 512
  .amdhsa_next_free_sgpr 102
  .amdhsa_accum_offset 256
  .amdhsa_group_segment_fixed_size 0
  .amdhsa_kernarg_size 80
  .amdhsa_user_sgpr_count 2
  .amdhsa_user_sgpr_kernarg_segment_ptr 1
  .amdhsa_system_sgpr_workgroup_id_x 1
  .amdhsa_float_denorm_mode_32 3
.end_amdhsa_kernel
```
